```python
import torch

def _softmax(x, axis=-1):
    return torch.softmax(x, dim=axis)

def _gelu(x):
    return torch.nn.functional.gelu(x, approximate='tanh')

def _silu(x):
    return torch.nn.functional.silu(x)

def _sigmoid(x):
    return torch.sigmoid(x)

def _layernorm(x, axis=-1, eps=1e-05):
    m = x.mean(dim=axis, keepdim=True)
    v = x.var(dim=axis, keepdim=True, unbiased=False)
    return (x - m) / torch.sqrt(v + eps)

def _scatter_add(tgt, idx, src, axis=0):
    return tgt.clone().index_add_(axis, idx, src)

def _segment_sum(src, seg, n):
    out = torch.zeros((n,) + src.shape[1:], dtype=src.dtype)
    return out.index_add_(0, seg, src)

def _pad(x, pw):
    flat = tuple((v for pair in reversed(pw) for v in pair))
    return torch.nn.functional.pad(x, flat)
kernel_name = 'concat_heads__linear_attn_block__memory_aug_recurrent_mem_tr__prompt'

def setup_inputs():

    _w = lambda a: (lambda t: t.to(torch.bfloat16) if t.is_floating_point() else t)(torch.as_tensor(a))

    def _A_setup():
        B, S, D = (1, 2048, 512)
        return {'x': _w((lambda *s: torch.randn(*s, dtype=torch.bfloat16) * 0.05)(B, S, D)), 'wqkv': _w((lambda *s: torch.randn(*s, dtype=torch.bfloat16) * 0.4)(D, 3 * D)), 'wo': _w((lambda *s: torch.randn(*s, dtype=torch.bfloat16) * 0.1)(D, D))}
    _A_in = _A_setup()

    def _B_setup():
        B, S, Dm = (1, 2048, 512)
        H, Dh = (32, 128)
        M, seg = (8, 32)
        seg = min(seg, S)
        S = S // seg * seg
        return {'x': _w((lambda *s: torch.randn(*s, dtype=torch.bfloat16) * 0.05)(B, S, Dm)), 'mem0': _w((lambda *s: torch.randn(*s, dtype=torch.bfloat16) * 0.4)(B, M, Dm)), 'Wq': _w((lambda *s: torch.randn(*s, dtype=torch.bfloat16) * 6.4)(Dm, H, Dh) * Dm ** (-0.5)), 'Wk': _w((lambda *s: torch.randn(*s, dtype=torch.bfloat16) * 6.4)(Dm, H, Dh) * Dm ** (-0.5)), 'Wv': _w((lambda *s: torch.randn(*s, dtype=torch.bfloat16) * 0.4)(Dm, H, Dh) * Dm ** (-0.5)), 'Wo': _w((lambda *s: torch.randn(*s, dtype=torch.bfloat16) * 0.4)(H, Dh, Dm) * (H * Dh) ** (-0.5)), 'seg_len': seg}
    _B_in = _B_setup()
    return {'A_x': _A_in['x'], 'A_wqkv': _A_in['wqkv'], 'A_wo': _A_in['wo'], 'B_x': _B_in['x'], 'B_mem0': _B_in['mem0'], 'B_Wq': _B_in['Wq'], 'B_Wk': _B_in['Wk'], 'B_Wv': _B_in['Wv'], 'B_Wo': _B_in['Wo'], 'B_seg_len': _B_in['seg_len']}

def reference(A_x, A_wqkv, A_wo, B_x, B_mem0, B_Wq, B_Wk, B_Wv, B_Wo, B_seg_len):

    def _A_ref(x, wqkv, wo):
        B, S, D = x.shape
        H = 32
        Dh = D // H
        qkv = (lambda x, *d: x.permute(*d))((x @ wqkv).reshape(B, S, 3, H, Dh), 2, 0, 3, 1, 4)
        q, k, v = (qkv[0], qkv[1], qkv[2])
        phi = lambda t: torch.where(t > 0, t + 1, torch.exp(t)) + 1e-06
        pq, pk = (phi(q), phi(k))
        kv = torch.einsum('bhsd,bhse->bhde', pk, v)
        z = torch.einsum('bhsd->bhd', pk)
        num = torch.einsum('bhqd,bhde->bhqe', pq, kv)
        den = torch.einsum('bhqd,bhd->bhq', pq, z)[..., None] + 1e-06
        o = num / den
        return (lambda x, *d: x.permute(*d))(o, 0, 2, 1, 3).reshape(B, S, D) @ wo

    def _B_ref(x, mem0, Wq, Wk, Wv, Wo, seg_len):
        B, S, Dm = x.shape
        H, Dh = (Wq.shape[1], Wq.shape[2])
        M = mem0.shape[1]
        scale = Dh ** (-0.5)
        n_seg = S // seg_len
        L = M + seg_len
        idx = torch.arange(L)
        mask = (idx[:, None] < M) | (idx[:, None] >= idx[None, :])
        mem = mem0
        outs = []
        for s in range(n_seg):
            xs = x[:, s * seg_len:(s + 1) * seg_len, :].clone()
            h = torch.concatenate([mem, xs], axis=1)
            q = torch.einsum('btd,dhe->bhte', h, Wq)
            k = torch.einsum('btd,dhe->bhte', h, Wk)
            v = torch.einsum('btd,dhe->bhte', h, Wv)
            scores = torch.einsum('bhqe,bhke->bhqk', q, k) * scale
            scores = torch.where(mask[None, None], scores, -1000000000.0)
            p = _softmax(scores, axis=-1)
            o = torch.einsum('bhqk,bhke->bhqe', p, v)
            o = torch.einsum('bhte,hed->btd', o, Wo)
            mem = o[:, :M, :].clone()
            outs.append(o[:, M:, :])
        return torch.concatenate(outs, axis=1)
    a = _A_ref(A_x, A_wqkv, A_wo)
    b = _B_ref(B_x, B_mem0, B_Wq, B_Wk, B_Wv, B_Wo, B_seg_len)
    return torch.concatenate([a, b], axis=-1)
```

```asm
; @launch grid=(256,1,1) block=(256,1,1) lds=163840
.amdgcn_target "amdgcn-amd-amdhsa--gfx950"
.text
.globl concat_heads__linear_attn_block__memory_aug_recurrent_mem_tr__prompt_kernel
.p2align 8
.type concat_heads__linear_attn_block__memory_aug_recurrent_mem_tr__prompt_kernel,@function
concat_heads__linear_attn_block__memory_aug_recurrent_mem_tr__prompt_kernel:
    s_cmp_ge_u32 s2, 256
    s_cbranch_scc0 L_go
L_team_done:
    s_endpgm
L_go:
    s_load_dwordx16 s[40:55], s[0:1], 0
    s_load_dwordx8 s[56:63], s[0:1], 64
    s_load_dwordx2 s[64:65], s[0:1], 96
    s_getreg_b32 s22, hwreg(HW_REG_XCC_ID, 0, 3)
    v_lshrrev_b32 v1, 6, v0
    s_lshl_b32 s20, s22, 5
    v_readfirstlane_b32 s16, v1
    s_mov_b32 s38, 1
    s_mov_b32 s71, 0
    s_mov_b32 s17, 0
    s_waitcnt lgkmcnt(0)
    s_mov_b32 s12, s62
    s_and_b32 s13, s63, 0xffff
    s_mov_b32 s14, 0x100
    s_mov_b32 s15, 0x20000
    s_mov_b32 s8, s64
    s_and_b32 s9, s65, 0xffff
    s_mov_b32 s10, 0x10000000
    s_mov_b32 s11, 0x20000
    v_mov_b32 v1, 0x7f000000
    v_cmp_eq_u32 vcc, 0, v0
    v_mov_b32 v3, 1
    v_mov_b32 v2, 30208
    v_cndmask_b32 v1, v1, 0, vcc
    buffer_atomic_add v3, v1, s[12:15], s20 offen sc0
    v_lshlrev_b32 v6, 4, v0
    s_cmp_eq_u32 s22, 0
    s_cbranch_scc1 L_nopf
    s_lshr_b32 s24, s2, 3
    s_mul_i32 s24, s24, 7
    s_add_u32 s24, s24, s22
    s_sub_u32 s24, s24, 1
    s_mul_i32 s24, s24, 20480
    s_mov_b32 s4, s50
    s_and_b32 s5, s51, 0xffff
    s_mov_b32 s6, 0x400000
    s_mov_b32 s7, 0x20000
    buffer_load_dwordx4 v[128:131], v6, s[4:7], s24 offen
    s_add_u32 s24, s24, 4096
    buffer_load_dwordx4 v[132:135], v6, s[4:7], s24 offen
    s_add_u32 s24, s24, 4096
    buffer_load_dwordx4 v[136:139], v6, s[4:7], s24 offen
    s_add_u32 s24, s24, 4096
    buffer_load_dwordx4 v[140:143], v6, s[4:7], s24 offen
    s_add_u32 s24, s24, 4096
    buffer_load_dwordx4 v[144:147], v6, s[4:7], s24 offen
    s_add_u32 s24, s24, 4096
    s_waitcnt vmcnt(5)
    s_branch L_pfd
L_nopf:
    v_and_b32 v7, 15, v0
    v_bfe_u32 v8, v0, 5, 1
    v_bfe_u32 v9, v0, 4, 1
    v_lshlrev_b32 v8, 18, v8
    v_lshl_add_u32 v8, v9, 16, v8
    v_lshl_add_u32 v7, v7, 4, v8
    s_lshr_b32 s24, s2, 3
    s_lshl_b32 s24, s24, 8
    s_lshl_b32 s25, s16, 20
    s_add_u32 s24, s24, s25
    s_mov_b32 s4, s50
    s_and_b32 s5, s51, 0xffff
    s_mov_b32 s6, 0x400000
    s_mov_b32 s7, 0x20000
    s_add_u32 s25, s24, 0
    buffer_load_dwordx4 v[128:131], v7, s[4:7], s25 offen
    s_add_u32 s25, s24, 8192
    buffer_load_dwordx4 v[132:135], v7, s[4:7], s25 offen
    s_add_u32 s25, s24, 131072
    buffer_load_dwordx4 v[136:139], v7, s[4:7], s25 offen
    s_add_u32 s25, s24, 139264
    buffer_load_dwordx4 v[140:143], v7, s[4:7], s25 offen
    s_add_u32 s25, s24, 16384
    buffer_load_dwordx4 v[144:147], v7, s[4:7], s25 offen
    s_add_u32 s25, s24, 24576
    buffer_load_dwordx4 v[148:151], v7, s[4:7], s25 offen
    s_add_u32 s25, s24, 147456
    buffer_load_dwordx4 v[152:155], v7, s[4:7], s25 offen
    s_add_u32 s25, s24, 155648
    buffer_load_dwordx4 v[156:159], v7, s[4:7], s25 offen
    s_waitcnt vmcnt(8)
L_pfd:
    s_and_saveexec_b64 s[72:73], vcc
    ds_write_b32 v2, v3
    s_mov_b64 exec, s[72:73]
    s_waitcnt lgkmcnt(0)
    s_barrier
    ds_read_b32 v3, v2
    s_waitcnt lgkmcnt(0)
    v_readfirstlane_b32 s19, v3
    s_barrier
    s_lshl_b32 s21, s22, 5
    s_add_u32 s21, s21, s19
    s_cmp_lt_u32 s19, 32
    s_cbranch_scc1 L_have_slot
    v_and_b32 v4, 63, v0
    v_lshlrev_b32 v4, 2, v4
L_ovf_wait:
    s_add_u32 s71, s71, 1
    s_cmp_gt_u32 s71, 0x200000
    s_cbranch_scc1 L_work_fail
    s_sleep 2
    buffer_load_dword v5, v4, s[12:15], 0 offen sc1
    s_waitcnt vmcnt(0)
    v_readlane_b32 s24, v5, 0
    v_readlane_b32 s25, v5, 8
    v_readlane_b32 s26, v5, 16
    v_readlane_b32 s27, v5, 24
    v_readlane_b32 s28, v5, 32
    v_readlane_b32 s29, v5, 40
    v_readlane_b32 s30, v5, 48
    v_readlane_b32 s31, v5, 56
    s_nop 1
    s_mov_b32 s19, s24
    s_add_u32 s19, s19, s25
    s_add_u32 s19, s19, s26
    s_add_u32 s19, s19, s27
    s_add_u32 s19, s19, s28
    s_add_u32 s19, s19, s29
    s_add_u32 s19, s19, s30
    s_add_u32 s19, s19, s31
    s_cmp_lt_u32 s19, 256
    s_cbranch_scc1 L_ovf_wait
    s_mov_b32 s20, 112
    v_mov_b32 v1, 0x7f000000
    v_cmp_eq_u32 vcc, 0, v0
    v_mov_b32 v3, 1
    v_mov_b32 v2, 30208
    v_cndmask_b32 v1, v1, 0, vcc
    buffer_atomic_add v3, v1, s[12:15], s20 offen sc0
    s_waitcnt vmcnt(0)
    s_and_saveexec_b64 s[72:73], vcc
    ds_write_b32 v2, v3
    s_mov_b64 exec, s[72:73]
    s_waitcnt lgkmcnt(0)
    s_barrier
    ds_read_b32 v3, v2
    s_waitcnt lgkmcnt(0)
    v_readfirstlane_b32 s19, v3
    s_barrier
    s_min_u32 s24, s24, 32
    s_add_u32 s21, s24, s19
    s_cmp_lt_u32 s21, 32
    s_cbranch_scc1 L_ovf_0
    s_sub_u32 s19, s21, 32
    s_min_u32 s25, s25, 32
    s_add_u32 s21, s25, s19
    s_cmp_lt_u32 s21, 32
    s_cbranch_scc1 L_ovf_1
    s_sub_u32 s19, s21, 32
    s_min_u32 s26, s26, 32
    s_add_u32 s21, s26, s19
    s_cmp_lt_u32 s21, 32
    s_cbranch_scc1 L_ovf_2
    s_sub_u32 s19, s21, 32
    s_min_u32 s27, s27, 32
    s_add_u32 s21, s27, s19
    s_cmp_lt_u32 s21, 32
    s_cbranch_scc1 L_ovf_3
    s_sub_u32 s19, s21, 32
    s_min_u32 s28, s28, 32
    s_add_u32 s21, s28, s19
    s_cmp_lt_u32 s21, 32
    s_cbranch_scc1 L_ovf_4
    s_sub_u32 s19, s21, 32
    s_min_u32 s29, s29, 32
    s_add_u32 s21, s29, s19
    s_cmp_lt_u32 s21, 32
    s_cbranch_scc1 L_ovf_5
    s_sub_u32 s19, s21, 32
    s_min_u32 s30, s30, 32
    s_add_u32 s21, s30, s19
    s_cmp_lt_u32 s21, 32
    s_cbranch_scc1 L_ovf_6
    s_sub_u32 s19, s21, 32
    s_min_u32 s31, s31, 32
    s_add_u32 s21, s31, s19
    s_cmp_lt_u32 s21, 32
    s_cbranch_scc1 L_ovf_7
    s_sub_u32 s19, s21, 32
    s_branch L_work_fail
L_ovf_7:
    s_add_u32 s21, s21, 32
L_ovf_6:
    s_add_u32 s21, s21, 32
L_ovf_5:
    s_add_u32 s21, s21, 32
L_ovf_4:
    s_add_u32 s21, s21, 32
L_ovf_3:
    s_add_u32 s21, s21, 32
L_ovf_2:
    s_add_u32 s21, s21, 32
L_ovf_1:
    s_add_u32 s21, s21, 32
L_ovf_0:
    s_mov_b32 s38, 0x10001
L_have_slot:
    s_cmp_ge_u32 s21, 32
    s_cbranch_scc1 L_worker
    s_mov_b32 s17, s21
    v_and_b32 v0, 63, v0
    v_lshlrev_b32 v0, 4, v0
    s_lshl_b32 s19, s17, 13
    s_add_u32 s32, s19, 62914560
    s_add_u32 s34, s32, 524288
    s_lshl_b32 s70, s17, 12
    s_add_u32 s70, s70, 63963136
    v_mov_b32 v116, 0x7f000000
    s_lshl_b32 s19, s16, 10
    v_add_u32 v117, s19, v0
    v_cmp_eq_u32 vcc, 0, v117
    v_mov_b32 v117, s38
    s_mov_b32 s71, 0
    v_cndmask_b32 v116, v116, 0, vcc
    v_lshrrev_b32 v1, 4, v0
    v_lshrrev_b32 v2, 4, v1
    v_and_b32 v1, 15, v1
    v_lshrrev_b32 v16, 1, v2
    v_and_b32 v17, 1, v2
    v_lshlrev_b32 v18, 5, v16
    v_lshl_add_u32 v18, v17, 3, v18
    v_lshlrev_b32 v18, 13, v18
    s_lshl_b32 s19, s17, 8
    s_lshl_b32 s21, s16, 20
    s_add_u32 s21, s21, s19
    v_lshl_add_u32 v3, v1, 4, v18
    s_mov_b32 s4, s50
    s_and_b32 s5, s51, 0xffff
    s_mov_b32 s6, 0x400000
    s_mov_b32 s7, 0x20000
    s_mov_b32 s84, s52
    s_and_b32 s85, s53, 0xffff
    s_mov_b32 s86, 0x400000
    s_mov_b32 s87, 0x20000
    s_mov_b32 s88, s54
    s_and_b32 s89, s55, 0xffff
    s_mov_b32 s90, 0x400000
    s_mov_b32 s91, 0x20000
    s_mov_b32 s80, s56
    s_and_b32 s81, s57, 0xffff
    s_mov_b32 s82, 0x400000
    s_mov_b32 s83, 0x20000
    s_add_u32 s22, s21, 0
    buffer_load_dwordx4 v[128:131], v3, s[4:7], s22 offen
    s_add_u32 s22, s21, 8192
    buffer_load_dwordx4 v[132:135], v3, s[4:7], s22 offen
    s_add_u32 s22, s21, 131072
    buffer_load_dwordx4 v[136:139], v3, s[4:7], s22 offen
    s_add_u32 s22, s21, 139264
    buffer_load_dwordx4 v[140:143], v3, s[4:7], s22 offen
    s_add_u32 s22, s21, 16384
    buffer_load_dwordx4 v[144:147], v3, s[4:7], s22 offen
    s_add_u32 s22, s21, 24576
    buffer_load_dwordx4 v[148:151], v3, s[4:7], s22 offen
    s_add_u32 s22, s21, 147456
    buffer_load_dwordx4 v[152:155], v3, s[4:7], s22 offen
    s_add_u32 s22, s21, 155648
    buffer_load_dwordx4 v[156:159], v3, s[4:7], s22 offen
    buffer_atomic_add v117, v116, s[12:15], 48 offen
    s_add_u32 s22, s21, 524288
    buffer_load_dwordx4 v[160:163], v3, s[4:7], s22 offen
    s_add_u32 s22, s21, 532480
    buffer_load_dwordx4 v[164:167], v3, s[4:7], s22 offen
    s_add_u32 s22, s21, 655360
    buffer_load_dwordx4 v[168:171], v3, s[4:7], s22 offen
    s_add_u32 s22, s21, 663552
    buffer_load_dwordx4 v[172:175], v3, s[4:7], s22 offen
    s_add_u32 s22, s21, 540672
    buffer_load_dwordx4 v[176:179], v3, s[4:7], s22 offen
    s_add_u32 s22, s21, 548864
    buffer_load_dwordx4 v[180:183], v3, s[4:7], s22 offen
    s_add_u32 s22, s21, 671744
    buffer_load_dwordx4 v[184:187], v3, s[4:7], s22 offen
    s_add_u32 s22, s21, 679936
    buffer_load_dwordx4 v[188:191], v3, s[4:7], s22 offen
    s_mov_b32 s28, 0x05040100
    s_mov_b32 s29, 0x07060302
    s_lshl_b32 s22, s16, 12
    s_add_u32 s22, s22, 32768
    v_add_u32 v5, s22, v0
    v_add_u32 v6, 0x10000, v5
    s_lshl_b32 s22, s16, 15
    s_add_u32 s22, s22, 32768
    v_add_u32 v7, s22, v0
    s_and_b32 s20, s16, 1
    s_lshl_b32 s20, s20, 16
    s_add_u32 s20, s20, 32768
    s_xor_b32 s22, s16, 0
    s_lshl_b32 s19, s22, 12
    s_add_u32 s19, s19, s20
    v_add_u32 v8, s19, v0
    s_lshl_b32 s19, s22, 10
    s_add_u32 s19, s19, 32768
    v_add_u32 v12, s19, v0
    s_xor_b32 s22, s16, 1
    s_lshl_b32 s19, s22, 12
    s_add_u32 s19, s19, s20
    v_add_u32 v9, s19, v0
    s_lshl_b32 s19, s22, 10
    s_add_u32 s19, s19, 65536
    v_add_u32 v13, s19, v0
    s_xor_b32 s22, s16, 2
    s_lshl_b32 s19, s22, 12
    s_add_u32 s19, s19, s20
    v_add_u32 v10, s19, v0
    s_lshl_b32 s19, s22, 10
    s_add_u32 s19, s19, 98304
    v_add_u32 v14, s19, v0
    s_xor_b32 s22, s16, 3
    s_lshl_b32 s19, s22, 12
    s_add_u32 s19, s19, s20
    v_add_u32 v11, s19, v0
    s_lshl_b32 s19, s22, 10
    s_add_u32 s19, s19, 131072
    v_add_u32 v15, s19, v0
    v_lshlrev_b32 v16, 6, v16
    v_add_u32 v16, v16, v17
    v_lshlrev_b32 v16, 10, v16
    v_lshl_add_u32 v4, v1, 4, v16
    s_lshl_b32 s19, s17, 17
    s_lshl_b32 s20, s16, 8
    s_add_u32 s19, s19, s20
    v_add_u32 v4, s19, v4
    s_waitcnt vmcnt(9)
    v_perm_b32 v16, v132, v128, s28
    v_perm_b32 v17, v140, v136, s28
    v_perm_b32 v18, v148, v144, s28
    v_perm_b32 v19, v156, v152, s28
    ds_write_b128 v5, v[16:19] offset:0
    v_perm_b32 v20, v132, v128, s29
    v_perm_b32 v21, v140, v136, s29
    v_perm_b32 v22, v148, v144, s29
    v_perm_b32 v23, v156, v152, s29
    ds_write_b128 v5, v[20:23] offset:16384
    v_perm_b32 v24, v133, v129, s28
    v_perm_b32 v25, v141, v137, s28
    v_perm_b32 v26, v149, v145, s28
    v_perm_b32 v27, v157, v153, s28
    ds_write_b128 v5, v[24:27] offset:32768
    v_perm_b32 v28, v133, v129, s29
    v_perm_b32 v29, v141, v137, s29
    v_perm_b32 v30, v149, v145, s29
    v_perm_b32 v31, v157, v153, s29
    ds_write_b128 v5, v[28:31] offset:49152
    v_perm_b32 v32, v134, v130, s28
    v_perm_b32 v33, v142, v138, s28
    v_perm_b32 v34, v150, v146, s28
    v_perm_b32 v35, v158, v154, s28
    ds_write_b128 v6, v[32:35] offset:0
    v_perm_b32 v36, v134, v130, s29
    v_perm_b32 v37, v142, v138, s29
    v_perm_b32 v38, v150, v146, s29
    v_perm_b32 v39, v158, v154, s29
    ds_write_b128 v6, v[36:39] offset:16384
    v_perm_b32 v40, v135, v131, s28
    v_perm_b32 v41, v143, v139, s28
    v_perm_b32 v42, v151, v147, s28
    v_perm_b32 v43, v159, v155, s28
    ds_write_b128 v6, v[40:43] offset:32768
    v_perm_b32 v44, v135, v131, s29
    v_perm_b32 v45, v143, v139, s29
    v_perm_b32 v46, v151, v147, s29
    v_perm_b32 v47, v159, v155, s29
    ds_write_b128 v6, v[44:47] offset:49152
    s_add_u32 s22, s21, 32768
    buffer_load_dwordx4 v[192:195], v3, s[4:7], s22 offen
    s_add_u32 s22, s21, 40960
    buffer_load_dwordx4 v[196:199], v3, s[4:7], s22 offen
    s_add_u32 s22, s21, 163840
    buffer_load_dwordx4 v[200:203], v3, s[4:7], s22 offen
    s_add_u32 s22, s21, 172032
    buffer_load_dwordx4 v[204:207], v3, s[4:7], s22 offen
    s_add_u32 s22, s21, 49152
    buffer_load_dwordx4 v[208:211], v3, s[4:7], s22 offen
    s_add_u32 s22, s21, 57344
    buffer_load_dwordx4 v[212:215], v3, s[4:7], s22 offen
    s_add_u32 s22, s21, 180224
    buffer_load_dwordx4 v[216:219], v3, s[4:7], s22 offen
    s_add_u32 s22, s21, 188416
    buffer_load_dwordx4 v[220:223], v3, s[4:7], s22 offen
    s_waitcnt vmcnt(8)
    s_waitcnt lgkmcnt(0)
    v_perm_b32 v16, v164, v160, s28
    v_perm_b32 v17, v172, v168, s28
    v_perm_b32 v18, v180, v176, s28
    v_perm_b32 v19, v188, v184, s28
    ds_write_b128 v5, v[16:19] offset:1024
    v_perm_b32 v20, v164, v160, s29
    v_perm_b32 v21, v172, v168, s29
    v_perm_b32 v22, v180, v176, s29
    v_perm_b32 v23, v188, v184, s29
    ds_write_b128 v5, v[20:23] offset:17408
    v_perm_b32 v24, v165, v161, s28
    v_perm_b32 v25, v173, v169, s28
    v_perm_b32 v26, v181, v177, s28
    v_perm_b32 v27, v189, v185, s28
    ds_write_b128 v5, v[24:27] offset:33792
    v_perm_b32 v28, v165, v161, s29
    v_perm_b32 v29, v173, v169, s29
    v_perm_b32 v30, v181, v177, s29
    v_perm_b32 v31, v189, v185, s29
    ds_write_b128 v5, v[28:31] offset:50176
    v_perm_b32 v32, v166, v162, s28
    v_perm_b32 v33, v174, v170, s28
    v_perm_b32 v34, v182, v178, s28
    v_perm_b32 v35, v190, v186, s28
    ds_write_b128 v6, v[32:35] offset:1024
    v_perm_b32 v36, v166, v162, s29
    v_perm_b32 v37, v174, v170, s29
    v_perm_b32 v38, v182, v178, s29
    v_perm_b32 v39, v190, v186, s29
    ds_write_b128 v6, v[36:39] offset:17408
    v_perm_b32 v40, v167, v163, s28
    v_perm_b32 v41, v175, v171, s28
    v_perm_b32 v42, v183, v179, s28
    v_perm_b32 v43, v191, v187, s28
    ds_write_b128 v6, v[40:43] offset:33792
    v_perm_b32 v44, v167, v163, s29
    v_perm_b32 v45, v175, v171, s29
    v_perm_b32 v46, v183, v179, s29
    v_perm_b32 v47, v191, v187, s29
    ds_write_b128 v6, v[44:47] offset:50176
    s_add_u32 s22, s21, 557056
    buffer_load_dwordx4 v[224:227], v3, s[4:7], s22 offen
    s_add_u32 s22, s21, 565248
    buffer_load_dwordx4 v[228:231], v3, s[4:7], s22 offen
    s_add_u32 s22, s21, 688128
    buffer_load_dwordx4 v[232:235], v3, s[4:7], s22 offen
    s_add_u32 s22, s21, 696320
    buffer_load_dwordx4 v[236:239], v3, s[4:7], s22 offen
    s_add_u32 s22, s21, 573440
    buffer_load_dwordx4 v[240:243], v3, s[4:7], s22 offen
    s_add_u32 s22, s21, 581632
    buffer_load_dwordx4 v[244:247], v3, s[4:7], s22 offen
    s_add_u32 s22, s21, 704512
    buffer_load_dwordx4 v[248:251], v3, s[4:7], s22 offen
    s_add_u32 s22, s21, 712704
    buffer_load_dwordx4 v[252:255], v3, s[4:7], s22 offen
    s_waitcnt vmcnt(8)
    s_waitcnt lgkmcnt(0)
    v_perm_b32 v16, v196, v192, s28
    v_perm_b32 v17, v204, v200, s28
    v_perm_b32 v18, v212, v208, s28
    v_perm_b32 v19, v220, v216, s28
    ds_write_b128 v5, v[16:19] offset:2048
    v_perm_b32 v20, v196, v192, s29
    v_perm_b32 v21, v204, v200, s29
    v_perm_b32 v22, v212, v208, s29
    v_perm_b32 v23, v220, v216, s29
    ds_write_b128 v5, v[20:23] offset:18432
    v_perm_b32 v24, v197, v193, s28
    v_perm_b32 v25, v205, v201, s28
    v_perm_b32 v26, v213, v209, s28
    v_perm_b32 v27, v221, v217, s28
    ds_write_b128 v5, v[24:27] offset:34816
    v_perm_b32 v28, v197, v193, s29
    v_perm_b32 v29, v205, v201, s29
    v_perm_b32 v30, v213, v209, s29
    v_perm_b32 v31, v221, v217, s29
    ds_write_b128 v5, v[28:31] offset:51200
    v_perm_b32 v32, v198, v194, s28
    v_perm_b32 v33, v206, v202, s28
    v_perm_b32 v34, v214, v210, s28
    v_perm_b32 v35, v222, v218, s28
    ds_write_b128 v6, v[32:35] offset:2048
    v_perm_b32 v36, v198, v194, s29
    v_perm_b32 v37, v206, v202, s29
    v_perm_b32 v38, v214, v210, s29
    v_perm_b32 v39, v222, v218, s29
    ds_write_b128 v6, v[36:39] offset:18432
    v_perm_b32 v40, v199, v195, s28
    v_perm_b32 v41, v207, v203, s28
    v_perm_b32 v42, v215, v211, s28
    v_perm_b32 v43, v223, v219, s28
    ds_write_b128 v6, v[40:43] offset:34816
    v_perm_b32 v44, v199, v195, s29
    v_perm_b32 v45, v207, v203, s29
    v_perm_b32 v46, v215, v211, s29
    v_perm_b32 v47, v223, v219, s29
    ds_write_b128 v6, v[44:47] offset:51200
    s_add_u32 s22, s21, 0
    buffer_load_dwordx4 v[48:51], v3, s[84:87], s22 offen
    s_add_u32 s22, s21, 8192
    buffer_load_dwordx4 v[52:55], v3, s[84:87], s22 offen
    s_add_u32 s22, s21, 131072
    buffer_load_dwordx4 v[56:59], v3, s[84:87], s22 offen
    s_add_u32 s22, s21, 139264
    buffer_load_dwordx4 v[60:63], v3, s[84:87], s22 offen
    s_add_u32 s22, s21, 16384
    buffer_load_dwordx4 v[64:67], v3, s[84:87], s22 offen
    s_add_u32 s22, s21, 24576
    buffer_load_dwordx4 v[68:71], v3, s[84:87], s22 offen
    s_add_u32 s22, s21, 147456
    buffer_load_dwordx4 v[72:75], v3, s[84:87], s22 offen
    s_add_u32 s22, s21, 155648
    buffer_load_dwordx4 v[76:79], v3, s[84:87], s22 offen
    s_waitcnt vmcnt(8)
    s_waitcnt lgkmcnt(0)
    v_perm_b32 v16, v228, v224, s28
    v_perm_b32 v17, v236, v232, s28
    v_perm_b32 v18, v244, v240, s28
    v_perm_b32 v19, v252, v248, s28
    ds_write_b128 v5, v[16:19] offset:3072
    v_perm_b32 v20, v228, v224, s29
    v_perm_b32 v21, v236, v232, s29
    v_perm_b32 v22, v244, v240, s29
    v_perm_b32 v23, v252, v248, s29
    ds_write_b128 v5, v[20:23] offset:19456
    v_perm_b32 v24, v229, v225, s28
    v_perm_b32 v25, v237, v233, s28
    v_perm_b32 v26, v245, v241, s28
    v_perm_b32 v27, v253, v249, s28
    ds_write_b128 v5, v[24:27] offset:35840
    v_perm_b32 v28, v229, v225, s29
    v_perm_b32 v29, v237, v233, s29
    v_perm_b32 v30, v245, v241, s29
    v_perm_b32 v31, v253, v249, s29
    ds_write_b128 v5, v[28:31] offset:52224
    v_perm_b32 v32, v230, v226, s28
    v_perm_b32 v33, v238, v234, s28
    v_perm_b32 v34, v246, v242, s28
    v_perm_b32 v35, v254, v250, s28
    ds_write_b128 v6, v[32:35] offset:3072
    v_perm_b32 v36, v230, v226, s29
    v_perm_b32 v37, v238, v234, s29
    v_perm_b32 v38, v246, v242, s29
    v_perm_b32 v39, v254, v250, s29
    ds_write_b128 v6, v[36:39] offset:19456
    v_perm_b32 v40, v231, v227, s28
    v_perm_b32 v41, v239, v235, s28
    v_perm_b32 v42, v247, v243, s28
    v_perm_b32 v43, v255, v251, s28
    ds_write_b128 v6, v[40:43] offset:35840
    v_perm_b32 v44, v231, v227, s29
    v_perm_b32 v45, v239, v235, s29
    v_perm_b32 v46, v247, v243, s29
    v_perm_b32 v47, v255, v251, s29
    ds_write_b128 v6, v[44:47] offset:52224
    s_add_u32 s22, s21, 524288
    buffer_load_dwordx4 v[80:83], v3, s[84:87], s22 offen
    s_add_u32 s22, s21, 532480
    buffer_load_dwordx4 v[84:87], v3, s[84:87], s22 offen
    s_add_u32 s22, s21, 655360
    buffer_load_dwordx4 v[88:91], v3, s[84:87], s22 offen
    s_add_u32 s22, s21, 663552
    buffer_load_dwordx4 v[92:95], v3, s[84:87], s22 offen
    s_add_u32 s22, s21, 540672
    buffer_load_dwordx4 v[96:99], v3, s[84:87], s22 offen
    s_add_u32 s22, s21, 548864
    buffer_load_dwordx4 v[100:103], v3, s[84:87], s22 offen
    s_add_u32 s22, s21, 671744
    buffer_load_dwordx4 v[104:107], v3, s[84:87], s22 offen
    s_add_u32 s22, s21, 679936
    buffer_load_dwordx4 v[108:111], v3, s[84:87], s22 offen
    s_waitcnt lgkmcnt(0)
    s_barrier
    s_cmp_ge_u32 s16, 2
    s_cbranch_scc1 L_rb_1
    ds_read_b128 a[0:3], v8 offset:0
    ds_read_b128 a[4:7], v8 offset:1024
    ds_read_b128 a[8:11], v8 offset:16384
    ds_read_b128 a[12:15], v8 offset:17408
    ds_read_b128 a[16:19], v8 offset:32768
    ds_read_b128 a[20:23], v8 offset:33792
    ds_read_b128 a[24:27], v8 offset:49152
    ds_read_b128 a[28:31], v8 offset:50176
    s_waitcnt lgkmcnt(6)
    ds_read_b128 a[32:35], v8 offset:2048
    ds_read_b128 a[36:39], v8 offset:3072
    ds_read_b128 a[40:43], v8 offset:18432
    ds_read_b128 a[44:47], v8 offset:19456
    ds_read_b128 a[48:51], v8 offset:34816
    ds_read_b128 a[52:55], v8 offset:35840
    ds_read_b128 a[56:59], v8 offset:51200
    ds_read_b128 a[60:63], v8 offset:52224
    s_waitcnt lgkmcnt(6)
    ds_read_b128 a[64:67], v9 offset:0
    ds_read_b128 a[68:71], v9 offset:1024
    ds_read_b128 a[72:75], v9 offset:16384
    ds_read_b128 a[76:79], v9 offset:17408
    ds_read_b128 a[80:83], v9 offset:32768
    ds_read_b128 a[84:87], v9 offset:33792
    ds_read_b128 a[88:91], v9 offset:49152
    ds_read_b128 a[92:95], v9 offset:50176
    s_waitcnt lgkmcnt(6)
    ds_read_b128 a[96:99], v9 offset:2048
    ds_read_b128 a[100:103], v9 offset:3072
    ds_read_b128 a[104:107], v9 offset:18432
    ds_read_b128 a[108:111], v9 offset:19456
    ds_read_b128 a[112:115], v9 offset:34816
    ds_read_b128 a[116:119], v9 offset:35840
    ds_read_b128 a[120:123], v9 offset:51200
    ds_read_b128 a[124:127], v9 offset:52224
    s_waitcnt lgkmcnt(6)
    ds_read_b128 a[128:131], v10 offset:0
    ds_read_b128 a[132:135], v10 offset:1024
    ds_read_b128 a[136:139], v10 offset:16384
    ds_read_b128 a[140:143], v10 offset:17408
    ds_read_b128 a[144:147], v10 offset:32768
    ds_read_b128 a[148:151], v10 offset:33792
    ds_read_b128 a[152:155], v10 offset:49152
    ds_read_b128 a[156:159], v10 offset:50176
    s_waitcnt lgkmcnt(6)
    ds_read_b128 a[160:163], v10 offset:2048
    ds_read_b128 a[164:167], v10 offset:3072
    ds_read_b128 a[168:171], v10 offset:18432
    ds_read_b128 a[172:175], v10 offset:19456
    ds_read_b128 a[176:179], v10 offset:34816
    ds_read_b128 a[180:183], v10 offset:35840
    ds_read_b128 a[184:187], v10 offset:51200
    ds_read_b128 a[188:191], v10 offset:52224
    s_waitcnt lgkmcnt(6)
    ds_read_b128 a[192:195], v11 offset:0
    ds_read_b128 a[196:199], v11 offset:1024
    ds_read_b128 a[200:203], v11 offset:16384
    ds_read_b128 a[204:207], v11 offset:17408
    ds_read_b128 a[208:211], v11 offset:32768
    ds_read_b128 a[212:215], v11 offset:33792
    ds_read_b128 a[216:219], v11 offset:49152
    ds_read_b128 a[220:223], v11 offset:50176
    s_waitcnt lgkmcnt(6)
    ds_read_b128 a[224:227], v11 offset:2048
    ds_read_b128 a[228:231], v11 offset:3072
    ds_read_b128 a[232:235], v11 offset:18432
    ds_read_b128 a[236:239], v11 offset:19456
    ds_read_b128 a[240:243], v11 offset:34816
    ds_read_b128 a[244:247], v11 offset:35840
    ds_read_b128 a[248:251], v11 offset:51200
    ds_read_b128 a[252:255], v11 offset:52224
    s_waitcnt lgkmcnt(6)
L_rb_1:
    s_waitcnt vmcnt(8)
    s_waitcnt lgkmcnt(0)
    s_barrier
    v_perm_b32 v16, v52, v48, s28
    v_perm_b32 v17, v60, v56, s28
    v_perm_b32 v18, v68, v64, s28
    v_perm_b32 v19, v76, v72, s28
    ds_write_b128 v5, v[16:19] offset:0
    v_perm_b32 v20, v52, v48, s29
    v_perm_b32 v21, v60, v56, s29
    v_perm_b32 v22, v68, v64, s29
    v_perm_b32 v23, v76, v72, s29
    ds_write_b128 v5, v[20:23] offset:16384
    v_perm_b32 v24, v53, v49, s28
    v_perm_b32 v25, v61, v57, s28
    v_perm_b32 v26, v69, v65, s28
    v_perm_b32 v27, v77, v73, s28
    ds_write_b128 v5, v[24:27] offset:32768
    v_perm_b32 v28, v53, v49, s29
    v_perm_b32 v29, v61, v57, s29
    v_perm_b32 v30, v69, v65, s29
    v_perm_b32 v31, v77, v73, s29
    ds_write_b128 v5, v[28:31] offset:49152
    v_perm_b32 v32, v54, v50, s28
    v_perm_b32 v33, v62, v58, s28
    v_perm_b32 v34, v70, v66, s28
    v_perm_b32 v35, v78, v74, s28
    ds_write_b128 v6, v[32:35] offset:0
    v_perm_b32 v36, v54, v50, s29
    v_perm_b32 v37, v62, v58, s29
    v_perm_b32 v38, v70, v66, s29
    v_perm_b32 v39, v78, v74, s29
    ds_write_b128 v6, v[36:39] offset:16384
    v_perm_b32 v40, v55, v51, s28
    v_perm_b32 v41, v63, v59, s28
    v_perm_b32 v42, v71, v67, s28
    v_perm_b32 v43, v79, v75, s28
    ds_write_b128 v6, v[40:43] offset:32768
    v_perm_b32 v44, v55, v51, s29
    v_perm_b32 v45, v63, v59, s29
    v_perm_b32 v46, v71, v67, s29
    v_perm_b32 v47, v79, v75, s29
    ds_write_b128 v6, v[44:47] offset:49152
    s_add_u32 s22, s21, 32768
    buffer_load_dwordx4 v[128:131], v3, s[84:87], s22 offen
    s_add_u32 s22, s21, 40960
    buffer_load_dwordx4 v[132:135], v3, s[84:87], s22 offen
    s_add_u32 s22, s21, 163840
    buffer_load_dwordx4 v[136:139], v3, s[84:87], s22 offen
    s_add_u32 s22, s21, 172032
    buffer_load_dwordx4 v[140:143], v3, s[84:87], s22 offen
    s_add_u32 s22, s21, 49152
    buffer_load_dwordx4 v[144:147], v3, s[84:87], s22 offen
    s_add_u32 s22, s21, 57344
    buffer_load_dwordx4 v[148:151], v3, s[84:87], s22 offen
    s_add_u32 s22, s21, 180224
    buffer_load_dwordx4 v[152:155], v3, s[84:87], s22 offen
    s_add_u32 s22, s21, 188416
    buffer_load_dwordx4 v[156:159], v3, s[84:87], s22 offen
    s_waitcnt vmcnt(8)
    s_waitcnt lgkmcnt(0)
    v_perm_b32 v16, v84, v80, s28
    v_perm_b32 v17, v92, v88, s28
    v_perm_b32 v18, v100, v96, s28
    v_perm_b32 v19, v108, v104, s28
    ds_write_b128 v5, v[16:19] offset:1024
    v_perm_b32 v20, v84, v80, s29
    v_perm_b32 v21, v92, v88, s29
    v_perm_b32 v22, v100, v96, s29
    v_perm_b32 v23, v108, v104, s29
    ds_write_b128 v5, v[20:23] offset:17408
    v_perm_b32 v24, v85, v81, s28
    v_perm_b32 v25, v93, v89, s28
    v_perm_b32 v26, v101, v97, s28
    v_perm_b32 v27, v109, v105, s28
    ds_write_b128 v5, v[24:27] offset:33792
    v_perm_b32 v28, v85, v81, s29
    v_perm_b32 v29, v93, v89, s29
    v_perm_b32 v30, v101, v97, s29
    v_perm_b32 v31, v109, v105, s29
    ds_write_b128 v5, v[28:31] offset:50176
    v_perm_b32 v32, v86, v82, s28
    v_perm_b32 v33, v94, v90, s28
    v_perm_b32 v34, v102, v98, s28
    v_perm_b32 v35, v110, v106, s28
    ds_write_b128 v6, v[32:35] offset:1024
    v_perm_b32 v36, v86, v82, s29
    v_perm_b32 v37, v94, v90, s29
    v_perm_b32 v38, v102, v98, s29
    v_perm_b32 v39, v110, v106, s29
    ds_write_b128 v6, v[36:39] offset:17408
    v_perm_b32 v40, v87, v83, s28
    v_perm_b32 v41, v95, v91, s28
    v_perm_b32 v42, v103, v99, s28
    v_perm_b32 v43, v111, v107, s28
    ds_write_b128 v6, v[40:43] offset:33792
    v_perm_b32 v44, v87, v83, s29
    v_perm_b32 v45, v95, v91, s29
    v_perm_b32 v46, v103, v99, s29
    v_perm_b32 v47, v111, v107, s29
    ds_write_b128 v6, v[44:47] offset:50176
    s_add_u32 s22, s21, 557056
    buffer_load_dwordx4 v[160:163], v3, s[84:87], s22 offen
    s_add_u32 s22, s21, 565248
    buffer_load_dwordx4 v[164:167], v3, s[84:87], s22 offen
    s_add_u32 s22, s21, 688128
    buffer_load_dwordx4 v[168:171], v3, s[84:87], s22 offen
    s_add_u32 s22, s21, 696320
    buffer_load_dwordx4 v[172:175], v3, s[84:87], s22 offen
    s_add_u32 s22, s21, 573440
    buffer_load_dwordx4 v[176:179], v3, s[84:87], s22 offen
    s_add_u32 s22, s21, 581632
    buffer_load_dwordx4 v[180:183], v3, s[84:87], s22 offen
    s_add_u32 s22, s21, 704512
    buffer_load_dwordx4 v[184:187], v3, s[84:87], s22 offen
    s_add_u32 s22, s21, 712704
    buffer_load_dwordx4 v[188:191], v3, s[84:87], s22 offen
    s_waitcnt vmcnt(8)
    s_waitcnt lgkmcnt(0)
    v_perm_b32 v16, v132, v128, s28
    v_perm_b32 v17, v140, v136, s28
    v_perm_b32 v18, v148, v144, s28
    v_perm_b32 v19, v156, v152, s28
    ds_write_b128 v5, v[16:19] offset:2048
    v_perm_b32 v20, v132, v128, s29
    v_perm_b32 v21, v140, v136, s29
    v_perm_b32 v22, v148, v144, s29
    v_perm_b32 v23, v156, v152, s29
    ds_write_b128 v5, v[20:23] offset:18432
    v_perm_b32 v24, v133, v129, s28
    v_perm_b32 v25, v141, v137, s28
    v_perm_b32 v26, v149, v145, s28
    v_perm_b32 v27, v157, v153, s28
    ds_write_b128 v5, v[24:27] offset:34816
    v_perm_b32 v28, v133, v129, s29
    v_perm_b32 v29, v141, v137, s29
    v_perm_b32 v30, v149, v145, s29
    v_perm_b32 v31, v157, v153, s29
    ds_write_b128 v5, v[28:31] offset:51200
    v_perm_b32 v32, v134, v130, s28
    v_perm_b32 v33, v142, v138, s28
    v_perm_b32 v34, v150, v146, s28
    v_perm_b32 v35, v158, v154, s28
    ds_write_b128 v6, v[32:35] offset:2048
    v_perm_b32 v36, v134, v130, s29
    v_perm_b32 v37, v142, v138, s29
    v_perm_b32 v38, v150, v146, s29
    v_perm_b32 v39, v158, v154, s29
    ds_write_b128 v6, v[36:39] offset:18432
    v_perm_b32 v40, v135, v131, s28
    v_perm_b32 v41, v143, v139, s28
    v_perm_b32 v42, v151, v147, s28
    v_perm_b32 v43, v159, v155, s28
    ds_write_b128 v6, v[40:43] offset:34816
    v_perm_b32 v44, v135, v131, s29
    v_perm_b32 v45, v143, v139, s29
    v_perm_b32 v46, v151, v147, s29
    v_perm_b32 v47, v159, v155, s29
    ds_write_b128 v6, v[44:47] offset:51200
    s_add_u32 s22, s21, 0
    buffer_load_dwordx4 v[192:195], v3, s[88:91], s22 offen
    s_add_u32 s22, s21, 8192
    buffer_load_dwordx4 v[196:199], v3, s[88:91], s22 offen
    s_add_u32 s22, s21, 131072
    buffer_load_dwordx4 v[200:203], v3, s[88:91], s22 offen
    s_add_u32 s22, s21, 139264
    buffer_load_dwordx4 v[204:207], v3, s[88:91], s22 offen
    s_add_u32 s22, s21, 16384
    buffer_load_dwordx4 v[208:211], v3, s[88:91], s22 offen
    s_add_u32 s22, s21, 24576
    buffer_load_dwordx4 v[212:215], v3, s[88:91], s22 offen
    s_add_u32 s22, s21, 147456
    buffer_load_dwordx4 v[216:219], v3, s[88:91], s22 offen
    s_add_u32 s22, s21, 155648
    buffer_load_dwordx4 v[220:223], v3, s[88:91], s22 offen
    s_waitcnt vmcnt(8)
    s_waitcnt lgkmcnt(0)
    v_perm_b32 v16, v164, v160, s28
    v_perm_b32 v17, v172, v168, s28
    v_perm_b32 v18, v180, v176, s28
    v_perm_b32 v19, v188, v184, s28
    ds_write_b128 v5, v[16:19] offset:3072
    v_perm_b32 v20, v164, v160, s29
    v_perm_b32 v21, v172, v168, s29
    v_perm_b32 v22, v180, v176, s29
    v_perm_b32 v23, v188, v184, s29
    ds_write_b128 v5, v[20:23] offset:19456
    v_perm_b32 v24, v165, v161, s28
    v_perm_b32 v25, v173, v169, s28
    v_perm_b32 v26, v181, v177, s28
    v_perm_b32 v27, v189, v185, s28
    ds_write_b128 v5, v[24:27] offset:35840
    v_perm_b32 v28, v165, v161, s29
    v_perm_b32 v29, v173, v169, s29
    v_perm_b32 v30, v181, v177, s29
    v_perm_b32 v31, v189, v185, s29
    ds_write_b128 v5, v[28:31] offset:52224
    v_perm_b32 v32, v166, v162, s28
    v_perm_b32 v33, v174, v170, s28
    v_perm_b32 v34, v182, v178, s28
    v_perm_b32 v35, v190, v186, s28
    ds_write_b128 v6, v[32:35] offset:3072
    v_perm_b32 v36, v166, v162, s29
    v_perm_b32 v37, v174, v170, s29
    v_perm_b32 v38, v182, v178, s29
    v_perm_b32 v39, v190, v186, s29
    ds_write_b128 v6, v[36:39] offset:19456
    v_perm_b32 v40, v167, v163, s28
    v_perm_b32 v41, v175, v171, s28
    v_perm_b32 v42, v183, v179, s28
    v_perm_b32 v43, v191, v187, s28
    ds_write_b128 v6, v[40:43] offset:35840
    v_perm_b32 v44, v167, v163, s29
    v_perm_b32 v45, v175, v171, s29
    v_perm_b32 v46, v183, v179, s29
    v_perm_b32 v47, v191, v187, s29
    ds_write_b128 v6, v[44:47] offset:52224
    s_add_u32 s22, s21, 524288
    buffer_load_dwordx4 v[224:227], v3, s[88:91], s22 offen
    s_add_u32 s22, s21, 532480
    buffer_load_dwordx4 v[228:231], v3, s[88:91], s22 offen
    s_add_u32 s22, s21, 655360
    buffer_load_dwordx4 v[232:235], v3, s[88:91], s22 offen
    s_add_u32 s22, s21, 663552
    buffer_load_dwordx4 v[236:239], v3, s[88:91], s22 offen
    s_add_u32 s22, s21, 540672
    buffer_load_dwordx4 v[240:243], v3, s[88:91], s22 offen
    s_add_u32 s22, s21, 548864
    buffer_load_dwordx4 v[244:247], v3, s[88:91], s22 offen
    s_add_u32 s22, s21, 671744
    buffer_load_dwordx4 v[248:251], v3, s[88:91], s22 offen
    s_add_u32 s22, s21, 679936
    buffer_load_dwordx4 v[252:255], v3, s[88:91], s22 offen
    s_waitcnt lgkmcnt(0)
    s_barrier
    s_cmp_lt_u32 s16, 2
    s_cbranch_scc1 L_rb_2
    ds_read_b128 a[0:3], v8 offset:0
    ds_read_b128 a[4:7], v8 offset:1024
    ds_read_b128 a[8:11], v8 offset:16384
    ds_read_b128 a[12:15], v8 offset:17408
    ds_read_b128 a[16:19], v8 offset:32768
    ds_read_b128 a[20:23], v8 offset:33792
    ds_read_b128 a[24:27], v8 offset:49152
    ds_read_b128 a[28:31], v8 offset:50176
    s_waitcnt lgkmcnt(6)
    ds_read_b128 a[32:35], v8 offset:2048
    ds_read_b128 a[36:39], v8 offset:3072
    ds_read_b128 a[40:43], v8 offset:18432
    ds_read_b128 a[44:47], v8 offset:19456
    ds_read_b128 a[48:51], v8 offset:34816
    ds_read_b128 a[52:55], v8 offset:35840
    ds_read_b128 a[56:59], v8 offset:51200
    ds_read_b128 a[60:63], v8 offset:52224
    s_waitcnt lgkmcnt(6)
    ds_read_b128 a[64:67], v9 offset:0
    ds_read_b128 a[68:71], v9 offset:1024
    ds_read_b128 a[72:75], v9 offset:16384
    ds_read_b128 a[76:79], v9 offset:17408
    ds_read_b128 a[80:83], v9 offset:32768
    ds_read_b128 a[84:87], v9 offset:33792
    ds_read_b128 a[88:91], v9 offset:49152
    ds_read_b128 a[92:95], v9 offset:50176
    s_waitcnt lgkmcnt(6)
    ds_read_b128 a[96:99], v9 offset:2048
    ds_read_b128 a[100:103], v9 offset:3072
    ds_read_b128 a[104:107], v9 offset:18432
    ds_read_b128 a[108:111], v9 offset:19456
    ds_read_b128 a[112:115], v9 offset:34816
    ds_read_b128 a[116:119], v9 offset:35840
    ds_read_b128 a[120:123], v9 offset:51200
    ds_read_b128 a[124:127], v9 offset:52224
    s_waitcnt lgkmcnt(6)
    ds_read_b128 a[128:131], v10 offset:0
    ds_read_b128 a[132:135], v10 offset:1024
    ds_read_b128 a[136:139], v10 offset:16384
    ds_read_b128 a[140:143], v10 offset:17408
    ds_read_b128 a[144:147], v10 offset:32768
    ds_read_b128 a[148:151], v10 offset:33792
    ds_read_b128 a[152:155], v10 offset:49152
    ds_read_b128 a[156:159], v10 offset:50176
    s_waitcnt lgkmcnt(6)
    ds_read_b128 a[160:163], v10 offset:2048
    ds_read_b128 a[164:167], v10 offset:3072
    ds_read_b128 a[168:171], v10 offset:18432
    ds_read_b128 a[172:175], v10 offset:19456
    ds_read_b128 a[176:179], v10 offset:34816
    ds_read_b128 a[180:183], v10 offset:35840
    ds_read_b128 a[184:187], v10 offset:51200
    ds_read_b128 a[188:191], v10 offset:52224
    s_waitcnt lgkmcnt(6)
    ds_read_b128 a[192:195], v11 offset:0
    ds_read_b128 a[196:199], v11 offset:1024
    ds_read_b128 a[200:203], v11 offset:16384
    ds_read_b128 a[204:207], v11 offset:17408
    ds_read_b128 a[208:211], v11 offset:32768
    ds_read_b128 a[212:215], v11 offset:33792
    ds_read_b128 a[216:219], v11 offset:49152
    ds_read_b128 a[220:223], v11 offset:50176
    s_waitcnt lgkmcnt(6)
    ds_read_b128 a[224:227], v11 offset:2048
    ds_read_b128 a[228:231], v11 offset:3072
    ds_read_b128 a[232:235], v11 offset:18432
    ds_read_b128 a[236:239], v11 offset:19456
    ds_read_b128 a[240:243], v11 offset:34816
    ds_read_b128 a[244:247], v11 offset:35840
    ds_read_b128 a[248:251], v11 offset:51200
    ds_read_b128 a[252:255], v11 offset:52224
    s_waitcnt lgkmcnt(6)
L_rb_2:
    s_waitcnt vmcnt(8)
    s_waitcnt lgkmcnt(0)
    s_barrier
    v_perm_b32 v16, v196, v192, s28
    v_perm_b32 v17, v204, v200, s28
    v_perm_b32 v18, v212, v208, s28
    v_perm_b32 v19, v220, v216, s28
    ds_write_b128 v12, v[16:19] offset:0
    v_perm_b32 v20, v196, v192, s29
    v_perm_b32 v21, v204, v200, s29
    v_perm_b32 v22, v212, v208, s29
    v_perm_b32 v23, v220, v216, s29
    ds_write_b128 v12, v[20:23] offset:8192
    v_perm_b32 v24, v197, v193, s28
    v_perm_b32 v25, v205, v201, s28
    v_perm_b32 v26, v213, v209, s28
    v_perm_b32 v27, v221, v217, s28
    ds_write_b128 v13, v[24:27] offset:0
    v_perm_b32 v28, v197, v193, s29
    v_perm_b32 v29, v205, v201, s29
    v_perm_b32 v30, v213, v209, s29
    v_perm_b32 v31, v221, v217, s29
    ds_write_b128 v13, v[28:31] offset:8192
    v_perm_b32 v32, v198, v194, s28
    v_perm_b32 v33, v206, v202, s28
    v_perm_b32 v34, v214, v210, s28
    v_perm_b32 v35, v222, v218, s28
    ds_write_b128 v14, v[32:35] offset:0
    v_perm_b32 v36, v198, v194, s29
    v_perm_b32 v37, v206, v202, s29
    v_perm_b32 v38, v214, v210, s29
    v_perm_b32 v39, v222, v218, s29
    ds_write_b128 v14, v[36:39] offset:8192
    v_perm_b32 v40, v199, v195, s28
    v_perm_b32 v41, v207, v203, s28
    v_perm_b32 v42, v215, v211, s28
    v_perm_b32 v43, v223, v219, s28
    ds_write_b128 v15, v[40:43] offset:0
    v_perm_b32 v44, v199, v195, s29
    v_perm_b32 v45, v207, v203, s29
    v_perm_b32 v46, v215, v211, s29
    v_perm_b32 v47, v223, v219, s29
    ds_write_b128 v15, v[44:47] offset:8192
    s_add_u32 s22, s21, 32768
    buffer_load_dwordx4 v[48:51], v3, s[88:91], s22 offen
    s_add_u32 s22, s21, 40960
    buffer_load_dwordx4 v[52:55], v3, s[88:91], s22 offen
    s_add_u32 s22, s21, 163840
    buffer_load_dwordx4 v[56:59], v3, s[88:91], s22 offen
    s_add_u32 s22, s21, 172032
    buffer_load_dwordx4 v[60:63], v3, s[88:91], s22 offen
    s_add_u32 s22, s21, 49152
    buffer_load_dwordx4 v[64:67], v3, s[88:91], s22 offen
    s_add_u32 s22, s21, 57344
    buffer_load_dwordx4 v[68:71], v3, s[88:91], s22 offen
    s_add_u32 s22, s21, 180224
    buffer_load_dwordx4 v[72:75], v3, s[88:91], s22 offen
    s_add_u32 s22, s21, 188416
    buffer_load_dwordx4 v[76:79], v3, s[88:91], s22 offen
    s_waitcnt vmcnt(8)
    s_waitcnt lgkmcnt(0)
    v_perm_b32 v16, v228, v224, s28
    v_perm_b32 v17, v236, v232, s28
    v_perm_b32 v18, v244, v240, s28
    v_perm_b32 v19, v252, v248, s28
    ds_write_b128 v12, v[16:19] offset:4096
    v_perm_b32 v20, v228, v224, s29
    v_perm_b32 v21, v236, v232, s29
    v_perm_b32 v22, v244, v240, s29
    v_perm_b32 v23, v252, v248, s29
    ds_write_b128 v12, v[20:23] offset:12288
    v_perm_b32 v24, v229, v225, s28
    v_perm_b32 v25, v237, v233, s28
    v_perm_b32 v26, v245, v241, s28
    v_perm_b32 v27, v253, v249, s28
    ds_write_b128 v13, v[24:27] offset:4096
    v_perm_b32 v28, v229, v225, s29
    v_perm_b32 v29, v237, v233, s29
    v_perm_b32 v30, v245, v241, s29
    v_perm_b32 v31, v253, v249, s29
    ds_write_b128 v13, v[28:31] offset:12288
    v_perm_b32 v32, v230, v226, s28
    v_perm_b32 v33, v238, v234, s28
    v_perm_b32 v34, v246, v242, s28
    v_perm_b32 v35, v254, v250, s28
    ds_write_b128 v14, v[32:35] offset:4096
    v_perm_b32 v36, v230, v226, s29
    v_perm_b32 v37, v238, v234, s29
    v_perm_b32 v38, v246, v242, s29
    v_perm_b32 v39, v254, v250, s29
    ds_write_b128 v14, v[36:39] offset:12288
    v_perm_b32 v40, v231, v227, s28
    v_perm_b32 v41, v239, v235, s28
    v_perm_b32 v42, v247, v243, s28
    v_perm_b32 v43, v255, v251, s28
    ds_write_b128 v15, v[40:43] offset:4096
    v_perm_b32 v44, v231, v227, s29
    v_perm_b32 v45, v239, v235, s29
    v_perm_b32 v46, v247, v243, s29
    v_perm_b32 v47, v255, v251, s29
    ds_write_b128 v15, v[44:47] offset:12288
    s_add_u32 s22, s21, 557056
    buffer_load_dwordx4 v[80:83], v3, s[88:91], s22 offen
    s_add_u32 s22, s21, 565248
    buffer_load_dwordx4 v[84:87], v3, s[88:91], s22 offen
    s_add_u32 s22, s21, 688128
    buffer_load_dwordx4 v[88:91], v3, s[88:91], s22 offen
    s_add_u32 s22, s21, 696320
    buffer_load_dwordx4 v[92:95], v3, s[88:91], s22 offen
    s_add_u32 s22, s21, 573440
    buffer_load_dwordx4 v[96:99], v3, s[88:91], s22 offen
    s_add_u32 s22, s21, 581632
    buffer_load_dwordx4 v[100:103], v3, s[88:91], s22 offen
    s_add_u32 s22, s21, 704512
    buffer_load_dwordx4 v[104:107], v3, s[88:91], s22 offen
    s_add_u32 s22, s21, 712704
    buffer_load_dwordx4 v[108:111], v3, s[88:91], s22 offen
    s_waitcnt vmcnt(8)
    s_waitcnt lgkmcnt(0)
    v_perm_b32 v16, v52, v48, s28
    v_perm_b32 v17, v60, v56, s28
    v_perm_b32 v18, v68, v64, s28
    v_perm_b32 v19, v76, v72, s28
    ds_write_b128 v12, v[16:19] offset:16384
    v_perm_b32 v20, v52, v48, s29
    v_perm_b32 v21, v60, v56, s29
    v_perm_b32 v22, v68, v64, s29
    v_perm_b32 v23, v76, v72, s29
    ds_write_b128 v12, v[20:23] offset:24576
    v_perm_b32 v24, v53, v49, s28
    v_perm_b32 v25, v61, v57, s28
    v_perm_b32 v26, v69, v65, s28
    v_perm_b32 v27, v77, v73, s28
    ds_write_b128 v13, v[24:27] offset:16384
    v_perm_b32 v28, v53, v49, s29
    v_perm_b32 v29, v61, v57, s29
    v_perm_b32 v30, v69, v65, s29
    v_perm_b32 v31, v77, v73, s29
    ds_write_b128 v13, v[28:31] offset:24576
    v_perm_b32 v32, v54, v50, s28
    v_perm_b32 v33, v62, v58, s28
    v_perm_b32 v34, v70, v66, s28
    v_perm_b32 v35, v78, v74, s28
    ds_write_b128 v14, v[32:35] offset:16384
    v_perm_b32 v36, v54, v50, s29
    v_perm_b32 v37, v62, v58, s29
    v_perm_b32 v38, v70, v66, s29
    v_perm_b32 v39, v78, v74, s29
    ds_write_b128 v14, v[36:39] offset:24576
    v_perm_b32 v40, v55, v51, s28
    v_perm_b32 v41, v63, v59, s28
    v_perm_b32 v42, v71, v67, s28
    v_perm_b32 v43, v79, v75, s28
    ds_write_b128 v15, v[40:43] offset:16384
    v_perm_b32 v44, v55, v51, s29
    v_perm_b32 v45, v63, v59, s29
    v_perm_b32 v46, v71, v67, s29
    v_perm_b32 v47, v79, v75, s29
    ds_write_b128 v15, v[44:47] offset:24576
    s_mov_b32 s22, 0
    buffer_load_dwordx4 v[128:131], v4, s[80:83], s22 offen
    s_mov_b32 s22, 8192
    buffer_load_dwordx4 v[132:135], v4, s[80:83], s22 offen
    s_mov_b32 s22, 32768
    buffer_load_dwordx4 v[136:139], v4, s[80:83], s22 offen
    s_mov_b32 s22, 40960
    buffer_load_dwordx4 v[140:143], v4, s[80:83], s22 offen
    s_mov_b32 s22, 16384
    buffer_load_dwordx4 v[144:147], v4, s[80:83], s22 offen
    s_mov_b32 s22, 24576
    buffer_load_dwordx4 v[148:151], v4, s[80:83], s22 offen
    s_mov_b32 s22, 49152
    buffer_load_dwordx4 v[152:155], v4, s[80:83], s22 offen
    s_mov_b32 s22, 57344
    buffer_load_dwordx4 v[156:159], v4, s[80:83], s22 offen
    s_waitcnt vmcnt(8)
    s_waitcnt lgkmcnt(0)
    v_perm_b32 v16, v84, v80, s28
    v_perm_b32 v17, v92, v88, s28
    v_perm_b32 v18, v100, v96, s28
    v_perm_b32 v19, v108, v104, s28
    ds_write_b128 v12, v[16:19] offset:20480
    v_perm_b32 v20, v84, v80, s29
    v_perm_b32 v21, v92, v88, s29
    v_perm_b32 v22, v100, v96, s29
    v_perm_b32 v23, v108, v104, s29
    ds_write_b128 v12, v[20:23] offset:28672
    v_perm_b32 v24, v85, v81, s28
    v_perm_b32 v25, v93, v89, s28
    v_perm_b32 v26, v101, v97, s28
    v_perm_b32 v27, v109, v105, s28
    ds_write_b128 v13, v[24:27] offset:20480
    v_perm_b32 v28, v85, v81, s29
    v_perm_b32 v29, v93, v89, s29
    v_perm_b32 v30, v101, v97, s29
    v_perm_b32 v31, v109, v105, s29
    ds_write_b128 v13, v[28:31] offset:28672
    v_perm_b32 v32, v86, v82, s28
    v_perm_b32 v33, v94, v90, s28
    v_perm_b32 v34, v102, v98, s28
    v_perm_b32 v35, v110, v106, s28
    ds_write_b128 v14, v[32:35] offset:20480
    v_perm_b32 v36, v86, v82, s29
    v_perm_b32 v37, v94, v90, s29
    v_perm_b32 v38, v102, v98, s29
    v_perm_b32 v39, v110, v106, s29
    ds_write_b128 v14, v[36:39] offset:28672
    v_perm_b32 v40, v87, v83, s28
    v_perm_b32 v41, v95, v91, s28
    v_perm_b32 v42, v103, v99, s28
    v_perm_b32 v43, v111, v107, s28
    ds_write_b128 v15, v[40:43] offset:20480
    v_perm_b32 v44, v87, v83, s29
    v_perm_b32 v45, v95, v91, s29
    v_perm_b32 v46, v103, v99, s29
    v_perm_b32 v47, v111, v107, s29
    ds_write_b128 v15, v[44:47] offset:28672
    v_mov_b32 v116, 0
    buffer_load_dwordx2 v[112:113], v116, s[12:15], 44 offen sc1
    s_mov_b32 s22, 2048
    buffer_load_dwordx4 v[160:163], v4, s[80:83], s22 offen
    s_mov_b32 s22, 10240
    buffer_load_dwordx4 v[164:167], v4, s[80:83], s22 offen
    s_mov_b32 s22, 34816
    buffer_load_dwordx4 v[168:171], v4, s[80:83], s22 offen
    s_mov_b32 s22, 43008
    buffer_load_dwordx4 v[172:175], v4, s[80:83], s22 offen
    s_mov_b32 s22, 18432
    buffer_load_dwordx4 v[176:179], v4, s[80:83], s22 offen
    s_mov_b32 s22, 26624
    buffer_load_dwordx4 v[180:183], v4, s[80:83], s22 offen
    s_mov_b32 s22, 51200
    buffer_load_dwordx4 v[184:187], v4, s[80:83], s22 offen
    s_mov_b32 s22, 59392
    buffer_load_dwordx4 v[188:191], v4, s[80:83], s22 offen
    s_waitcnt lgkmcnt(0)
    s_barrier
    s_waitcnt vmcnt(9)
    s_waitcnt lgkmcnt(0)
    v_perm_b32 v16, v132, v128, s28
    v_perm_b32 v17, v140, v136, s28
    v_perm_b32 v18, v148, v144, s28
    v_perm_b32 v19, v156, v152, s28
    v_perm_b32 v20, v132, v128, s29
    v_perm_b32 v21, v140, v136, s29
    v_perm_b32 v22, v148, v144, s29
    v_perm_b32 v23, v156, v152, s29
    v_perm_b32 v24, v133, v129, s28
    v_perm_b32 v25, v141, v137, s28
    v_perm_b32 v26, v149, v145, s28
    v_perm_b32 v27, v157, v153, s28
    v_perm_b32 v28, v133, v129, s29
    v_perm_b32 v29, v141, v137, s29
    v_perm_b32 v30, v149, v145, s29
    v_perm_b32 v31, v157, v153, s29
    v_perm_b32 v32, v134, v130, s28
    v_perm_b32 v33, v142, v138, s28
    v_perm_b32 v34, v150, v146, s28
    v_perm_b32 v35, v158, v154, s28
    v_perm_b32 v36, v134, v130, s29
    v_perm_b32 v37, v142, v138, s29
    v_perm_b32 v38, v150, v146, s29
    v_perm_b32 v39, v158, v154, s29
    v_perm_b32 v40, v135, v131, s28
    v_perm_b32 v41, v143, v139, s28
    v_perm_b32 v42, v151, v147, s28
    v_perm_b32 v43, v159, v155, s28
    v_perm_b32 v44, v135, v131, s29
    v_perm_b32 v45, v143, v139, s29
    v_perm_b32 v46, v151, v147, s29
    v_perm_b32 v47, v159, v155, s29
    ds_read_b128 v[128:131], v7 offset:0
    ds_read_b128 v[132:135], v7 offset:4096
    ds_read_b128 v[136:139], v7 offset:8192
    ds_read_b128 v[140:143], v7 offset:12288
    ds_read_b128 v[144:147], v7 offset:16384
    ds_read_b128 v[148:151], v7 offset:20480
    ds_read_b128 v[152:155], v7 offset:24576
    ds_read_b128 v[156:159], v7 offset:28672
    s_waitcnt lgkmcnt(0)
    ds_write_b128 v7, v[16:19] offset:0
    ds_write_b128 v7, v[20:23] offset:4096
    ds_write_b128 v7, v[24:27] offset:8192
    ds_write_b128 v7, v[28:31] offset:12288
    ds_write_b128 v7, v[32:35] offset:16384
    ds_write_b128 v7, v[36:39] offset:20480
    ds_write_b128 v7, v[40:43] offset:24576
    ds_write_b128 v7, v[44:47] offset:28672
    s_mov_b32 s22, 4096
    buffer_load_dwordx4 v[192:195], v4, s[80:83], s22 offen
    s_mov_b32 s22, 12288
    buffer_load_dwordx4 v[196:199], v4, s[80:83], s22 offen
    s_mov_b32 s22, 36864
    buffer_load_dwordx4 v[200:203], v4, s[80:83], s22 offen
    s_mov_b32 s22, 45056
    buffer_load_dwordx4 v[204:207], v4, s[80:83], s22 offen
    s_mov_b32 s22, 20480
    buffer_load_dwordx4 v[208:211], v4, s[80:83], s22 offen
    s_mov_b32 s22, 28672
    buffer_load_dwordx4 v[212:215], v4, s[80:83], s22 offen
    s_mov_b32 s22, 53248
    buffer_load_dwordx4 v[216:219], v4, s[80:83], s22 offen
    s_mov_b32 s22, 61440
    buffer_load_dwordx4 v[220:223], v4, s[80:83], s22 offen
    s_waitcnt vmcnt(8)
    s_waitcnt lgkmcnt(0)
    v_perm_b32 v16, v164, v160, s28
    v_perm_b32 v17, v172, v168, s28
    v_perm_b32 v18, v180, v176, s28
    v_perm_b32 v19, v188, v184, s28
    v_perm_b32 v20, v164, v160, s29
    v_perm_b32 v21, v172, v168, s29
    v_perm_b32 v22, v180, v176, s29
    v_perm_b32 v23, v188, v184, s29
    v_perm_b32 v24, v165, v161, s28
    v_perm_b32 v25, v173, v169, s28
    v_perm_b32 v26, v181, v177, s28
    v_perm_b32 v27, v189, v185, s28
    v_perm_b32 v28, v165, v161, s29
    v_perm_b32 v29, v173, v169, s29
    v_perm_b32 v30, v181, v177, s29
    v_perm_b32 v31, v189, v185, s29
    v_perm_b32 v32, v166, v162, s28
    v_perm_b32 v33, v174, v170, s28
    v_perm_b32 v34, v182, v178, s28
    v_perm_b32 v35, v190, v186, s28
    v_perm_b32 v36, v166, v162, s29
    v_perm_b32 v37, v174, v170, s29
    v_perm_b32 v38, v182, v178, s29
    v_perm_b32 v39, v190, v186, s29
    v_perm_b32 v40, v167, v163, s28
    v_perm_b32 v41, v175, v171, s28
    v_perm_b32 v42, v183, v179, s28
    v_perm_b32 v43, v191, v187, s28
    v_perm_b32 v44, v167, v163, s29
    v_perm_b32 v45, v175, v171, s29
    v_perm_b32 v46, v183, v179, s29
    v_perm_b32 v47, v191, v187, s29
    ds_read_b128 v[160:163], v7 offset:1024
    ds_read_b128 v[164:167], v7 offset:5120
    ds_read_b128 v[168:171], v7 offset:9216
    ds_read_b128 v[172:175], v7 offset:13312
    ds_read_b128 v[176:179], v7 offset:17408
    ds_read_b128 v[180:183], v7 offset:21504
    ds_read_b128 v[184:187], v7 offset:25600
    ds_read_b128 v[188:191], v7 offset:29696
    s_waitcnt lgkmcnt(0)
    ds_write_b128 v7, v[16:19] offset:1024
    ds_write_b128 v7, v[20:23] offset:5120
    ds_write_b128 v7, v[24:27] offset:9216
    ds_write_b128 v7, v[28:31] offset:13312
    ds_write_b128 v7, v[32:35] offset:17408
    ds_write_b128 v7, v[36:39] offset:21504
    ds_write_b128 v7, v[40:43] offset:25600
    ds_write_b128 v7, v[44:47] offset:29696
    s_mov_b32 s22, 6144
    buffer_load_dwordx4 v[224:227], v4, s[80:83], s22 offen
    s_mov_b32 s22, 14336
    buffer_load_dwordx4 v[228:231], v4, s[80:83], s22 offen
    s_mov_b32 s22, 38912
    buffer_load_dwordx4 v[232:235], v4, s[80:83], s22 offen
    s_mov_b32 s22, 47104
    buffer_load_dwordx4 v[236:239], v4, s[80:83], s22 offen
    s_mov_b32 s22, 22528
    buffer_load_dwordx4 v[240:243], v4, s[80:83], s22 offen
    s_mov_b32 s22, 30720
    buffer_load_dwordx4 v[244:247], v4, s[80:83], s22 offen
    s_mov_b32 s22, 55296
    buffer_load_dwordx4 v[248:251], v4, s[80:83], s22 offen
    s_mov_b32 s22, 63488
    buffer_load_dwordx4 v[252:255], v4, s[80:83], s22 offen
L_initw_3:
    v_readfirstlane_b32 s26, v113
    v_readfirstlane_b32 s20, v112
    s_and_b32 s19, s26, 0xffff
    s_add_u32 s19, s19, s20
    s_cmp_ge_u32 s19, 64
    s_cbranch_scc1 L_initd_4
    buffer_load_dwordx2 v[112:113], v116, s[12:15], 44 offen sc1
    s_add_u32 s71, s71, 1
    s_cmp_gt_u32 s71, 0x100000
    s_cbranch_scc1 L_team_fail
    s_waitcnt vmcnt(0)
    s_branch L_initw_3
L_initd_4:
    v_lshrrev_b32 v118, 2, v0
    buffer_load_dword v119, v118, s[8:11], s70 offen sc1
    s_lshl_b32 s20, s16, 11
    s_add_u32 s19, s32, s20
    buffer_load_dwordx4 v[120:123], v0, s[8:11], s19 offen sc1
    buffer_load_dwordx4 v[120:123], v0, s[8:11], s19 offen offset:1024 sc1
    s_add_u32 s19, s19, 262144
    buffer_load_dwordx4 v[120:123], v0, s[8:11], s19 offen sc1
    buffer_load_dwordx4 v[120:123], v0, s[8:11], s19 offen offset:1024 sc1
    s_add_u32 s19, s19, 262144
    buffer_load_dwordx4 v[120:123], v0, s[8:11], s19 offen sc1
    buffer_load_dwordx4 v[120:123], v0, s[8:11], s19 offen offset:1024 sc1
    s_add_u32 s19, s19, 262144
    s_lshl_b32 s19, s17, 10
    s_add_u32 s19, s19, 63700992
    buffer_load_dwordx4 v[120:123], v0, s[8:11], s19 offen sc1
    s_mov_b32 s4, s48
    s_and_b32 s5, s49, 0xffff
    s_mov_b32 s6, 0x2000
    s_mov_b32 s7, 0x20000
    buffer_load_dwordx4 v[120:123], v0, s[4:7], s20 offen
    buffer_load_dwordx4 v[120:123], v0, s[4:7], s20 offen offset:1024
    s_waitcnt vmcnt(18)
    s_waitcnt lgkmcnt(0)
    v_perm_b32 v16, v196, v192, s28
    v_perm_b32 v17, v204, v200, s28
    v_perm_b32 v18, v212, v208, s28
    v_perm_b32 v19, v220, v216, s28
    v_perm_b32 v20, v196, v192, s29
    v_perm_b32 v21, v204, v200, s29
    v_perm_b32 v22, v212, v208, s29
    v_perm_b32 v23, v220, v216, s29
    v_perm_b32 v24, v197, v193, s28
    v_perm_b32 v25, v205, v201, s28
    v_perm_b32 v26, v213, v209, s28
    v_perm_b32 v27, v221, v217, s28
    v_perm_b32 v28, v197, v193, s29
    v_perm_b32 v29, v205, v201, s29
    v_perm_b32 v30, v213, v209, s29
    v_perm_b32 v31, v221, v217, s29
    v_perm_b32 v32, v198, v194, s28
    v_perm_b32 v33, v206, v202, s28
    v_perm_b32 v34, v214, v210, s28
    v_perm_b32 v35, v222, v218, s28
    v_perm_b32 v36, v198, v194, s29
    v_perm_b32 v37, v206, v202, s29
    v_perm_b32 v38, v214, v210, s29
    v_perm_b32 v39, v222, v218, s29
    v_perm_b32 v40, v199, v195, s28
    v_perm_b32 v41, v207, v203, s28
    v_perm_b32 v42, v215, v211, s28
    v_perm_b32 v43, v223, v219, s28
    v_perm_b32 v44, v199, v195, s29
    v_perm_b32 v45, v207, v203, s29
    v_perm_b32 v46, v215, v211, s29
    v_perm_b32 v47, v223, v219, s29
    ds_read_b128 v[192:195], v7 offset:2048
    ds_read_b128 v[196:199], v7 offset:6144
    ds_read_b128 v[200:203], v7 offset:10240
    ds_read_b128 v[204:207], v7 offset:14336
    ds_read_b128 v[208:211], v7 offset:18432
    ds_read_b128 v[212:215], v7 offset:22528
    ds_read_b128 v[216:219], v7 offset:26624
    ds_read_b128 v[220:223], v7 offset:30720
    s_waitcnt lgkmcnt(0)
    ds_write_b128 v7, v[16:19] offset:2048
    ds_write_b128 v7, v[20:23] offset:6144
    ds_write_b128 v7, v[24:27] offset:10240
    ds_write_b128 v7, v[28:31] offset:14336
    ds_write_b128 v7, v[32:35] offset:18432
    ds_write_b128 v7, v[36:39] offset:22528
    ds_write_b128 v7, v[40:43] offset:26624
    ds_write_b128 v7, v[44:47] offset:30720
    s_waitcnt vmcnt(10)
    s_waitcnt lgkmcnt(0)
    v_perm_b32 v16, v228, v224, s28
    v_perm_b32 v17, v236, v232, s28
    v_perm_b32 v18, v244, v240, s28
    v_perm_b32 v19, v252, v248, s28
    v_perm_b32 v20, v228, v224, s29
    v_perm_b32 v21, v236, v232, s29
    v_perm_b32 v22, v244, v240, s29
    v_perm_b32 v23, v252, v248, s29
    v_perm_b32 v24, v229, v225, s28
    v_perm_b32 v25, v237, v233, s28
    v_perm_b32 v26, v245, v241, s28
    v_perm_b32 v27, v253, v249, s28
    v_perm_b32 v28, v229, v225, s29
    v_perm_b32 v29, v237, v233, s29
    v_perm_b32 v30, v245, v241, s29
    v_perm_b32 v31, v253, v249, s29
    v_perm_b32 v32, v230, v226, s28
    v_perm_b32 v33, v238, v234, s28
    v_perm_b32 v34, v246, v242, s28
    v_perm_b32 v35, v254, v250, s28
    v_perm_b32 v36, v230, v226, s29
    v_perm_b32 v37, v238, v234, s29
    v_perm_b32 v38, v246, v242, s29
    v_perm_b32 v39, v254, v250, s29
    v_perm_b32 v40, v231, v227, s28
    v_perm_b32 v41, v239, v235, s28
    v_perm_b32 v42, v247, v243, s28
    v_perm_b32 v43, v255, v251, s28
    v_perm_b32 v44, v231, v227, s29
    v_perm_b32 v45, v239, v235, s29
    v_perm_b32 v46, v247, v243, s29
    v_perm_b32 v47, v255, v251, s29
    ds_read_b128 v[224:227], v7 offset:3072
    ds_read_b128 v[228:231], v7 offset:7168
    ds_read_b128 v[232:235], v7 offset:11264
    ds_read_b128 v[236:239], v7 offset:15360
    ds_read_b128 v[240:243], v7 offset:19456
    ds_read_b128 v[244:247], v7 offset:23552
    ds_read_b128 v[248:251], v7 offset:27648
    ds_read_b128 v[252:255], v7 offset:31744
    s_waitcnt lgkmcnt(0)
    ds_write_b128 v7, v[16:19] offset:3072
    ds_write_b128 v7, v[20:23] offset:7168
    ds_write_b128 v7, v[24:27] offset:11264
    ds_write_b128 v7, v[28:31] offset:15360
    ds_write_b128 v7, v[32:35] offset:19456
    ds_write_b128 v7, v[36:39] offset:23552
    ds_write_b128 v7, v[40:43] offset:27648
    ds_write_b128 v7, v[44:47] offset:31744
    s_waitcnt lgkmcnt(0)
    s_waitcnt vmcnt(9)
L_flagw_5:
    v_cmp_ne_u32 s[66:67], 0, v119
    s_nop 0
    s_and_b32 s19, s66, 3
    s_cmp_eq_u32 s19, 3
    s_cbranch_scc1 L_flagd_6
    buffer_load_dword v119, v118, s[8:11], s70 offen sc1
    s_add_u32 s71, s71, 1
    s_cmp_gt_u32 s71, 0x100000
    s_cbranch_scc1 L_team_fail
    s_waitcnt vmcnt(0)
    s_branch L_flagw_5
L_flagd_6:
    s_lshl_b32 s19, s16, 12
    s_add_u32 m0, s19, 0
    s_lshl_b32 s30, s17, 14
    s_add_u32 s30, s30, s19
    s_add_u32 s30, s30, 0
    buffer_load_dwordx4 v0, s[8:11], s30 offen offset:0 sc1 lds
    buffer_load_dwordx4 v0, s[8:11], s30 offen offset:1024 sc1 lds
    buffer_load_dwordx4 v0, s[8:11], s30 offen offset:2048 sc1 lds
    buffer_load_dwordx4 v0, s[8:11], s30 offen offset:3072 sc1 lds
    s_add_u32 s30, s30, 524288
    v_lshrrev_b32 v20, 4, v0
    v_lshrrev_b32 v21, 4, v20
    v_and_b32 v20, 15, v20
    s_lshl_b32 s19, s16, 11
    v_add_u32 v1, s19, v0
    s_lshl_b32 s19, s16, 15
    s_add_u32 s19, s19, 32768
    v_add_u32 v2, s19, v0
    v_bfe_u32 v22, v20, 1, 1
    v_lshrrev_b32 v23, 2, v20
    v_and_b32 v24, 1, v20
    v_lshl_add_u32 v23, v23, 1, v24
    v_mov_b32 v24, 0xaaaa
    v_mul_u32_u24 v24, v24, v22
    v_add_u32 v3, 0x4444, v24
    v_add_u32 v25, 4, v20
    v_bfe_u32 v26, v25, 3, 1
    v_and_b32 v25, 7, v25
    v_lshl_add_u32 v25, v25, 1, v26
    v_mul_u32_u24 v5, 272, v25
    v_lshl_add_u32 v5, v21, 5, v5
    v_add_u32 v5, 24576, v5
    s_cmp_lt_u32 s16, 2
    s_cselect_b32 s19, 2, 0
    v_lshlrev_b32 v27, 2, v21
    v_add_u32 v27, s19, v27
    v_add_u32 v25, 4, v27
    v_bfe_u32 v26, v25, 3, 1
    v_and_b32 v25, 7, v25
    v_lshl_add_u32 v25, v25, 1, v26
    v_mul_u32_u24 v4, 272, v25
    s_and_b32 s19, s16, 1
    s_lshl_b32 s19, s19, 7
    s_add_u32 s20, s19, 24576
    v_lshl_add_u32 v4, v20, 3, v4
    v_add_u32 v4, s20, v4
    v_mul_u32_u24 v25, 288, v23
    v_lshl_add_u32 v7, v21, 4, v25
    v_lshl_add_u32 v7, v22, 7, v7
    v_add_u32 v7, 16384, v7
    v_xor_b32 v26, 1, v22
    v_mul_u32_u24 v26, 2320, v26
    v_add_u32 v25, v25, v26
    v_lshrrev_b32 v26, 1, v21
    v_lshl_add_u32 v25, v26, 4, v25
    v_and_b32 v26, 1, v21
    v_lshl_add_u32 v25, v26, 7, v25
    s_lshl_b32 s19, s16, 5
    s_add_u32 s19, s19, 16384
    v_add_u32 v6, s19, v25
    v_lshlrev_b32 v25, 14, v21
    v_lshrrev_b32 v26, 3, v20
    v_lshl_add_u32 v25, v26, 13, v25
    v_bfe_u32 v26, v20, 2, 1
    v_lshl_add_u32 v25, v26, 11, v25
    v_and_b32 v26, 3, v20
    v_lshl_add_u32 v25, v26, 4, v25
    s_lshl_b32 s19, s16, 16
    v_add_u32 v8, s19, v25
    v_lshlrev_b32 v25, 10, v23
    v_lshl_add_u32 v25, v21, 6, v25
    v_lshl_add_u32 v25, v22, 5, v25
    s_lshl_b32 s19, s16, 8
    v_add_u32 v40, s19, v25
    buffer_load_dwordx2 v[32:33], v40, s[4:7], 0 offen offset:0
    buffer_load_dwordx2 v[34:35], v40, s[4:7], 0 offen offset:16
    buffer_load_dwordx2 v[36:37], v40, s[4:7], 0 offen offset:8
    buffer_load_dwordx2 v[38:39], v40, s[4:7], 0 offen offset:24
    v_lshrrev_b32 v25, 1, v20
    v_lshlrev_b32 v25, 5, v25
    v_and_b32 v26, 1, v20
    v_lshl_add_u32 v25, v26, 3, v25
    v_lshrrev_b32 v26, 1, v21
    v_lshl_add_u32 v25, v26, 4, v25
    v_and_b32 v26, 1, v21
    v_lshl_add_u32 v25, v26, 2, v25
    s_lshr_b32 s19, s17, 3
    s_lshl_b32 s19, s19, 10
    s_lshr_b32 s20, s16, 1
    s_lshl_b32 s20, s20, 12
    s_add_u32 s19, s19, s20
    s_and_b32 s20, s17, 1
    s_lshl_b32 s20, s20, 9
    s_add_u32 s19, s19, s20
    s_and_b32 s20, s16, 1
    s_lshl_b32 s20, s20, 8
    s_add_u32 s19, s19, s20
    s_and_b32 s20, s17, 6
    s_lshl_b32 s20, s20, 5
    s_add_u32 s19, s19, s20
    v_add_u32 v25, s19, v25
    v_mov_b32 v26, 0x7f000000
    v_cmp_gt_u32 vcc, 4, v20
    s_nop 1
    v_cndmask_b32 v9, v26, v25, vcc
    v_accvgpr_read_b32 v64, a8
    v_accvgpr_read_b32 v65, a9
    v_accvgpr_read_b32 v66, a10
    v_accvgpr_read_b32 v67, a11
    v_accvgpr_read_b32 v68, a12
    v_accvgpr_read_b32 v69, a13
    v_accvgpr_read_b32 v70, a14
    v_accvgpr_read_b32 v71, a15
    v_accvgpr_read_b32 v72, a16
    v_accvgpr_read_b32 v73, a17
    v_accvgpr_read_b32 v74, a18
    v_accvgpr_read_b32 v75, a19
    v_accvgpr_read_b32 v76, a20
    v_accvgpr_read_b32 v77, a21
    v_accvgpr_read_b32 v78, a22
    v_accvgpr_read_b32 v79, a23
    v_accvgpr_read_b32 v80, a24
    v_accvgpr_read_b32 v81, a25
    v_accvgpr_read_b32 v82, a26
    v_accvgpr_read_b32 v83, a27
    v_accvgpr_read_b32 v84, a28
    v_accvgpr_read_b32 v85, a29
    v_accvgpr_read_b32 v86, a30
    v_accvgpr_read_b32 v87, a31
    s_nop 1
    ds_read_b128 a[8:11], v2 offset:28672
    ds_read_b128 a[12:15], v2 offset:29696
    ds_read_b128 a[16:19], v2 offset:26624
    ds_read_b128 a[20:23], v2 offset:27648
    ds_read_b128 a[24:27], v2 offset:30720
    ds_read_b128 a[28:31], v2 offset:31744
    s_waitcnt lgkmcnt(0)
    ds_write_b128 v2, v[64:67] offset:28672
    ds_write_b128 v2, v[68:71] offset:29696
    ds_write_b128 v2, v[72:75] offset:26624
    ds_write_b128 v2, v[76:79] offset:27648
    ds_write_b128 v2, v[80:83] offset:30720
    ds_write_b128 v2, v[84:87] offset:31744
    v_lshrrev_b32 v25, 2, v20
    v_lshl_add_u32 v25, v22, 2, v25
    v_and_b32 v24, 1, v20
    v_lshlrev_b32 v24, 4, v24
    v_mov_b32 v26, 0x3f80
    v_lshlrev_b32 v24, v24, v26
    v_cmp_eq_u32 vcc, 0, v25
    s_nop 1
    v_cndmask_b32 v28, 0, v24, vcc
    v_cmp_eq_u32 vcc, 1, v25
    s_nop 1
    v_cndmask_b32 v29, 0, v24, vcc
    v_cmp_eq_u32 vcc, 2, v25
    s_nop 1
    v_cndmask_b32 v30, 0, v24, vcc
    v_cmp_eq_u32 vcc, 3, v25
    s_nop 1
    v_cndmask_b32 v31, 0, v24, vcc
    ds_write_b128 v0, v[28:31] offset:28928
    s_mov_b32 s68, 0x3e0293ee
    s_mov_b32 s69, 0x3e0293ee
    s_mov_b32 s18, 0
    s_mov_b32 s24, 0xcccccccc
    s_mov_b32 s25, 0xcccccccc
    s_mov_b32 s33, 0
    s_mov_b32 s75, 0
    s_mov_b32 s98, 0x3f803f80
    s_mov_b32 s99, 0x3f803f80
    s_mov_b32 s100, 0x7f817f81
    s_mov_b32 s101, 0x7f817f81
    s_lshl_b32 s31, s17, 6
    s_add_u32 s31, s31, 62914560
    s_mov_b32 s35, 63709184
    s_mov_b32 s36, 63717376
    s_mov_b32 s37, 0x7f000000
    s_waitcnt vmcnt(0) lgkmcnt(0)
    s_barrier
    s_mov_b32 s75, 0
    s_cmp_gt_u32 s26, 0xffff
    s_cbranch_scc1 L_slow_pre
L_fast_pre:
    ds_read_b128 v[20:23], v0 offset:28928
    ds_read_b128 v[40:43], v2 offset:28672
    ds_read_b128 v[44:47], v2 offset:29696
    ds_read_b128 v[48:51], v2 offset:26624
    ds_read_b128 v[52:55], v2 offset:27648
    ds_read_b128 v[56:59], v2 offset:30720
    ds_read_b128 v[60:63], v2 offset:31744
    v_mov_b64 v[80:81], 0
    v_mov_b64 v[82:83], 0
    v_mov_b64 v[84:85], 0
    v_mov_b64 v[86:87], 0
    v_xor_b32 v28, 2048, v1
    v_xor_b32 v29, 4096, v1
    v_xor_b32 v30, 6144, v1
    v_mfma_f32_16x16x1_4b_f32 v[64:79], v80, v80, 0
    v_lshrrev_b32 v11, 2, v0
    s_waitcnt lgkmcnt(0)
    ds_read_b128 v[96:99], v0 offset:0
    ds_read_b128 v[100:103], v0 offset:1024
    ds_read_b128 v[104:107], v0 offset:2048
    ds_read_b128 v[108:111], v0 offset:3072
    ds_read_b128 v[112:115], v0 offset:4096
    ds_read_b128 v[116:119], v0 offset:5120
    ds_read_b128 v[120:123], v0 offset:6144
    ds_read_b128 v[124:127], v0 offset:7168
    ds_read_b128 v[88:91], v1 offset:8192
    ds_read_b128 v[92:95], v1 offset:9216
    v_mov_b64 v[20:21], s[100:101]
    v_mov_b64 v[22:23], s[100:101]
    s_nop 15
    ds_write_b128 v1, v[32:35] offset:16384
    s_branch L_fast_top0
    .p2align 6
L_fast_early:
    buffer_load_dwordx4 v[12:15], v1, s[8:11], s32 offen sc1
    buffer_load_dwordx4 v[16:19], v1, s[8:11], s32 offen offset:1024 sc1
    ds_read_b128 v[20:23], v0 offset:28928
    ds_read_b128 v[40:43], v2 offset:28672
    ds_read_b128 v[44:47], v2 offset:29696
    ds_read_b128 v[48:51], v2 offset:26624
    ds_read_b128 v[52:55], v2 offset:27648
    ds_read_b128 v[56:59], v2 offset:30720
    ds_read_b128 v[60:63], v2 offset:31744
    s_waitcnt vmcnt(6)
    s_barrier
    s_add_u32 s18, s18, 1
    s_lshl_b32 s37, s18, 13
    s_add_u32 s37, s37, 50331648
    s_add_u32 s20, s18, 1
    s_cmp_lt_u32 s20, 64
    s_cselect_b32 s19, 524288, 0
    s_cselect_b32 s23, s20, 63
    s_add_u32 s30, s30, s19
    s_mov_b32 s22, s35
    s_lshl_b32 s20, s16, 10
    s_add_u32 s33, s22, s20
    s_add_u32 s75, s33, 4096
    s_mov_b32 s35, s36
    s_add_u32 s36, s36, 8192
    s_and_b32 s36, s36, 0xffff7fff
    s_mov_b32 s39, 0
    s_waitcnt lgkmcnt(0)
    ds_read_b128 v[96:99], v0 offset:0
    ds_read_b128 v[100:103], v0 offset:1024
    ds_read_b128 v[104:107], v0 offset:2048
    ds_read_b128 v[108:111], v0 offset:3072
    ds_read_b128 v[112:115], v0 offset:4096
    ds_read_b128 v[116:119], v0 offset:5120
    ds_read_b128 v[120:123], v0 offset:6144
    ds_read_b128 v[124:127], v0 offset:7168
    ds_read_b128 v[88:91], v1 offset:8192
    ds_read_b128 v[92:95], v1 offset:9216
    s_waitcnt vmcnt(1)
    v_mfma_f32_16x16x32_bf16 v[24:27], v[20:23], v[12:15], 0
    s_waitcnt vmcnt(0)
    v_mfma_f32_16x16x32_bf16 v[24:27], v[20:23], v[16:19], v[24:27]
    s_nop 7
    v_cmp_u_f32 vcc, v24, v25
    v_add_f32_dpp v24, v24, v24 row_ror:4 row_mask:0xf bank_mask:0xf
    v_add_f32_dpp v25, v25, v25 row_ror:4 row_mask:0xf bank_mask:0xf
    s_cbranch_vccnz L_fast_er
L_fast_eok:
    v_add_f32_dpp v24, v24, v24 row_ror:8 row_mask:0xf bank_mask:0xf
    v_add_f32_dpp v25, v25, v25 row_ror:8 row_mask:0xf bank_mask:0xf
    v_cvt_pk_bf16_f32 v31, v24, v25
    buffer_store_dword v31, v9, s[8:11], s22 offen
    s_mov_b32 s39, 0
    v_mov_b64 v[20:21], s[100:101]
    v_mov_b64 v[22:23], s[100:101]
    s_cmp_eq_u32 s18, 63
    s_cbranch_scc1 L_fast_exit
    v_cmp_ne_u32 s[66:67], 0, v10
    s_mov_b32 s34, s32
    s_mov_b32 s19, 262144
    s_cmp_ge_u32 s31, 63438848
    s_cselect_b32 s19, 0xfff80000, s19
    s_add_u32 s31, s31, s19
    s_add_u32 s32, s32, s19
    s_bitcmp0_b64 s[66:67], s23
    s_cbranch_scc1 L_fast_ekv
L_fast_ekvok:
    s_nop 3
    buffer_load_dwordx4 v[32:35], v0, s[8:11], s33 offen sc1
    s_nop 15
    s_nop 1
L_fast_h2j:
    buffer_load_dwordx4 v[32:35], v0, s[8:11], s33 offen sc1
    s_nop 15
    s_nop 1
    buffer_load_dwordx4 v[32:35], v0, s[8:11], s33 offen sc1
    s_nop 15
    s_nop 1
    buffer_load_dwordx4 v[32:35], v0, s[8:11], s33 offen sc1
L_fast_h2w:
    s_waitcnt vmcnt(3)
L_fast_h2c:
    v_maximum3_f32 v24, v32, v33, v34
    v_cmp_u_f32 vcc, v24, v35
    ds_write_b128 v1, v[32:35] offset:16384
    s_cbranch_vccnz L_fast_h2l
L_fast_h2ok:
L_fast_top:
    buffer_load_dwordx4 v[36:39], v0, s[8:11], s75 offen sc1
L_fast_top0:
    v_smfmac_f32_16x16x64_bf16 v[68:71], v[32:35], v[40:47], v3
    v_smfmac_f32_16x16x64_bf16 v[72:75], v[32:35], v[48:55], v3
    v_smfmac_f32_16x16x64_bf16 v[76:79], v[32:35], v[56:63], v3
    s_waitcnt lgkmcnt(0)
    s_barrier
    ds_read_b128 v[40:43], v28 offset:16384
    v_smfmac_f32_16x16x64_bf16 v[64:67], v[32:35], a[0:7], v3
    ds_read_b128 v[48:51], v29 offset:16384
    v_smfmac_f32_16x16x64_bf16 v[80:83], v[32:35], v[128:135], v3
    ds_read_b128 v[56:59], v30 offset:16384
    v_smfmac_f32_16x16x64_bf16 v[84:87], v[32:35], v[136:143], v3
    s_waitcnt lgkmcnt(2)
    v_smfmac_f32_16x16x64_bf16 v[64:67], v[40:43], a[64:71], v3
    v_smfmac_f32_16x16x64_bf16 v[68:71], v[40:43], a[72:79], v3
    v_smfmac_f32_16x16x64_bf16 v[72:75], v[40:43], a[80:87], v3
    v_smfmac_f32_16x16x64_bf16 v[76:79], v[40:43], a[88:95], v3
    s_waitcnt lgkmcnt(1)
    v_smfmac_f32_16x16x64_bf16 v[64:67], v[48:51], a[128:135], v3
    v_smfmac_f32_16x16x64_bf16 v[68:71], v[48:51], a[136:143], v3
    v_smfmac_f32_16x16x64_bf16 v[72:75], v[48:51], a[144:151], v3
    s_waitcnt lgkmcnt(0)
    v_smfmac_f32_16x16x64_bf16 v[76:79], v[48:51], a[152:159], v3
    v_smfmac_f32_16x16x64_bf16 v[64:67], v[56:59], a[192:199], v3
    s_waitcnt vmcnt(0)
    ds_write_b128 v1, v[36:39] offset:17408
    v_smfmac_f32_16x16x64_bf16 v[68:71], v[56:59], a[200:207], v3
    v_maximum3_f32 v24, v36, v37, v38
    v_smfmac_f32_16x16x64_bf16 v[72:75], v[56:59], a[208:215], v3
    v_cmp_u_f32 vcc, v24, v39
    v_smfmac_f32_16x16x64_bf16 v[76:79], v[56:59], a[216:223], v3
    s_cbranch_vccnz L_fast_Lr
L_fast_Lok:
    v_smfmac_f32_16x16x64_bf16 v[80:83], v[40:43], v[160:167], v3
    v_smfmac_f32_16x16x64_bf16 v[84:87], v[40:43], v[168:175], v3
    s_waitcnt lgkmcnt(0)
    s_barrier
    ds_read_b128 v[44:47], v28 offset:17408
    v_smfmac_f32_16x16x64_bf16 v[64:67], v[36:39], a[32:39], v3
    ds_read_b128 v[52:55], v29 offset:17408
    v_smfmac_f32_16x16x64_bf16 v[68:71], v[36:39], a[40:47], v3
    ds_read_b128 v[60:63], v30 offset:17408
    v_smfmac_f32_16x16x64_bf16 v[72:75], v[36:39], a[48:55], v3
    buffer_load_dwordx4 v0, s[8:11], s30 offen offset:0 sc1 lds
    v_smfmac_f32_16x16x64_bf16 v[76:79], v[36:39], a[56:63], v3
    s_waitcnt lgkmcnt(2)
    v_smfmac_f32_16x16x64_bf16 v[64:67], v[44:47], a[96:103], v3
    buffer_store_dword v20, v1, s[8:11], s34 offen
    v_smfmac_f32_16x16x64_bf16 v[68:71], v[44:47], a[104:111], v3
    s_waitcnt lgkmcnt(0)
    v_smfmac_f32_16x16x64_bf16 v[64:67], v[52:55], a[160:167], v3
    buffer_load_dwordx4 v0, s[8:11], s30 offen offset:1024 sc1 lds
    v_smfmac_f32_16x16x64_bf16 v[68:71], v[52:55], a[168:175], v3
    buffer_store_dword v31, v9, s[8:11], s37 offen sc1
    v_smfmac_f32_16x16x64_bf16 v[64:67], v[60:63], a[224:231], v3
    v_smfmac_f32_16x16x64_bf16 v[68:71], v[60:63], a[232:239], v3
    buffer_load_dwordx4 v0, s[8:11], s30 offen offset:2048 sc1 lds
    v_smfmac_f32_16x16x64_bf16 v[72:75], v[44:47], a[112:119], v3
    v_add_f32 v64, v64, v66
    v_smfmac_f32_16x16x64_bf16 v[76:79], v[44:47], a[120:127], v3
    v_add_f32 v65, v65, v67
    v_smfmac_f32_16x16x64_bf16 v[72:75], v[52:55], a[176:183], v3
    v_add_f32 v68, v68, v70
    v_smfmac_f32_16x16x64_bf16 v[76:79], v[52:55], a[184:191], v3
    v_add_f32 v69, v69, v71
    v_smfmac_f32_16x16x64_bf16 v[72:75], v[60:63], a[240:247], v3
    v_cvt_pk_bf16_f32 v24, v64, v68
    v_smfmac_f32_16x16x64_bf16 v[76:79], v[60:63], a[248:255], v3
    v_cvt_pk_bf16_f32 v26, v65, v69
    v_smfmac_f32_16x16x64_bf16 v[80:83], v[48:51], v[192:199], v3
    v_add_f32 v72, v72, v74
    v_add_f32 v73, v73, v75
    v_smfmac_f32_16x16x64_bf16 v[84:87], v[48:51], v[200:207], v3
    v_add_f32 v76, v76, v78
    v_add_f32 v77, v77, v79
    v_cvt_pk_bf16_f32 v25, v72, v76
    v_smfmac_f32_16x16x64_bf16 v[80:83], v[56:59], v[224:231], v3
    ds_write_b64 v4, v[24:25]
    v_cvt_pk_bf16_f32 v27, v73, v77
    ds_write_b64 v4, v[26:27] offset:544
    v_smfmac_f32_16x16x64_bf16 v[84:87], v[56:59], v[232:239], v3
    v_smfmac_f32_16x16x64_bf16 v[80:83], v[36:39], v[144:151], v3
    buffer_load_dwordx4 v0, s[8:11], s30 offen offset:3072 sc1 lds
    v_smfmac_f32_16x16x64_bf16 v[84:87], v[36:39], v[152:159], v3
    v_smfmac_f32_16x16x64_bf16 v[80:83], v[44:47], v[176:183], v3
    s_waitcnt vmcnt(6) lgkmcnt(0)
    s_barrier
    ds_read_b128 v[64:67], v5 offset:0
    ds_read_b128 v[68:71], v5 offset:16
    v_smfmac_f32_16x16x64_bf16 v[84:87], v[44:47], v[184:191], v3
    ds_read_b128 v[72:75], v5 offset:128
    v_smfmac_f32_16x16x64_bf16 v[80:83], v[52:55], v[208:215], v3
    ds_read_b128 v[76:79], v5 offset:144
    v_smfmac_f32_16x16x64_bf16 v[84:87], v[52:55], v[216:223], v3
    buffer_load_dword v10, v11, s[8:11], s70 offen sc1
    v_smfmac_f32_16x16x64_bf16 v[80:83], v[60:63], v[240:247], v3
    buffer_store_dword v20, v1, s[8:11], s34 offen offset:1024
    v_smfmac_f32_16x16x64_bf16 v[84:87], v[60:63], v[248:255], v3
    s_waitcnt lgkmcnt(0)
    v_mfma_f32_16x16x32_bf16 v[20:23], v[96:99], v[64:67], 0
    ds_read_b128 v[32:35], v2 offset:0
    v_mfma_f32_16x16x32_bf16 v[24:27], v[112:115], v[64:67], 0
    ds_read_b128 v[36:39], v2 offset:1024
    v_mfma_f32_16x16x32_bf16 v[28:31], v[64:67], v[64:67], 0
    ds_read_b128 v[40:43], v2 offset:4096
    v_add_f32 v80, v80, v82
    v_mfma_f32_16x16x32_bf16 v[20:23], v[100:103], v[68:71], v[20:23]
    ds_read_b128 v[44:47], v2 offset:5120
    v_add_f32 v81, v81, v83
    v_mfma_f32_16x16x32_bf16 v[24:27], v[116:119], v[68:71], v[24:27]
    ds_read_b128 v[48:51], v2 offset:2048
    v_add_f32 v84, v84, v86
    v_mfma_f32_16x16x32_bf16 v[28:31], v[68:71], v[68:71], v[28:31]
    ds_read_b128 v[52:55], v2 offset:3072
    v_add_f32 v85, v85, v87
    v_mfma_f32_16x16x32_bf16 v[20:23], v[104:107], v[72:75], v[20:23]
    ds_read_b128 v[56:59], v2 offset:6144
    v_mov_b32 v17, 0
    v_mfma_f32_16x16x32_bf16 v[24:27], v[120:123], v[72:75], v[24:27]
    ds_read_b128 v[60:63], v2 offset:7168
    v_cvt_pk_bf16_f32 v12, v80, v81
    v_mfma_f32_16x16x32_bf16 v[28:31], v[72:75], v[72:75], v[28:31]
    v_cvt_pk_bf16_f32 v14, v84, v85
    v_mov_b32 v13, 0
    v_mfma_f32_16x16x32_bf16 v[20:23], v[108:111], v[76:79], v[20:23]
    v_mov_b32 v15, 0
    v_mfma_f32_16x16x32_bf16 v[24:27], v[124:127], v[76:79], v[24:27]
    v_mfma_f32_16x16x32_bf16 v[28:31], v[76:79], v[76:79], v[28:31]
    s_nop 3
    v_max3_f32 v11, v20, v21, v22
    v_max3_f32 v11, v11, v23, v24
    v_max3_f32 v16, v25, v26, v27
    v_max_f32 v11, v11, v16
    v_max3_f32 v16, v11, v28, v29
    v_max3_f32 v11, v11, v28, v29
    ds_read_b128 v[72:75], v2 offset:8192
    ds_read_b128 v[76:79], v2 offset:9216
    v_permlane32_swap_b32 v16, v11
    v_max_f32 v11, v11, v16
    v_max_f32 v16, v11, v16
    v_mov_b64 v[68:69], s[98:99]
    v_mov_b64 v[70:71], s[98:99]
    v_permlane16_swap_b32 v16, v11
    v_max_f32 v11, v11, v16
    v_mul_f32 v30, s68, v11
    v_pk_fma_f32 v[28:29], v[28:29], s[68:69], v[30:31] op_sel_hi:[1,1,0] neg_lo:[0,0,1] neg_hi:[0,0,1]
    v_pk_fma_f32 v[20:21], v[20:21], s[68:69], v[30:31] op_sel_hi:[1,1,0] neg_lo:[0,0,1] neg_hi:[0,0,1]
    v_pk_fma_f32 v[22:23], v[22:23], s[68:69], v[30:31] op_sel_hi:[1,1,0] neg_lo:[0,0,1] neg_hi:[0,0,1]
    v_pk_fma_f32 v[24:25], v[24:25], s[68:69], v[30:31] op_sel_hi:[1,1,0] neg_lo:[0,0,1] neg_hi:[0,0,1]
    v_pk_fma_f32 v[26:27], v[26:27], s[68:69], v[30:31] op_sel_hi:[1,1,0] neg_lo:[0,0,1] neg_hi:[0,0,1]
    v_exp_f32 v28, v28
    v_exp_f32 v29, v29
    v_exp_f32 v20, v20
    v_cvt_pk_bf16_f32 v16, v28, v29
    v_exp_f32 v21, v21
    v_exp_f32 v22, v22
    v_mfma_f32_16x16x16_bf16 v[64:67], v[68:69], v[16:17], 0
    v_exp_f32 v23, v23
    v_cvt_pk_bf16_f32 v28, v20, v21
    v_mfma_f32_16x16x16_bf16 v[80:83], v[12:13], v[16:17], 0
    v_exp_f32 v24, v24
    v_cvt_pk_bf16_f32 v29, v22, v23
    v_mfma_f32_16x16x16_bf16 v[84:87], v[14:15], v[16:17], 0
    v_exp_f32 v25, v25
    v_exp_f32 v26, v26
    v_exp_f32 v27, v27
    v_cvt_pk_bf16_f32 v30, v24, v25
    v_cvt_pk_bf16_f32 v31, v26, v27
    ds_read_b128 v[20:23], v2 offset:12288
    ds_read_b128 v[24:27], v2 offset:13312
    v_mfma_f32_16x16x32_bf16 v[64:67], v[68:71], v[28:31], v[64:67]
    ds_read_b128 v[12:15], v2 offset:16384
    v_mov_b32 v11, 0
    v_mfma_f32_16x16x32_bf16 v[80:83], v[88:91], v[28:31], v[80:83]
    ds_read_b128 v[16:19], v2 offset:17408
    v_mfma_f32_16x16x32_bf16 v[84:87], v[92:95], v[28:31], v[84:87]
    v_rcp_f32 v64, v64
    s_add_u32 s19, s31, 4096
    v_pk_mul_f32 v[80:81], v[80:81], v[64:65] op_sel_hi:[1,0]
    v_pk_mul_f32 v[82:83], v[82:83], v[64:65] op_sel_hi:[1,0]
    v_cvt_pk_bf16_f32 v28, v80, v81
    v_cvt_pk_bf16_f32 v29, v82, v83
    v_pk_mul_f32 v[84:85], v[84:85], v[64:65] op_sel_hi:[1,0]
    v_pk_mul_f32 v[86:87], v[86:87], v[64:65] op_sel_hi:[1,0]
    v_cvt_pk_bf16_f32 v30, v84, v85
    v_cvt_pk_bf16_f32 v31, v86, v87
    ds_write_b128 v6, v[28:31]
    v_mfma_f32_32x32x1_2b_f32 v[96:127], v11, v11, 0
    ds_read_b128 v[64:67], v2 offset:10240
    ds_read_b128 v[68:71], v2 offset:11264
    s_waitcnt lgkmcnt(2)
    s_barrier
    ds_read_b128 v[88:91], v7
    ds_read_b128 v[92:95], v7 offset:64
    ds_read_b128 v[80:83], v2 offset:14336
    ds_read_b128 v[84:87], v2 offset:15360
    s_cmp_lt_u32 s16, 2
    s_waitcnt lgkmcnt(3)
    v_smfmac_f32_16x16x64_bf16 v[96:99], v[88:91], v[32:39], v3
    ds_read_b128 v[32:35], v2 offset:20480
    v_smfmac_f32_16x16x64_bf16 v[100:103], v[88:91], v[40:47], v3
    ds_read_b128 v[36:39], v2 offset:21504
    s_waitcnt lgkmcnt(4)
    v_smfmac_f32_16x16x64_bf16 v[96:99], v[92:95], v[48:55], v3
    ds_read_b128 v[40:43], v2 offset:18432
    v_smfmac_f32_16x16x64_bf16 v[100:103], v[92:95], v[56:63], v3
    ds_read_b128 v[44:47], v2 offset:19456
    v_smfmac_f32_16x16x64_bf16 v[104:107], v[88:91], v[72:79], v3
    ds_read_b128 v[48:51], v2 offset:22528
    v_smfmac_f32_16x16x64_bf16 v[108:111], v[88:91], v[20:27], v3
    ds_read_b128 v[52:55], v2 offset:23552
    s_waitcnt lgkmcnt(6)
    v_add_f32 v96, v96, v98
    v_smfmac_f32_16x16x64_bf16 v[104:107], v[92:95], v[64:71], v3
    ds_read_b128 v[56:59], v2 offset:24576
    v_add_f32 v97, v97, v99
    v_smfmac_f32_16x16x64_bf16 v[108:111], v[92:95], v[80:87], v3
    ds_read_b128 v[60:63], v2 offset:25600
    v_add_f32 v100, v100, v102
    v_add_f32 v101, v101, v103
    v_smfmac_f32_16x16x64_bf16 v[112:115], v[88:91], v[12:19], v3
    v_cvt_pk_bf16_f32 v28, v96, v100
    v_cvt_pk_bf16_f32 v30, v97, v101
    s_waitcnt lgkmcnt(4)
    v_smfmac_f32_16x16x64_bf16 v[116:119], v[88:91], v[32:39], v3
    v_add_f32 v104, v104, v106
    v_add_f32 v105, v105, v107
    v_add_f32 v108, v108, v110
    v_smfmac_f32_16x16x64_bf16 v[112:115], v[92:95], v[40:47], v3
    v_add_f32 v109, v109, v111
    v_cvt_pk_bf16_f32 v29, v104, v108
    v_cvt_pk_bf16_f32 v31, v105, v109
    buffer_store_dwordx4 v[28:31], v8, s[8:11], s31 offen
    s_waitcnt lgkmcnt(0)
    v_smfmac_f32_16x16x64_bf16 v[116:119], v[92:95], v[48:55], v3
    v_smfmac_f32_16x16x64_bf16 v[120:123], v[88:91], v[56:63], v3
    v_add_f32 v112, v112, v114
    v_smfmac_f32_16x16x64_bf16 v[124:127], v[88:91], a[8:15], v3
    v_add_f32 v113, v113, v115
    v_smfmac_f32_16x16x64_bf16 v[120:123], v[92:95], a[16:23], v3
    v_add_f32 v116, v116, v118
    v_smfmac_f32_16x16x64_bf16 v[124:127], v[92:95], a[24:31], v3
    v_add_f32 v117, v117, v119
    v_cvt_pk_bf16_f32 v96, v112, v116
    v_cvt_pk_bf16_f32 v98, v113, v117
    v_pk_add_f32 v[120:121], v[120:121], v[122:123]
    s_nop 1
    v_pk_add_f32 v[124:125], v[124:125], v[126:127]
    v_cvt_pk_bf16_f32 v97, v120, v124
    v_cvt_pk_bf16_f32 v99, v121, v125
    buffer_store_dwordx4 v[96:99], v8, s[8:11], s19 offen
    v_mov_b32 v24, s100
    buffer_store_dword v24, v9, s[8:11], s36 offen
    v_mov_b64 v[80:81], 0
    v_mov_b64 v[82:83], 0
    v_mov_b64 v[84:85], 0
    v_mov_b64 v[86:87], 0
    v_xor_b32 v28, 2048, v1
    v_xor_b32 v29, 4096, v1
    v_xor_b32 v30, 6144, v1
    v_mfma_f32_16x16x1_4b_f32 v[64:79], v80, v80, 0
    v_lshrrev_b32 v11, 2, v0
    s_cbranch_scc1 L_fast_early
    ds_read_b128 v[20:23], v0 offset:28928
    ds_read_b128 v[40:43], v2 offset:28672
    ds_read_b128 v[44:47], v2 offset:29696
    ds_read_b128 v[48:51], v2 offset:26624
    ds_read_b128 v[52:55], v2 offset:27648
    ds_read_b128 v[56:59], v2 offset:30720
    ds_read_b128 v[60:63], v2 offset:31744
    s_waitcnt vmcnt(4)
    s_barrier
    s_add_u32 s18, s18, 1
    s_lshl_b32 s37, s18, 13
    s_add_u32 s37, s37, 50331648
    s_add_u32 s20, s18, 1
    s_cmp_lt_u32 s20, 64
    s_cselect_b32 s19, 524288, 0
    s_cselect_b32 s23, s20, 63
    s_add_u32 s30, s30, s19
    s_mov_b32 s22, s35
    s_lshl_b32 s20, s16, 10
    s_add_u32 s33, s22, s20
    s_add_u32 s75, s33, 4096
    s_mov_b32 s35, s36
    s_add_u32 s36, s36, 8192
    s_and_b32 s36, s36, 0xffff7fff
    s_nop 11
    buffer_load_dwordx4 v[12:15], v1, s[8:11], s32 offen sc1
    buffer_load_dwordx4 v[16:19], v1, s[8:11], s32 offen offset:1024 sc1
    s_waitcnt lgkmcnt(0)
    ds_read_b128 v[96:99], v0 offset:0
    ds_read_b128 v[100:103], v0 offset:1024
    ds_read_b128 v[104:107], v0 offset:2048
    ds_read_b128 v[108:111], v0 offset:3072
    ds_read_b128 v[112:115], v0 offset:4096
    ds_read_b128 v[116:119], v0 offset:5120
    ds_read_b128 v[120:123], v0 offset:6144
    ds_read_b128 v[124:127], v0 offset:7168
    ds_read_b128 v[88:91], v1 offset:8192
    ds_read_b128 v[92:95], v1 offset:9216
    s_mov_b32 s39, 0
    s_waitcnt vmcnt(1)
    v_mfma_f32_16x16x32_bf16 v[24:27], v[20:23], v[12:15], 0
    s_waitcnt vmcnt(0)
    v_mfma_f32_16x16x32_bf16 v[24:27], v[20:23], v[16:19], v[24:27]
    s_nop 7
    v_cmp_u_f32 vcc, v24, v25
    v_add_f32_dpp v24, v24, v24 row_ror:4 row_mask:0xf bank_mask:0xf
    v_add_f32_dpp v25, v25, v25 row_ror:4 row_mask:0xf bank_mask:0xf
    s_cbranch_vccnz L_fast_lr
L_fast_lok:
    v_add_f32_dpp v24, v24, v24 row_ror:8 row_mask:0xf bank_mask:0xf
    v_add_f32_dpp v25, v25, v25 row_ror:8 row_mask:0xf bank_mask:0xf
    v_cvt_pk_bf16_f32 v31, v24, v25
    buffer_store_dword v31, v9, s[8:11], s22 offen
    s_mov_b32 s39, 0
    buffer_load_dwordx4 v[32:35], v0, s[8:11], s33 offen sc1
    v_mov_b64 v[20:21], s[100:101]
    v_mov_b64 v[22:23], s[100:101]
    s_cmp_eq_u32 s18, 63
    s_cbranch_scc1 L_fast_exit
    v_cmp_ne_u32 s[66:67], 0, v10
    s_mov_b32 s34, s32
    s_mov_b32 s19, 262144
    s_cmp_ge_u32 s31, 63438848
    s_cselect_b32 s19, 0xfff80000, s19
    s_add_u32 s31, s31, s19
    s_add_u32 s32, s32, s19
    s_bitcmp0_b64 s[66:67], s23
    s_cbranch_scc1 L_fast_lkv
L_fast_lkvok:
    s_branch L_fast_h2j
L_fast_h2l:
    buffer_load_dwordx4 v[32:35], v0, s[8:11], s33 offen sc1
    s_add_u32 s39, s39, 1
    s_and_b32 s19, s39, 63
    s_cbranch_scc1 L_fast_h2w
    s_waitcnt vmcnt(0)
    s_cmp_gt_u32 s39, 0x100000
    s_cbranch_scc1 L_team_fail
    s_mov_b64 s[72:73], 0
    v_cmp_eq_u32 vcc, s100, v32
    s_or_b64 s[72:73], s[72:73], vcc
    v_cmp_eq_u32 vcc, s100, v33
    s_or_b64 s[72:73], s[72:73], vcc
    v_cmp_eq_u32 vcc, s100, v34
    s_or_b64 s[72:73], s[72:73], vcc
    v_cmp_eq_u32 vcc, s100, v35
    s_or_b64 s[72:73], s[72:73], vcc
    s_cbranch_scc1 L_fast_h2l
    ds_write_b128 v1, v[32:35] offset:16384
    s_branch L_fast_h2ok
L_fast_er:
L_fast_er1:
    buffer_load_dwordx4 v[12:15], v1, s[8:11], s32 offen sc1
    buffer_load_dwordx4 v[16:19], v1, s[8:11], s32 offen offset:1024 sc1
    s_add_u32 s39, s39, 1
    s_waitcnt vmcnt(0)
    v_mfma_f32_16x16x32_bf16 v[24:27], v[20:23], v[12:15], 0
    v_mfma_f32_16x16x32_bf16 v[24:27], v[20:23], v[16:19], v[24:27]
    s_and_b32 s19, s39, 63
    s_nop 6
    v_cmp_u_f32 vcc, v24, v25
    v_add_f32_dpp v24, v24, v24 row_ror:4 row_mask:0xf bank_mask:0xf
    v_add_f32_dpp v25, v25, v25 row_ror:4 row_mask:0xf bank_mask:0xf
    s_cbranch_vccz L_fast_eok
    s_cbranch_scc1 L_fast_er1
    s_waitcnt vmcnt(0)
    s_cmp_gt_u32 s39, 0x100000
    s_cbranch_scc1 L_team_fail
    s_mov_b64 s[72:73], 0
    v_cmp_eq_u32 vcc, s100, v12
    s_or_b64 s[72:73], s[72:73], vcc
    v_cmp_eq_u32 vcc, s100, v13
    s_or_b64 s[72:73], s[72:73], vcc
    v_cmp_eq_u32 vcc, s100, v14
    s_or_b64 s[72:73], s[72:73], vcc
    v_cmp_eq_u32 vcc, s100, v15
    s_or_b64 s[72:73], s[72:73], vcc
    v_cmp_eq_u32 vcc, s100, v16
    s_or_b64 s[72:73], s[72:73], vcc
    v_cmp_eq_u32 vcc, s100, v17
    s_or_b64 s[72:73], s[72:73], vcc
    v_cmp_eq_u32 vcc, s100, v18
    s_or_b64 s[72:73], s[72:73], vcc
    v_cmp_eq_u32 vcc, s100, v19
    s_or_b64 s[72:73], s[72:73], vcc
    s_cbranch_scc1 L_fast_er1
    v_mfma_f32_16x16x32_bf16 v[24:27], v[20:23], v[12:15], 0
    v_mfma_f32_16x16x32_bf16 v[24:27], v[20:23], v[16:19], v[24:27]
    s_nop 7
    v_add_f32_dpp v24, v24, v24 row_ror:4 row_mask:0xf bank_mask:0xf
    v_add_f32_dpp v25, v25, v25 row_ror:4 row_mask:0xf bank_mask:0xf
    s_branch L_fast_eok
L_fast_lr:
L_fast_lr1:
    buffer_load_dwordx4 v[12:15], v1, s[8:11], s32 offen sc1
    buffer_load_dwordx4 v[16:19], v1, s[8:11], s32 offen offset:1024 sc1
    s_add_u32 s39, s39, 1
    s_waitcnt vmcnt(0)
    v_mfma_f32_16x16x32_bf16 v[24:27], v[20:23], v[12:15], 0
    v_mfma_f32_16x16x32_bf16 v[24:27], v[20:23], v[16:19], v[24:27]
    s_and_b32 s19, s39, 63
    s_nop 6
    v_cmp_u_f32 vcc, v24, v25
    v_add_f32_dpp v24, v24, v24 row_ror:4 row_mask:0xf bank_mask:0xf
    v_add_f32_dpp v25, v25, v25 row_ror:4 row_mask:0xf bank_mask:0xf
    s_cbranch_vccz L_fast_lok
    s_cbranch_scc1 L_fast_lr1
    s_waitcnt vmcnt(0)
    s_cmp_gt_u32 s39, 0x100000
    s_cbranch_scc1 L_team_fail
    s_mov_b64 s[72:73], 0
    v_cmp_eq_u32 vcc, s100, v12
    s_or_b64 s[72:73], s[72:73], vcc
    v_cmp_eq_u32 vcc, s100, v13
    s_or_b64 s[72:73], s[72:73], vcc
    v_cmp_eq_u32 vcc, s100, v14
    s_or_b64 s[72:73], s[72:73], vcc
    v_cmp_eq_u32 vcc, s100, v15
    s_or_b64 s[72:73], s[72:73], vcc
    v_cmp_eq_u32 vcc, s100, v16
    s_or_b64 s[72:73], s[72:73], vcc
    v_cmp_eq_u32 vcc, s100, v17
    s_or_b64 s[72:73], s[72:73], vcc
    v_cmp_eq_u32 vcc, s100, v18
    s_or_b64 s[72:73], s[72:73], vcc
    v_cmp_eq_u32 vcc, s100, v19
    s_or_b64 s[72:73], s[72:73], vcc
    s_cbranch_scc1 L_fast_lr1
    v_mfma_f32_16x16x32_bf16 v[24:27], v[20:23], v[12:15], 0
    v_mfma_f32_16x16x32_bf16 v[24:27], v[20:23], v[16:19], v[24:27]
    s_nop 7
    v_add_f32_dpp v24, v24, v24 row_ror:4 row_mask:0xf bank_mask:0xf
    v_add_f32_dpp v25, v25, v25 row_ror:4 row_mask:0xf bank_mask:0xf
    s_branch L_fast_lok
L_fast_ekv:
    buffer_load_dword v10, v11, s[8:11], s70 offen sc1
    s_add_u32 s71, s71, 1
    s_cmp_gt_u32 s71, 0x100000
    s_cbranch_scc1 L_team_fail
    s_waitcnt vmcnt(0)
    v_cmp_ne_u32 s[66:67], 0, v10
    s_nop 3
    s_bitcmp0_b64 s[66:67], s23
    s_cbranch_scc1 L_fast_ekv
    s_branch L_fast_ekvok
L_fast_lkv:
    buffer_load_dword v10, v11, s[8:11], s70 offen sc1
    s_add_u32 s71, s71, 1
    s_cmp_gt_u32 s71, 0x100000
    s_cbranch_scc1 L_team_fail
    s_waitcnt vmcnt(0)
    v_cmp_ne_u32 s[66:67], 0, v10
    s_nop 3
    s_bitcmp0_b64 s[66:67], s23
    s_cbranch_scc1 L_fast_lkv
    s_branch L_fast_lkvok
L_fast_Lr:
    s_cmp_eq_u32 s18, 0
    s_cbranch_scc1 L_fast_Lok
    buffer_load_dwordx4 v[36:39], v0, s[8:11], s75 offen sc1
    s_add_u32 s71, s71, 1
    s_add_u32 s39, s39, 1
    s_and_b32 s19, s39, 63
    s_waitcnt vmcnt(0)
    v_maximum3_f32 v24, v36, v37, v38
    v_cmp_u_f32 vcc, v24, v39
    ds_write_b128 v1, v[36:39] offset:17408
    s_cbranch_vccz L_fast_Lok
    s_cbranch_scc1 L_fast_Lr
    s_waitcnt vmcnt(0)
    s_cmp_gt_u32 s39, 0x100000
    s_cbranch_scc1 L_team_fail
    s_mov_b64 s[72:73], 0
    v_cmp_eq_u32 vcc, s100, v36
    s_or_b64 s[72:73], s[72:73], vcc
    v_cmp_eq_u32 vcc, s100, v37
    s_or_b64 s[72:73], s[72:73], vcc
    v_cmp_eq_u32 vcc, s100, v38
    s_or_b64 s[72:73], s[72:73], vcc
    v_cmp_eq_u32 vcc, s100, v39
    s_or_b64 s[72:73], s[72:73], vcc
    s_cbranch_scc1 L_fast_Lr
    ds_write_b128 v1, v[36:39] offset:17408
    s_branch L_fast_Lok
L_fast_exit:
    buffer_store_dword v31, v9, s[8:11], s37 offen sc1
    s_waitcnt vmcnt(0) lgkmcnt(0)
    s_branch L_team_done
L_slow_pre:
    ds_read_b128 v[20:23], v0 offset:28928
    ds_read_b128 v[40:43], v2 offset:28672
    ds_read_b128 v[44:47], v2 offset:29696
    ds_read_b128 v[48:51], v2 offset:26624
    ds_read_b128 v[52:55], v2 offset:27648
    ds_read_b128 v[56:59], v2 offset:30720
    ds_read_b128 v[60:63], v2 offset:31744
    v_mov_b64 v[80:81], 0
    v_mov_b64 v[82:83], 0
    v_mov_b64 v[84:85], 0
    v_mov_b64 v[86:87], 0
    v_xor_b32 v28, 2048, v1
    v_xor_b32 v29, 4096, v1
    v_xor_b32 v30, 6144, v1
    v_mfma_f32_16x16x1_4b_f32 v[64:79], v80, v80, 0
    v_lshrrev_b32 v11, 2, v0
    s_waitcnt lgkmcnt(0)
    ds_read_b128 v[96:99], v0 offset:0
    ds_read_b128 v[100:103], v0 offset:1024
    ds_read_b128 v[104:107], v0 offset:2048
    ds_read_b128 v[108:111], v0 offset:3072
    ds_read_b128 v[112:115], v0 offset:4096
    ds_read_b128 v[116:119], v0 offset:5120
    ds_read_b128 v[120:123], v0 offset:6144
    ds_read_b128 v[124:127], v0 offset:7168
    ds_read_b128 v[88:91], v1 offset:8192
    ds_read_b128 v[92:95], v1 offset:9216
    v_mov_b64 v[20:21], s[100:101]
    v_mov_b64 v[22:23], s[100:101]
    s_nop 15
    ds_write_b128 v1, v[32:35] offset:16384
    s_branch L_slow_top0
    .p2align 6
L_slow_early:
    buffer_load_dwordx4 v[12:15], v1, s[8:11], s32 offen sc1
    buffer_load_dwordx4 v[16:19], v1, s[8:11], s32 offen offset:1024 sc1
    ds_read_b128 v[20:23], v0 offset:28928
    ds_read_b128 v[40:43], v2 offset:28672
    ds_read_b128 v[44:47], v2 offset:29696
    ds_read_b128 v[48:51], v2 offset:26624
    ds_read_b128 v[52:55], v2 offset:27648
    ds_read_b128 v[56:59], v2 offset:30720
    ds_read_b128 v[60:63], v2 offset:31744
    s_waitcnt vmcnt(6)
    s_barrier
    s_add_u32 s18, s18, 1
    s_lshl_b32 s37, s18, 13
    s_add_u32 s37, s37, 50331648
    s_add_u32 s20, s18, 1
    s_cmp_lt_u32 s20, 64
    s_cselect_b32 s19, 524288, 0
    s_cselect_b32 s23, s20, 63
    s_add_u32 s30, s30, s19
    s_mov_b32 s22, s35
    s_lshl_b32 s20, s16, 10
    s_add_u32 s33, s22, s20
    s_add_u32 s75, s33, 4096
    s_mov_b32 s35, s36
    s_add_u32 s36, s36, 8192
    s_and_b32 s36, s36, 0xffff7fff
    s_mov_b32 s39, 0
    s_waitcnt lgkmcnt(0)
    ds_read_b128 v[96:99], v0 offset:0
    ds_read_b128 v[100:103], v0 offset:1024
    ds_read_b128 v[104:107], v0 offset:2048
    ds_read_b128 v[108:111], v0 offset:3072
    ds_read_b128 v[112:115], v0 offset:4096
    ds_read_b128 v[116:119], v0 offset:5120
    ds_read_b128 v[120:123], v0 offset:6144
    ds_read_b128 v[124:127], v0 offset:7168
    ds_read_b128 v[88:91], v1 offset:8192
    ds_read_b128 v[92:95], v1 offset:9216
    s_waitcnt vmcnt(1)
    v_mfma_f32_16x16x32_bf16 v[24:27], v[20:23], v[12:15], 0
    s_waitcnt vmcnt(0)
    v_mfma_f32_16x16x32_bf16 v[24:27], v[20:23], v[16:19], v[24:27]
    s_nop 7
    v_cmp_u_f32 vcc, v24, v25
    v_add_f32_dpp v24, v24, v24 row_ror:4 row_mask:0xf bank_mask:0xf
    v_add_f32_dpp v25, v25, v25 row_ror:4 row_mask:0xf bank_mask:0xf
    s_cbranch_vccnz L_slow_er
L_slow_eok:
    v_add_f32_dpp v24, v24, v24 row_ror:8 row_mask:0xf bank_mask:0xf
    v_add_f32_dpp v25, v25, v25 row_ror:8 row_mask:0xf bank_mask:0xf
    v_cvt_pk_bf16_f32 v31, v24, v25
    buffer_store_dword v31, v9, s[8:11], s22 offen sc1
    s_mov_b32 s39, 0
    v_mov_b64 v[20:21], s[100:101]
    v_mov_b64 v[22:23], s[100:101]
    s_cmp_eq_u32 s18, 63
    s_cbranch_scc1 L_slow_exit
    v_cmp_ne_u32 s[66:67], 0, v10
    s_mov_b32 s34, s32
    s_mov_b32 s19, 262144
    s_cmp_ge_u32 s31, 63438848
    s_cselect_b32 s19, 0xfff80000, s19
    s_add_u32 s31, s31, s19
    s_add_u32 s32, s32, s19
    s_bitcmp0_b64 s[66:67], s23
    s_cbranch_scc1 L_slow_ekv
L_slow_ekvok:
    s_nop 3
    buffer_load_dwordx4 v[32:35], v0, s[8:11], s33 offen sc1
    s_nop 15
    s_nop 1
L_slow_h2j:
    buffer_load_dwordx4 v[32:35], v0, s[8:11], s33 offen sc1
    s_nop 15
    s_nop 1
    buffer_load_dwordx4 v[32:35], v0, s[8:11], s33 offen sc1
    s_nop 15
    s_nop 1
    buffer_load_dwordx4 v[32:35], v0, s[8:11], s33 offen sc1
L_slow_h2w:
    s_waitcnt vmcnt(3)
L_slow_h2c:
    v_maximum3_f32 v24, v32, v33, v34
    v_cmp_u_f32 vcc, v24, v35
    ds_write_b128 v1, v[32:35] offset:16384
    s_cbranch_vccnz L_slow_h2l
L_slow_h2ok:
L_slow_top:
    buffer_load_dwordx4 v[36:39], v0, s[8:11], s75 offen sc1
L_slow_top0:
    v_smfmac_f32_16x16x64_bf16 v[68:71], v[32:35], v[40:47], v3
    v_smfmac_f32_16x16x64_bf16 v[72:75], v[32:35], v[48:55], v3
    v_smfmac_f32_16x16x64_bf16 v[76:79], v[32:35], v[56:63], v3
    s_waitcnt lgkmcnt(0)
    s_barrier
    ds_read_b128 v[40:43], v28 offset:16384
    v_smfmac_f32_16x16x64_bf16 v[64:67], v[32:35], a[0:7], v3
    ds_read_b128 v[48:51], v29 offset:16384
    v_smfmac_f32_16x16x64_bf16 v[80:83], v[32:35], v[128:135], v3
    ds_read_b128 v[56:59], v30 offset:16384
    v_smfmac_f32_16x16x64_bf16 v[84:87], v[32:35], v[136:143], v3
    s_waitcnt lgkmcnt(2)
    v_smfmac_f32_16x16x64_bf16 v[64:67], v[40:43], a[64:71], v3
    v_smfmac_f32_16x16x64_bf16 v[68:71], v[40:43], a[72:79], v3
    v_smfmac_f32_16x16x64_bf16 v[72:75], v[40:43], a[80:87], v3
    v_smfmac_f32_16x16x64_bf16 v[76:79], v[40:43], a[88:95], v3
    s_waitcnt lgkmcnt(1)
    v_smfmac_f32_16x16x64_bf16 v[64:67], v[48:51], a[128:135], v3
    v_smfmac_f32_16x16x64_bf16 v[68:71], v[48:51], a[136:143], v3
    v_smfmac_f32_16x16x64_bf16 v[72:75], v[48:51], a[144:151], v3
    s_waitcnt lgkmcnt(0)
    v_smfmac_f32_16x16x64_bf16 v[76:79], v[48:51], a[152:159], v3
    v_smfmac_f32_16x16x64_bf16 v[64:67], v[56:59], a[192:199], v3
    s_waitcnt vmcnt(0)
    ds_write_b128 v1, v[36:39] offset:17408
    v_smfmac_f32_16x16x64_bf16 v[68:71], v[56:59], a[200:207], v3
    v_maximum3_f32 v24, v36, v37, v38
    v_smfmac_f32_16x16x64_bf16 v[72:75], v[56:59], a[208:215], v3
    v_cmp_u_f32 vcc, v24, v39
    v_smfmac_f32_16x16x64_bf16 v[76:79], v[56:59], a[216:223], v3
    s_cbranch_vccnz L_slow_Lr
L_slow_Lok:
    v_smfmac_f32_16x16x64_bf16 v[80:83], v[40:43], v[160:167], v3
    v_smfmac_f32_16x16x64_bf16 v[84:87], v[40:43], v[168:175], v3
    s_waitcnt lgkmcnt(0)
    s_barrier
    ds_read_b128 v[44:47], v28 offset:17408
    v_smfmac_f32_16x16x64_bf16 v[64:67], v[36:39], a[32:39], v3
    ds_read_b128 v[52:55], v29 offset:17408
    v_smfmac_f32_16x16x64_bf16 v[68:71], v[36:39], a[40:47], v3
    ds_read_b128 v[60:63], v30 offset:17408
    v_smfmac_f32_16x16x64_bf16 v[72:75], v[36:39], a[48:55], v3
    buffer_load_dwordx4 v0, s[8:11], s30 offen offset:0 sc1 lds
    v_smfmac_f32_16x16x64_bf16 v[76:79], v[36:39], a[56:63], v3
    s_waitcnt lgkmcnt(2)
    v_smfmac_f32_16x16x64_bf16 v[64:67], v[44:47], a[96:103], v3
    buffer_store_dword v20, v1, s[8:11], s34 offen sc1
    v_smfmac_f32_16x16x64_bf16 v[68:71], v[44:47], a[104:111], v3
    s_waitcnt lgkmcnt(0)
    v_smfmac_f32_16x16x64_bf16 v[64:67], v[52:55], a[160:167], v3
    buffer_load_dwordx4 v0, s[8:11], s30 offen offset:1024 sc1 lds
    v_smfmac_f32_16x16x64_bf16 v[68:71], v[52:55], a[168:175], v3
    buffer_store_dword v31, v9, s[8:11], s37 offen sc1
    v_smfmac_f32_16x16x64_bf16 v[64:67], v[60:63], a[224:231], v3
    v_smfmac_f32_16x16x64_bf16 v[68:71], v[60:63], a[232:239], v3
    buffer_load_dwordx4 v0, s[8:11], s30 offen offset:2048 sc1 lds
    v_smfmac_f32_16x16x64_bf16 v[72:75], v[44:47], a[112:119], v3
    v_add_f32 v64, v64, v66
    v_smfmac_f32_16x16x64_bf16 v[76:79], v[44:47], a[120:127], v3
    v_add_f32 v65, v65, v67
    v_smfmac_f32_16x16x64_bf16 v[72:75], v[52:55], a[176:183], v3
    v_add_f32 v68, v68, v70
    v_smfmac_f32_16x16x64_bf16 v[76:79], v[52:55], a[184:191], v3
    v_add_f32 v69, v69, v71
    v_smfmac_f32_16x16x64_bf16 v[72:75], v[60:63], a[240:247], v3
    v_cvt_pk_bf16_f32 v24, v64, v68
    v_smfmac_f32_16x16x64_bf16 v[76:79], v[60:63], a[248:255], v3
    v_cvt_pk_bf16_f32 v26, v65, v69
    v_smfmac_f32_16x16x64_bf16 v[80:83], v[48:51], v[192:199], v3
    v_add_f32 v72, v72, v74
    v_add_f32 v73, v73, v75
    v_smfmac_f32_16x16x64_bf16 v[84:87], v[48:51], v[200:207], v3
    v_add_f32 v76, v76, v78
    v_add_f32 v77, v77, v79
    v_cvt_pk_bf16_f32 v25, v72, v76
    v_smfmac_f32_16x16x64_bf16 v[80:83], v[56:59], v[224:231], v3
    ds_write_b64 v4, v[24:25]
    v_cvt_pk_bf16_f32 v27, v73, v77
    ds_write_b64 v4, v[26:27] offset:544
    v_smfmac_f32_16x16x64_bf16 v[84:87], v[56:59], v[232:239], v3
    v_smfmac_f32_16x16x64_bf16 v[80:83], v[36:39], v[144:151], v3
    buffer_load_dwordx4 v0, s[8:11], s30 offen offset:3072 sc1 lds
    v_smfmac_f32_16x16x64_bf16 v[84:87], v[36:39], v[152:159], v3
    v_smfmac_f32_16x16x64_bf16 v[80:83], v[44:47], v[176:183], v3
    s_waitcnt vmcnt(6) lgkmcnt(0)
    s_barrier
    ds_read_b128 v[64:67], v5 offset:0
    ds_read_b128 v[68:71], v5 offset:16
    v_smfmac_f32_16x16x64_bf16 v[84:87], v[44:47], v[184:191], v3
    ds_read_b128 v[72:75], v5 offset:128
    v_smfmac_f32_16x16x64_bf16 v[80:83], v[52:55], v[208:215], v3
    ds_read_b128 v[76:79], v5 offset:144
    v_smfmac_f32_16x16x64_bf16 v[84:87], v[52:55], v[216:223], v3
    buffer_load_dword v10, v11, s[8:11], s70 offen sc1
    v_smfmac_f32_16x16x64_bf16 v[80:83], v[60:63], v[240:247], v3
    buffer_store_dword v20, v1, s[8:11], s34 offen offset:1024 sc1
    v_smfmac_f32_16x16x64_bf16 v[84:87], v[60:63], v[248:255], v3
    s_waitcnt lgkmcnt(0)
    v_mfma_f32_16x16x32_bf16 v[20:23], v[96:99], v[64:67], 0
    ds_read_b128 v[32:35], v2 offset:0
    v_mfma_f32_16x16x32_bf16 v[24:27], v[112:115], v[64:67], 0
    ds_read_b128 v[36:39], v2 offset:1024
    v_mfma_f32_16x16x32_bf16 v[28:31], v[64:67], v[64:67], 0
    ds_read_b128 v[40:43], v2 offset:4096
    v_add_f32 v80, v80, v82
    v_mfma_f32_16x16x32_bf16 v[20:23], v[100:103], v[68:71], v[20:23]
    ds_read_b128 v[44:47], v2 offset:5120
    v_add_f32 v81, v81, v83
    v_mfma_f32_16x16x32_bf16 v[24:27], v[116:119], v[68:71], v[24:27]
    ds_read_b128 v[48:51], v2 offset:2048
    v_add_f32 v84, v84, v86
    v_mfma_f32_16x16x32_bf16 v[28:31], v[68:71], v[68:71], v[28:31]
    ds_read_b128 v[52:55], v2 offset:3072
    v_add_f32 v85, v85, v87
    v_mfma_f32_16x16x32_bf16 v[20:23], v[104:107], v[72:75], v[20:23]
    ds_read_b128 v[56:59], v2 offset:6144
    v_mov_b32 v17, 0
    v_mfma_f32_16x16x32_bf16 v[24:27], v[120:123], v[72:75], v[24:27]
    ds_read_b128 v[60:63], v2 offset:7168
    v_cvt_pk_bf16_f32 v12, v80, v81
    v_mfma_f32_16x16x32_bf16 v[28:31], v[72:75], v[72:75], v[28:31]
    v_cvt_pk_bf16_f32 v14, v84, v85
    v_mov_b32 v13, 0
    v_mfma_f32_16x16x32_bf16 v[20:23], v[108:111], v[76:79], v[20:23]
    v_mov_b32 v15, 0
    v_mfma_f32_16x16x32_bf16 v[24:27], v[124:127], v[76:79], v[24:27]
    v_mfma_f32_16x16x32_bf16 v[28:31], v[76:79], v[76:79], v[28:31]
    s_nop 3
    v_max3_f32 v11, v20, v21, v22
    v_max3_f32 v11, v11, v23, v24
    v_max3_f32 v16, v25, v26, v27
    v_max_f32 v11, v11, v16
    v_max3_f32 v16, v11, v28, v29
    v_max3_f32 v11, v11, v28, v29
    ds_read_b128 v[72:75], v2 offset:8192
    ds_read_b128 v[76:79], v2 offset:9216
    v_permlane32_swap_b32 v16, v11
    v_max_f32 v11, v11, v16
    v_max_f32 v16, v11, v16
    v_mov_b64 v[68:69], s[98:99]
    v_mov_b64 v[70:71], s[98:99]
    v_permlane16_swap_b32 v16, v11
    v_max_f32 v11, v11, v16
    v_mul_f32 v30, s68, v11
    v_pk_fma_f32 v[28:29], v[28:29], s[68:69], v[30:31] op_sel_hi:[1,1,0] neg_lo:[0,0,1] neg_hi:[0,0,1]
    v_pk_fma_f32 v[20:21], v[20:21], s[68:69], v[30:31] op_sel_hi:[1,1,0] neg_lo:[0,0,1] neg_hi:[0,0,1]
    v_pk_fma_f32 v[22:23], v[22:23], s[68:69], v[30:31] op_sel_hi:[1,1,0] neg_lo:[0,0,1] neg_hi:[0,0,1]
    v_pk_fma_f32 v[24:25], v[24:25], s[68:69], v[30:31] op_sel_hi:[1,1,0] neg_lo:[0,0,1] neg_hi:[0,0,1]
    v_pk_fma_f32 v[26:27], v[26:27], s[68:69], v[30:31] op_sel_hi:[1,1,0] neg_lo:[0,0,1] neg_hi:[0,0,1]
    v_exp_f32 v28, v28
    v_exp_f32 v29, v29
    v_exp_f32 v20, v20
    v_cvt_pk_bf16_f32 v16, v28, v29
    v_exp_f32 v21, v21
    v_exp_f32 v22, v22
    v_mfma_f32_16x16x16_bf16 v[64:67], v[68:69], v[16:17], 0
    v_exp_f32 v23, v23
    v_cvt_pk_bf16_f32 v28, v20, v21
    v_mfma_f32_16x16x16_bf16 v[80:83], v[12:13], v[16:17], 0
    v_exp_f32 v24, v24
    v_cvt_pk_bf16_f32 v29, v22, v23
    v_mfma_f32_16x16x16_bf16 v[84:87], v[14:15], v[16:17], 0
    v_exp_f32 v25, v25
    v_exp_f32 v26, v26
    v_exp_f32 v27, v27
    v_cvt_pk_bf16_f32 v30, v24, v25
    v_cvt_pk_bf16_f32 v31, v26, v27
    ds_read_b128 v[20:23], v2 offset:12288
    ds_read_b128 v[24:27], v2 offset:13312
    v_mfma_f32_16x16x32_bf16 v[64:67], v[68:71], v[28:31], v[64:67]
    ds_read_b128 v[12:15], v2 offset:16384
    v_mov_b32 v11, 0
    v_mfma_f32_16x16x32_bf16 v[80:83], v[88:91], v[28:31], v[80:83]
    ds_read_b128 v[16:19], v2 offset:17408
    v_mfma_f32_16x16x32_bf16 v[84:87], v[92:95], v[28:31], v[84:87]
    v_rcp_f32 v64, v64
    s_add_u32 s19, s31, 4096
    v_pk_mul_f32 v[80:81], v[80:81], v[64:65] op_sel_hi:[1,0]
    v_pk_mul_f32 v[82:83], v[82:83], v[64:65] op_sel_hi:[1,0]
    v_cvt_pk_bf16_f32 v28, v80, v81
    v_cvt_pk_bf16_f32 v29, v82, v83
    v_pk_mul_f32 v[84:85], v[84:85], v[64:65] op_sel_hi:[1,0]
    v_pk_mul_f32 v[86:87], v[86:87], v[64:65] op_sel_hi:[1,0]
    v_cvt_pk_bf16_f32 v30, v84, v85
    v_cvt_pk_bf16_f32 v31, v86, v87
    ds_write_b128 v6, v[28:31]
    v_mfma_f32_32x32x1_2b_f32 v[96:127], v11, v11, 0
    ds_read_b128 v[64:67], v2 offset:10240
    ds_read_b128 v[68:71], v2 offset:11264
    s_waitcnt lgkmcnt(2)
    s_barrier
    ds_read_b128 v[88:91], v7
    ds_read_b128 v[92:95], v7 offset:64
    ds_read_b128 v[80:83], v2 offset:14336
    ds_read_b128 v[84:87], v2 offset:15360
    s_cmp_lt_u32 s16, 2
    s_waitcnt lgkmcnt(3)
    v_smfmac_f32_16x16x64_bf16 v[96:99], v[88:91], v[32:39], v3
    ds_read_b128 v[32:35], v2 offset:20480
    v_smfmac_f32_16x16x64_bf16 v[100:103], v[88:91], v[40:47], v3
    ds_read_b128 v[36:39], v2 offset:21504
    s_waitcnt lgkmcnt(4)
    v_smfmac_f32_16x16x64_bf16 v[96:99], v[92:95], v[48:55], v3
    ds_read_b128 v[40:43], v2 offset:18432
    v_smfmac_f32_16x16x64_bf16 v[100:103], v[92:95], v[56:63], v3
    ds_read_b128 v[44:47], v2 offset:19456
    v_smfmac_f32_16x16x64_bf16 v[104:107], v[88:91], v[72:79], v3
    ds_read_b128 v[48:51], v2 offset:22528
    v_smfmac_f32_16x16x64_bf16 v[108:111], v[88:91], v[20:27], v3
    ds_read_b128 v[52:55], v2 offset:23552
    s_waitcnt lgkmcnt(6)
    v_add_f32 v96, v96, v98
    v_smfmac_f32_16x16x64_bf16 v[104:107], v[92:95], v[64:71], v3
    ds_read_b128 v[56:59], v2 offset:24576
    v_add_f32 v97, v97, v99
    v_smfmac_f32_16x16x64_bf16 v[108:111], v[92:95], v[80:87], v3
    ds_read_b128 v[60:63], v2 offset:25600
    v_add_f32 v100, v100, v102
    v_add_f32 v101, v101, v103
    v_smfmac_f32_16x16x64_bf16 v[112:115], v[88:91], v[12:19], v3
    v_cvt_pk_bf16_f32 v28, v96, v100
    v_cvt_pk_bf16_f32 v30, v97, v101
    s_waitcnt lgkmcnt(4)
    v_smfmac_f32_16x16x64_bf16 v[116:119], v[88:91], v[32:39], v3
    v_add_f32 v104, v104, v106
    v_add_f32 v105, v105, v107
    v_add_f32 v108, v108, v110
    v_smfmac_f32_16x16x64_bf16 v[112:115], v[92:95], v[40:47], v3
    v_add_f32 v109, v109, v111
    v_cvt_pk_bf16_f32 v29, v104, v108
    v_cvt_pk_bf16_f32 v31, v105, v109
    buffer_store_dwordx4 v[28:31], v8, s[8:11], s31 offen sc1
    s_waitcnt lgkmcnt(0)
    v_smfmac_f32_16x16x64_bf16 v[116:119], v[92:95], v[48:55], v3
    v_smfmac_f32_16x16x64_bf16 v[120:123], v[88:91], v[56:63], v3
    v_add_f32 v112, v112, v114
    v_smfmac_f32_16x16x64_bf16 v[124:127], v[88:91], a[8:15], v3
    v_add_f32 v113, v113, v115
    v_smfmac_f32_16x16x64_bf16 v[120:123], v[92:95], a[16:23], v3
    v_add_f32 v116, v116, v118
    v_smfmac_f32_16x16x64_bf16 v[124:127], v[92:95], a[24:31], v3
    v_add_f32 v117, v117, v119
    v_cvt_pk_bf16_f32 v96, v112, v116
    v_cvt_pk_bf16_f32 v98, v113, v117
    v_pk_add_f32 v[120:121], v[120:121], v[122:123]
    s_nop 1
    v_pk_add_f32 v[124:125], v[124:125], v[126:127]
    v_cvt_pk_bf16_f32 v97, v120, v124
    v_cvt_pk_bf16_f32 v99, v121, v125
    buffer_store_dwordx4 v[96:99], v8, s[8:11], s19 offen sc1
    v_mov_b32 v24, s100
    buffer_store_dword v24, v9, s[8:11], s36 offen sc1
    v_mov_b64 v[80:81], 0
    v_mov_b64 v[82:83], 0
    v_mov_b64 v[84:85], 0
    v_mov_b64 v[86:87], 0
    v_xor_b32 v28, 2048, v1
    v_xor_b32 v29, 4096, v1
    v_xor_b32 v30, 6144, v1
    v_mfma_f32_16x16x1_4b_f32 v[64:79], v80, v80, 0
    v_lshrrev_b32 v11, 2, v0
    s_cbranch_scc1 L_slow_early
    ds_read_b128 v[20:23], v0 offset:28928
    ds_read_b128 v[40:43], v2 offset:28672
    ds_read_b128 v[44:47], v2 offset:29696
    ds_read_b128 v[48:51], v2 offset:26624
    ds_read_b128 v[52:55], v2 offset:27648
    ds_read_b128 v[56:59], v2 offset:30720
    ds_read_b128 v[60:63], v2 offset:31744
    s_waitcnt vmcnt(4)
    s_barrier
    s_add_u32 s18, s18, 1
    s_lshl_b32 s37, s18, 13
    s_add_u32 s37, s37, 50331648
    s_add_u32 s20, s18, 1
    s_cmp_lt_u32 s20, 64
    s_cselect_b32 s19, 524288, 0
    s_cselect_b32 s23, s20, 63
    s_add_u32 s30, s30, s19
    s_mov_b32 s22, s35
    s_lshl_b32 s20, s16, 10
    s_add_u32 s33, s22, s20
    s_add_u32 s75, s33, 4096
    s_mov_b32 s35, s36
    s_add_u32 s36, s36, 8192
    s_and_b32 s36, s36, 0xffff7fff
    s_nop 11
    buffer_load_dwordx4 v[12:15], v1, s[8:11], s32 offen sc1
    buffer_load_dwordx4 v[16:19], v1, s[8:11], s32 offen offset:1024 sc1
    s_waitcnt lgkmcnt(0)
    ds_read_b128 v[96:99], v0 offset:0
    ds_read_b128 v[100:103], v0 offset:1024
    ds_read_b128 v[104:107], v0 offset:2048
    ds_read_b128 v[108:111], v0 offset:3072
    ds_read_b128 v[112:115], v0 offset:4096
    ds_read_b128 v[116:119], v0 offset:5120
    ds_read_b128 v[120:123], v0 offset:6144
    ds_read_b128 v[124:127], v0 offset:7168
    ds_read_b128 v[88:91], v1 offset:8192
    ds_read_b128 v[92:95], v1 offset:9216
    s_mov_b32 s39, 0
    s_waitcnt vmcnt(1)
    v_mfma_f32_16x16x32_bf16 v[24:27], v[20:23], v[12:15], 0
    s_waitcnt vmcnt(0)
    v_mfma_f32_16x16x32_bf16 v[24:27], v[20:23], v[16:19], v[24:27]
    s_nop 7
    v_cmp_u_f32 vcc, v24, v25
    v_add_f32_dpp v24, v24, v24 row_ror:4 row_mask:0xf bank_mask:0xf
    v_add_f32_dpp v25, v25, v25 row_ror:4 row_mask:0xf bank_mask:0xf
    s_cbranch_vccnz L_slow_lr
L_slow_lok:
    v_add_f32_dpp v24, v24, v24 row_ror:8 row_mask:0xf bank_mask:0xf
    v_add_f32_dpp v25, v25, v25 row_ror:8 row_mask:0xf bank_mask:0xf
    v_cvt_pk_bf16_f32 v31, v24, v25
    buffer_store_dword v31, v9, s[8:11], s22 offen sc1
    s_mov_b32 s39, 0
    buffer_load_dwordx4 v[32:35], v0, s[8:11], s33 offen sc1
    v_mov_b64 v[20:21], s[100:101]
    v_mov_b64 v[22:23], s[100:101]
    s_cmp_eq_u32 s18, 63
    s_cbranch_scc1 L_slow_exit
    v_cmp_ne_u32 s[66:67], 0, v10
    s_mov_b32 s34, s32
    s_mov_b32 s19, 262144
    s_cmp_ge_u32 s31, 63438848
    s_cselect_b32 s19, 0xfff80000, s19
    s_add_u32 s31, s31, s19
    s_add_u32 s32, s32, s19
    s_bitcmp0_b64 s[66:67], s23
    s_cbranch_scc1 L_slow_lkv
L_slow_lkvok:
    s_branch L_slow_h2j
L_slow_h2l:
    buffer_load_dwordx4 v[32:35], v0, s[8:11], s33 offen sc1
    s_add_u32 s39, s39, 1
    s_and_b32 s19, s39, 63
    s_cbranch_scc1 L_slow_h2w
    s_waitcnt vmcnt(0)
    s_cmp_gt_u32 s39, 0x100000
    s_cbranch_scc1 L_team_fail
    s_mov_b64 s[72:73], 0
    v_cmp_eq_u32 vcc, s100, v32
    s_or_b64 s[72:73], s[72:73], vcc
    v_cmp_eq_u32 vcc, s100, v33
    s_or_b64 s[72:73], s[72:73], vcc
    v_cmp_eq_u32 vcc, s100, v34
    s_or_b64 s[72:73], s[72:73], vcc
    v_cmp_eq_u32 vcc, s100, v35
    s_or_b64 s[72:73], s[72:73], vcc
    s_cbranch_scc1 L_slow_h2l
    ds_write_b128 v1, v[32:35] offset:16384
    s_branch L_slow_h2ok
L_slow_er:
L_slow_er1:
    buffer_load_dwordx4 v[12:15], v1, s[8:11], s32 offen sc1
    buffer_load_dwordx4 v[16:19], v1, s[8:11], s32 offen offset:1024 sc1
    s_add_u32 s39, s39, 1
    s_waitcnt vmcnt(0)
    v_mfma_f32_16x16x32_bf16 v[24:27], v[20:23], v[12:15], 0
    v_mfma_f32_16x16x32_bf16 v[24:27], v[20:23], v[16:19], v[24:27]
    s_and_b32 s19, s39, 63
    s_nop 6
    v_cmp_u_f32 vcc, v24, v25
    v_add_f32_dpp v24, v24, v24 row_ror:4 row_mask:0xf bank_mask:0xf
    v_add_f32_dpp v25, v25, v25 row_ror:4 row_mask:0xf bank_mask:0xf
    s_cbranch_vccz L_slow_eok
    s_cbranch_scc1 L_slow_er1
    s_waitcnt vmcnt(0)
    s_cmp_gt_u32 s39, 0x100000
    s_cbranch_scc1 L_team_fail
    s_mov_b64 s[72:73], 0
    v_cmp_eq_u32 vcc, s100, v12
    s_or_b64 s[72:73], s[72:73], vcc
    v_cmp_eq_u32 vcc, s100, v13
    s_or_b64 s[72:73], s[72:73], vcc
    v_cmp_eq_u32 vcc, s100, v14
    s_or_b64 s[72:73], s[72:73], vcc
    v_cmp_eq_u32 vcc, s100, v15
    s_or_b64 s[72:73], s[72:73], vcc
    v_cmp_eq_u32 vcc, s100, v16
    s_or_b64 s[72:73], s[72:73], vcc
    v_cmp_eq_u32 vcc, s100, v17
    s_or_b64 s[72:73], s[72:73], vcc
    v_cmp_eq_u32 vcc, s100, v18
    s_or_b64 s[72:73], s[72:73], vcc
    v_cmp_eq_u32 vcc, s100, v19
    s_or_b64 s[72:73], s[72:73], vcc
    s_cbranch_scc1 L_slow_er1
    v_mfma_f32_16x16x32_bf16 v[24:27], v[20:23], v[12:15], 0
    v_mfma_f32_16x16x32_bf16 v[24:27], v[20:23], v[16:19], v[24:27]
    s_nop 7
    v_add_f32_dpp v24, v24, v24 row_ror:4 row_mask:0xf bank_mask:0xf
    v_add_f32_dpp v25, v25, v25 row_ror:4 row_mask:0xf bank_mask:0xf
    s_branch L_slow_eok
L_slow_lr:
L_slow_lr1:
    buffer_load_dwordx4 v[12:15], v1, s[8:11], s32 offen sc1
    buffer_load_dwordx4 v[16:19], v1, s[8:11], s32 offen offset:1024 sc1
    s_add_u32 s39, s39, 1
    s_waitcnt vmcnt(0)
    v_mfma_f32_16x16x32_bf16 v[24:27], v[20:23], v[12:15], 0
    v_mfma_f32_16x16x32_bf16 v[24:27], v[20:23], v[16:19], v[24:27]
    s_and_b32 s19, s39, 63
    s_nop 6
    v_cmp_u_f32 vcc, v24, v25
    v_add_f32_dpp v24, v24, v24 row_ror:4 row_mask:0xf bank_mask:0xf
    v_add_f32_dpp v25, v25, v25 row_ror:4 row_mask:0xf bank_mask:0xf
    s_cbranch_vccz L_slow_lok
    s_cbranch_scc1 L_slow_lr1
    s_waitcnt vmcnt(0)
    s_cmp_gt_u32 s39, 0x100000
    s_cbranch_scc1 L_team_fail
    s_mov_b64 s[72:73], 0
    v_cmp_eq_u32 vcc, s100, v12
    s_or_b64 s[72:73], s[72:73], vcc
    v_cmp_eq_u32 vcc, s100, v13
    s_or_b64 s[72:73], s[72:73], vcc
    v_cmp_eq_u32 vcc, s100, v14
    s_or_b64 s[72:73], s[72:73], vcc
    v_cmp_eq_u32 vcc, s100, v15
    s_or_b64 s[72:73], s[72:73], vcc
    v_cmp_eq_u32 vcc, s100, v16
    s_or_b64 s[72:73], s[72:73], vcc
    v_cmp_eq_u32 vcc, s100, v17
    s_or_b64 s[72:73], s[72:73], vcc
    v_cmp_eq_u32 vcc, s100, v18
    s_or_b64 s[72:73], s[72:73], vcc
    v_cmp_eq_u32 vcc, s100, v19
    s_or_b64 s[72:73], s[72:73], vcc
    s_cbranch_scc1 L_slow_lr1
    v_mfma_f32_16x16x32_bf16 v[24:27], v[20:23], v[12:15], 0
    v_mfma_f32_16x16x32_bf16 v[24:27], v[20:23], v[16:19], v[24:27]
    s_nop 7
    v_add_f32_dpp v24, v24, v24 row_ror:4 row_mask:0xf bank_mask:0xf
    v_add_f32_dpp v25, v25, v25 row_ror:4 row_mask:0xf bank_mask:0xf
    s_branch L_slow_lok
L_slow_ekv:
    buffer_load_dword v10, v11, s[8:11], s70 offen sc1
    s_add_u32 s71, s71, 1
    s_cmp_gt_u32 s71, 0x100000
    s_cbranch_scc1 L_team_fail
    s_waitcnt vmcnt(0)
    v_cmp_ne_u32 s[66:67], 0, v10
    s_nop 3
    s_bitcmp0_b64 s[66:67], s23
    s_cbranch_scc1 L_slow_ekv
    s_branch L_slow_ekvok
L_slow_lkv:
    buffer_load_dword v10, v11, s[8:11], s70 offen sc1
    s_add_u32 s71, s71, 1
    s_cmp_gt_u32 s71, 0x100000
    s_cbranch_scc1 L_team_fail
    s_waitcnt vmcnt(0)
    v_cmp_ne_u32 s[66:67], 0, v10
    s_nop 3
    s_bitcmp0_b64 s[66:67], s23
    s_cbranch_scc1 L_slow_lkv
    s_branch L_slow_lkvok
L_slow_Lr:
    s_cmp_eq_u32 s18, 0
    s_cbranch_scc1 L_slow_Lok
    buffer_load_dwordx4 v[36:39], v0, s[8:11], s75 offen sc1
    s_add_u32 s71, s71, 1
    s_add_u32 s39, s39, 1
    s_and_b32 s19, s39, 63
    s_waitcnt vmcnt(0)
    v_maximum3_f32 v24, v36, v37, v38
    v_cmp_u_f32 vcc, v24, v39
    ds_write_b128 v1, v[36:39] offset:17408
    s_cbranch_vccz L_slow_Lok
    s_cbranch_scc1 L_slow_Lr
    s_waitcnt vmcnt(0)
    s_cmp_gt_u32 s39, 0x100000
    s_cbranch_scc1 L_team_fail
    s_mov_b64 s[72:73], 0
    v_cmp_eq_u32 vcc, s100, v36
    s_or_b64 s[72:73], s[72:73], vcc
    v_cmp_eq_u32 vcc, s100, v37
    s_or_b64 s[72:73], s[72:73], vcc
    v_cmp_eq_u32 vcc, s100, v38
    s_or_b64 s[72:73], s[72:73], vcc
    v_cmp_eq_u32 vcc, s100, v39
    s_or_b64 s[72:73], s[72:73], vcc
    s_cbranch_scc1 L_slow_Lr
    ds_write_b128 v1, v[36:39] offset:17408
    s_branch L_slow_Lok
L_slow_exit:
    buffer_store_dword v31, v9, s[8:11], s37 offen sc1
    s_waitcnt vmcnt(0) lgkmcnt(0)
    s_branch L_team_done
L_team_fail:
    v_mov_b32 v20, 52
    v_mov_b32 v21, s18
    v_add_u32 v21, 0x100, v21
    buffer_store_dword v21, v20, s[12:15], 0 offen sc1
    s_waitcnt vmcnt(0)
    s_endpgm
L_worker:
    s_sub_u32 s21, s21, 32
    s_and_b32 s19, s21, 31
    s_sub_u32 s21, s21, s19
    s_mul_i32 s20, s21, 9363
    s_lshr_b32 s20, s20, 16
    s_mul_i32 s20, s20, 7
    s_add_u32 s20, s20, 7
    s_sub_u32 s20, s20, s21
L_sort:
    s_cmp_eq_u32 s20, 7
    s_cselect_b32 s20, 0, s20
    s_cmp_lt_u32 s20, 4
    s_cselect_b32 s22, 5, 4
    s_cmp_lt_u32 s19, s22
    s_cbranch_scc1 L_sorted
    s_sub_u32 s19, s19, s22
    s_add_u32 s20, s20, 1
    s_branch L_sort
L_sorted:
    s_mul_i32 s19, s19, 7
    s_add_u32 s21, s21, s20
    s_add_u32 s21, s21, s19
    s_mul_i32 s17, s21, 9363
    s_lshr_b32 s17, s17, 16
    s_mul_i32 s19, s17, 7
    s_sub_u32 s18, s21, s19
    v_and_b32 v0, 63, v0
    v_lshlrev_b32 v0, 4, v0
    s_mov_b32 s71, 0
    s_mov_b32 s30, s18
    s_lshl_b32 s70, s17, 12
    s_add_u32 s70, s70, 63963136
    s_cmp_lg_u32 s18, 3
    s_cbranch_scc1 L_noinit
    v_mov_b32 v112, 0x7f817f81
    v_mov_b32 v113, 0x7f817f81
    v_mov_b32 v114, 0x7f817f81
    v_mov_b32 v115, 0x7f817f81
    v_mov_b32 v116, 0
    v_mov_b32 v117, 0
    v_mov_b32 v118, 0
    v_mov_b32 v119, 0
    s_lshl_b32 s19, s17, 14
    s_lshl_b32 s20, s16, 12
    s_add_u32 s19, s19, s20
    s_add_u32 s19, s19, 50331648
    s_lshl_b32 s20, s16, 10
    s_add_u32 s20, s20, s70
    buffer_store_dwordx4 v[112:115], v0, s[8:11], s19 offen offset:0 sc1
    buffer_store_dwordx4 v[112:115], v0, s[8:11], s19 offen offset:1024 sc1
    buffer_store_dwordx4 v[112:115], v0, s[8:11], s19 offen offset:2048 sc1
    buffer_store_dwordx4 v[112:115], v0, s[8:11], s19 offen offset:3072 sc1
    buffer_store_dwordx4 v[116:119], v0, s[8:11], s20 offen sc1
    s_mul_i32 s19, s17, 24576
    s_mul_i32 s20, s16, 6144
    s_add_u32 s19, s19, s20
    s_add_u32 s19, s19, 62914560
    s_add_u32 s20, s19, 4096
    buffer_store_dwordx4 v[112:115], v0, s[8:11], s19 offen offset:0 sc1
    buffer_store_dwordx4 v[112:115], v0, s[8:11], s19 offen offset:1024 sc1
    buffer_store_dwordx4 v[112:115], v0, s[8:11], s19 offen offset:2048 sc1
    buffer_store_dwordx4 v[112:115], v0, s[8:11], s19 offen offset:3072 sc1
    buffer_store_dwordx4 v[112:115], v0, s[8:11], s20 offen offset:0 sc1
    buffer_store_dwordx4 v[112:115], v0, s[8:11], s20 offen offset:1024 sc1
    s_lshl_b32 s19, s17, 10
    s_add_u32 s19, s19, 63700992
    buffer_store_dwordx4 v[112:115], v0, s[8:11], s19 offen sc1
    s_waitcnt vmcnt(0)
    s_barrier
    s_lshl_b32 s19, s16, 10
    v_add_u32 v121, s19, v0
    v_mov_b32 v120, 0x7f000000
    v_cmp_eq_u32 vcc, 0, v121
    s_nop 1
    v_cndmask_b32 v120, v120, 0, vcc
    v_mov_b32 v121, 1
    buffer_atomic_add v121, v120, s[12:15], 44 offen
L_noinit:
    s_cmp_lt_u32 s18, 2
    s_cbranch_scc1 L_nopf3
    v_lshrrev_b32 v116, 8, v0
    v_and_b32 v117, 0xf0, v0
    v_lshl_add_u32 v116, v116, 13, v117
    s_sub_u32 s19, s18, 2
    s_lshl_b32 s19, s19, 2
    s_add_u32 s19, s19, s16
    s_mul_i32 s19, s19, 229376
    s_lshl_b32 s20, s17, 8
    s_add_u32 s19, s19, s20
    s_mov_b32 s92, s52
    s_and_b32 s93, s53, 0xffff
    s_mov_b32 s94, 0x400000
    s_mov_b32 s95, 0x20000
    s_add_u32 s20, s19, 0
    buffer_load_dwordx4 v[112:115], v116, s[92:95], s20 offen
    s_add_u32 s20, s19, 32768
    buffer_load_dwordx4 v[112:115], v116, s[92:95], s20 offen
    s_add_u32 s20, s19, 65536
    buffer_load_dwordx4 v[112:115], v116, s[92:95], s20 offen
    s_add_u32 s20, s19, 98304
    buffer_load_dwordx4 v[112:115], v116, s[92:95], s20 offen
    s_add_u32 s20, s19, 131072
    buffer_load_dwordx4 v[112:115], v116, s[92:95], s20 offen
    s_add_u32 s20, s19, 163840
    buffer_load_dwordx4 v[112:115], v116, s[92:95], s20 offen
    s_add_u32 s20, s19, 196608
    buffer_load_dwordx4 v[112:115], v116, s[92:95], s20 offen
    s_mov_b32 s92, s54
    s_and_b32 s93, s55, 0xffff
    s_mov_b32 s94, 0x400000
    s_mov_b32 s95, 0x20000
    s_add_u32 s20, s19, 0
    buffer_load_dwordx4 v[112:115], v116, s[92:95], s20 offen
    s_add_u32 s20, s19, 32768
    buffer_load_dwordx4 v[112:115], v116, s[92:95], s20 offen
    s_add_u32 s20, s19, 65536
    buffer_load_dwordx4 v[112:115], v116, s[92:95], s20 offen
    s_add_u32 s20, s19, 98304
    buffer_load_dwordx4 v[112:115], v116, s[92:95], s20 offen
    s_add_u32 s20, s19, 131072
    buffer_load_dwordx4 v[112:115], v116, s[92:95], s20 offen
    s_add_u32 s20, s19, 163840
    buffer_load_dwordx4 v[112:115], v116, s[92:95], s20 offen
    s_add_u32 s20, s19, 196608
    buffer_load_dwordx4 v[112:115], v116, s[92:95], s20 offen
    s_waitcnt vmcnt(5)
L_nopf3:
    v_lshrrev_b32 v1, 4, v0
    v_lshrrev_b32 v2, 4, v1
    v_and_b32 v1, 15, v1
    v_lshrrev_b32 v16, 1, v2
    v_and_b32 v17, 1, v2
    v_lshlrev_b32 v18, 3, v2
    v_lshlrev_b32 v18, 13, v18
    s_lshl_b32 s19, s17, 8
    s_lshl_b32 s21, s16, 20
    s_add_u32 s21, s21, s19
    v_lshl_add_u32 v3, v1, 4, v18
    s_mov_b32 s4, s50
    s_and_b32 s5, s51, 0xffff
    s_mov_b32 s6, 0x400000
    s_mov_b32 s7, 0x20000
    s_mov_b32 s84, s52
    s_and_b32 s85, s53, 0xffff
    s_mov_b32 s86, 0x400000
    s_mov_b32 s87, 0x20000
    s_mov_b32 s88, s54
    s_and_b32 s89, s55, 0xffff
    s_mov_b32 s90, 0x400000
    s_mov_b32 s91, 0x20000
    s_add_u32 s22, s21, 0
    buffer_load_dwordx4 v[128:131], v3, s[4:7], s22 offen
    s_add_u32 s22, s21, 8192
    buffer_load_dwordx4 v[132:135], v3, s[4:7], s22 offen
    s_add_u32 s22, s21, 16384
    buffer_load_dwordx4 v[136:139], v3, s[4:7], s22 offen
    s_add_u32 s22, s21, 24576
    buffer_load_dwordx4 v[140:143], v3, s[4:7], s22 offen
    s_add_u32 s22, s21, 32768
    buffer_load_dwordx4 v[144:147], v3, s[4:7], s22 offen
    s_add_u32 s22, s21, 40960
    buffer_load_dwordx4 v[148:151], v3, s[4:7], s22 offen
    s_add_u32 s22, s21, 49152
    buffer_load_dwordx4 v[152:155], v3, s[4:7], s22 offen
    s_add_u32 s22, s21, 57344
    buffer_load_dwordx4 v[156:159], v3, s[4:7], s22 offen
    s_add_u32 s22, s21, 262144
    buffer_load_dwordx4 v[160:163], v3, s[4:7], s22 offen
    s_add_u32 s22, s21, 270336
    buffer_load_dwordx4 v[164:167], v3, s[4:7], s22 offen
    s_add_u32 s22, s21, 278528
    buffer_load_dwordx4 v[168:171], v3, s[4:7], s22 offen
    s_add_u32 s22, s21, 286720
    buffer_load_dwordx4 v[172:175], v3, s[4:7], s22 offen
    s_add_u32 s22, s21, 294912
    buffer_load_dwordx4 v[176:179], v3, s[4:7], s22 offen
    s_add_u32 s22, s21, 303104
    buffer_load_dwordx4 v[180:183], v3, s[4:7], s22 offen
    s_add_u32 s22, s21, 311296
    buffer_load_dwordx4 v[184:187], v3, s[4:7], s22 offen
    s_add_u32 s22, s21, 319488
    buffer_load_dwordx4 v[188:191], v3, s[4:7], s22 offen
    s_mov_b32 s28, 0x05040100
    s_mov_b32 s29, 0x07060302
    s_lshl_b32 s22, s16, 12
    s_add_u32 s22, s22, 32768
    v_add_u32 v5, s22, v0
    v_add_u32 v6, 0x10000, v5
    s_lshl_b32 s22, s16, 15
    s_add_u32 s22, s22, 32768
    v_add_u32 v7, s22, v0
    s_and_b32 s20, s16, 1
    s_lshl_b32 s20, s20, 16
    s_add_u32 s20, s20, 32768
    s_mov_b32 s22, 0
    s_lshl_b32 s19, s22, 12
    s_add_u32 s19, s19, s20
    v_add_u32 v8, s19, v0
    s_mov_b32 s22, s16
    s_lshl_b32 s19, s22, 10
    s_add_u32 s19, s19, 32768
    v_add_u32 v12, s19, v0
    s_mov_b32 s22, 1
    s_lshl_b32 s19, s22, 12
    s_add_u32 s19, s19, s20
    v_add_u32 v9, s19, v0
    s_mov_b32 s22, s16
    s_lshl_b32 s19, s22, 10
    s_add_u32 s19, s19, 65536
    v_add_u32 v13, s19, v0
    s_mov_b32 s22, 2
    s_lshl_b32 s19, s22, 12
    s_add_u32 s19, s19, s20
    v_add_u32 v10, s19, v0
    s_mov_b32 s22, s16
    s_lshl_b32 s19, s22, 10
    s_add_u32 s19, s19, 98304
    v_add_u32 v14, s19, v0
    s_mov_b32 s22, 3
    s_lshl_b32 s19, s22, 12
    s_add_u32 s19, s19, s20
    v_add_u32 v11, s19, v0
    s_mov_b32 s22, s16
    s_lshl_b32 s19, s22, 10
    s_add_u32 s19, s19, 131072
    v_add_u32 v15, s19, v0
    s_waitcnt vmcnt(8)
    v_perm_b32 v16, v132, v128, s28
    v_perm_b32 v17, v140, v136, s28
    v_perm_b32 v18, v148, v144, s28
    v_perm_b32 v19, v156, v152, s28
    ds_write_b128 v5, v[16:19] offset:0
    v_perm_b32 v20, v132, v128, s29
    v_perm_b32 v21, v140, v136, s29
    v_perm_b32 v22, v148, v144, s29
    v_perm_b32 v23, v156, v152, s29
    ds_write_b128 v5, v[20:23] offset:16384
    v_perm_b32 v24, v133, v129, s28
    v_perm_b32 v25, v141, v137, s28
    v_perm_b32 v26, v149, v145, s28
    v_perm_b32 v27, v157, v153, s28
    ds_write_b128 v5, v[24:27] offset:32768
    v_perm_b32 v28, v133, v129, s29
    v_perm_b32 v29, v141, v137, s29
    v_perm_b32 v30, v149, v145, s29
    v_perm_b32 v31, v157, v153, s29
    ds_write_b128 v5, v[28:31] offset:49152
    v_perm_b32 v32, v134, v130, s28
    v_perm_b32 v33, v142, v138, s28
    v_perm_b32 v34, v150, v146, s28
    v_perm_b32 v35, v158, v154, s28
    ds_write_b128 v6, v[32:35] offset:0
    v_perm_b32 v36, v134, v130, s29
    v_perm_b32 v37, v142, v138, s29
    v_perm_b32 v38, v150, v146, s29
    v_perm_b32 v39, v158, v154, s29
    ds_write_b128 v6, v[36:39] offset:16384
    v_perm_b32 v40, v135, v131, s28
    v_perm_b32 v41, v143, v139, s28
    v_perm_b32 v42, v151, v147, s28
    v_perm_b32 v43, v159, v155, s28
    ds_write_b128 v6, v[40:43] offset:32768
    v_perm_b32 v44, v135, v131, s29
    v_perm_b32 v45, v143, v139, s29
    v_perm_b32 v46, v151, v147, s29
    v_perm_b32 v47, v159, v155, s29
    ds_write_b128 v6, v[44:47] offset:49152
    s_add_u32 s22, s21, 524288
    buffer_load_dwordx4 v[192:195], v3, s[4:7], s22 offen
    s_add_u32 s22, s21, 532480
    buffer_load_dwordx4 v[196:199], v3, s[4:7], s22 offen
    s_add_u32 s22, s21, 540672
    buffer_load_dwordx4 v[200:203], v3, s[4:7], s22 offen
    s_add_u32 s22, s21, 548864
    buffer_load_dwordx4 v[204:207], v3, s[4:7], s22 offen
    s_add_u32 s22, s21, 557056
    buffer_load_dwordx4 v[208:211], v3, s[4:7], s22 offen
    s_add_u32 s22, s21, 565248
    buffer_load_dwordx4 v[212:215], v3, s[4:7], s22 offen
    s_add_u32 s22, s21, 573440
    buffer_load_dwordx4 v[216:219], v3, s[4:7], s22 offen
    s_add_u32 s22, s21, 581632
    buffer_load_dwordx4 v[220:223], v3, s[4:7], s22 offen
    s_waitcnt vmcnt(8)
    s_waitcnt lgkmcnt(0)
    v_perm_b32 v16, v164, v160, s28
    v_perm_b32 v17, v172, v168, s28
    v_perm_b32 v18, v180, v176, s28
    v_perm_b32 v19, v188, v184, s28
    ds_write_b128 v5, v[16:19] offset:1024
    v_perm_b32 v20, v164, v160, s29
    v_perm_b32 v21, v172, v168, s29
    v_perm_b32 v22, v180, v176, s29
    v_perm_b32 v23, v188, v184, s29
    ds_write_b128 v5, v[20:23] offset:17408
    v_perm_b32 v24, v165, v161, s28
    v_perm_b32 v25, v173, v169, s28
    v_perm_b32 v26, v181, v177, s28
    v_perm_b32 v27, v189, v185, s28
    ds_write_b128 v5, v[24:27] offset:33792
    v_perm_b32 v28, v165, v161, s29
    v_perm_b32 v29, v173, v169, s29
    v_perm_b32 v30, v181, v177, s29
    v_perm_b32 v31, v189, v185, s29
    ds_write_b128 v5, v[28:31] offset:50176
    v_perm_b32 v32, v166, v162, s28
    v_perm_b32 v33, v174, v170, s28
    v_perm_b32 v34, v182, v178, s28
    v_perm_b32 v35, v190, v186, s28
    ds_write_b128 v6, v[32:35] offset:1024
    v_perm_b32 v36, v166, v162, s29
    v_perm_b32 v37, v174, v170, s29
    v_perm_b32 v38, v182, v178, s29
    v_perm_b32 v39, v190, v186, s29
    ds_write_b128 v6, v[36:39] offset:17408
    v_perm_b32 v40, v167, v163, s28
    v_perm_b32 v41, v175, v171, s28
    v_perm_b32 v42, v183, v179, s28
    v_perm_b32 v43, v191, v187, s28
    ds_write_b128 v6, v[40:43] offset:33792
    v_perm_b32 v44, v167, v163, s29
    v_perm_b32 v45, v175, v171, s29
    v_perm_b32 v46, v183, v179, s29
    v_perm_b32 v47, v191, v187, s29
    ds_write_b128 v6, v[44:47] offset:50176
    s_add_u32 s22, s21, 786432
    buffer_load_dwordx4 v[224:227], v3, s[4:7], s22 offen
    s_add_u32 s22, s21, 794624
    buffer_load_dwordx4 v[228:231], v3, s[4:7], s22 offen
    s_add_u32 s22, s21, 802816
    buffer_load_dwordx4 v[232:235], v3, s[4:7], s22 offen
    s_add_u32 s22, s21, 811008
    buffer_load_dwordx4 v[236:239], v3, s[4:7], s22 offen
    s_add_u32 s22, s21, 819200
    buffer_load_dwordx4 v[240:243], v3, s[4:7], s22 offen
    s_add_u32 s22, s21, 827392
    buffer_load_dwordx4 v[244:247], v3, s[4:7], s22 offen
    s_add_u32 s22, s21, 835584
    buffer_load_dwordx4 v[248:251], v3, s[4:7], s22 offen
    s_add_u32 s22, s21, 843776
    buffer_load_dwordx4 v[252:255], v3, s[4:7], s22 offen
    s_waitcnt vmcnt(8)
    s_waitcnt lgkmcnt(0)
    v_perm_b32 v16, v196, v192, s28
    v_perm_b32 v17, v204, v200, s28
    v_perm_b32 v18, v212, v208, s28
    v_perm_b32 v19, v220, v216, s28
    ds_write_b128 v5, v[16:19] offset:2048
    v_perm_b32 v20, v196, v192, s29
    v_perm_b32 v21, v204, v200, s29
    v_perm_b32 v22, v212, v208, s29
    v_perm_b32 v23, v220, v216, s29
    ds_write_b128 v5, v[20:23] offset:18432
    v_perm_b32 v24, v197, v193, s28
    v_perm_b32 v25, v205, v201, s28
    v_perm_b32 v26, v213, v209, s28
    v_perm_b32 v27, v221, v217, s28
    ds_write_b128 v5, v[24:27] offset:34816
    v_perm_b32 v28, v197, v193, s29
    v_perm_b32 v29, v205, v201, s29
    v_perm_b32 v30, v213, v209, s29
    v_perm_b32 v31, v221, v217, s29
    ds_write_b128 v5, v[28:31] offset:51200
    v_perm_b32 v32, v198, v194, s28
    v_perm_b32 v33, v206, v202, s28
    v_perm_b32 v34, v214, v210, s28
    v_perm_b32 v35, v222, v218, s28
    ds_write_b128 v6, v[32:35] offset:2048
    v_perm_b32 v36, v198, v194, s29
    v_perm_b32 v37, v206, v202, s29
    v_perm_b32 v38, v214, v210, s29
    v_perm_b32 v39, v222, v218, s29
    ds_write_b128 v6, v[36:39] offset:18432
    v_perm_b32 v40, v199, v195, s28
    v_perm_b32 v41, v207, v203, s28
    v_perm_b32 v42, v215, v211, s28
    v_perm_b32 v43, v223, v219, s28
    ds_write_b128 v6, v[40:43] offset:34816
    v_perm_b32 v44, v199, v195, s29
    v_perm_b32 v45, v207, v203, s29
    v_perm_b32 v46, v215, v211, s29
    v_perm_b32 v47, v223, v219, s29
    ds_write_b128 v6, v[44:47] offset:51200
    s_add_u32 s22, s21, 0
    buffer_load_dwordx4 v[48:51], v3, s[84:87], s22 offen
    s_add_u32 s22, s21, 8192
    buffer_load_dwordx4 v[52:55], v3, s[84:87], s22 offen
    s_add_u32 s22, s21, 16384
    buffer_load_dwordx4 v[56:59], v3, s[84:87], s22 offen
    s_add_u32 s22, s21, 24576
    buffer_load_dwordx4 v[60:63], v3, s[84:87], s22 offen
    s_add_u32 s22, s21, 32768
    buffer_load_dwordx4 v[64:67], v3, s[84:87], s22 offen
    s_add_u32 s22, s21, 40960
    buffer_load_dwordx4 v[68:71], v3, s[84:87], s22 offen
    s_add_u32 s22, s21, 49152
    buffer_load_dwordx4 v[72:75], v3, s[84:87], s22 offen
    s_add_u32 s22, s21, 57344
    buffer_load_dwordx4 v[76:79], v3, s[84:87], s22 offen
    s_waitcnt vmcnt(8)
    s_waitcnt lgkmcnt(0)
    v_perm_b32 v16, v228, v224, s28
    v_perm_b32 v17, v236, v232, s28
    v_perm_b32 v18, v244, v240, s28
    v_perm_b32 v19, v252, v248, s28
    ds_write_b128 v5, v[16:19] offset:3072
    v_perm_b32 v20, v228, v224, s29
    v_perm_b32 v21, v236, v232, s29
    v_perm_b32 v22, v244, v240, s29
    v_perm_b32 v23, v252, v248, s29
    ds_write_b128 v5, v[20:23] offset:19456
    v_perm_b32 v24, v229, v225, s28
    v_perm_b32 v25, v237, v233, s28
    v_perm_b32 v26, v245, v241, s28
    v_perm_b32 v27, v253, v249, s28
    ds_write_b128 v5, v[24:27] offset:35840
    v_perm_b32 v28, v229, v225, s29
    v_perm_b32 v29, v237, v233, s29
    v_perm_b32 v30, v245, v241, s29
    v_perm_b32 v31, v253, v249, s29
    ds_write_b128 v5, v[28:31] offset:52224
    v_perm_b32 v32, v230, v226, s28
    v_perm_b32 v33, v238, v234, s28
    v_perm_b32 v34, v246, v242, s28
    v_perm_b32 v35, v254, v250, s28
    ds_write_b128 v6, v[32:35] offset:3072
    v_perm_b32 v36, v230, v226, s29
    v_perm_b32 v37, v238, v234, s29
    v_perm_b32 v38, v246, v242, s29
    v_perm_b32 v39, v254, v250, s29
    ds_write_b128 v6, v[36:39] offset:19456
    v_perm_b32 v40, v231, v227, s28
    v_perm_b32 v41, v239, v235, s28
    v_perm_b32 v42, v247, v243, s28
    v_perm_b32 v43, v255, v251, s28
    ds_write_b128 v6, v[40:43] offset:35840
    v_perm_b32 v44, v231, v227, s29
    v_perm_b32 v45, v239, v235, s29
    v_perm_b32 v46, v247, v243, s29
    v_perm_b32 v47, v255, v251, s29
    ds_write_b128 v6, v[44:47] offset:52224
    s_add_u32 s22, s21, 262144
    buffer_load_dwordx4 v[80:83], v3, s[84:87], s22 offen
    s_add_u32 s22, s21, 270336
    buffer_load_dwordx4 v[84:87], v3, s[84:87], s22 offen
    s_add_u32 s22, s21, 278528
    buffer_load_dwordx4 v[88:91], v3, s[84:87], s22 offen
    s_add_u32 s22, s21, 286720
    buffer_load_dwordx4 v[92:95], v3, s[84:87], s22 offen
    s_add_u32 s22, s21, 294912
    buffer_load_dwordx4 v[96:99], v3, s[84:87], s22 offen
    s_add_u32 s22, s21, 303104
    buffer_load_dwordx4 v[100:103], v3, s[84:87], s22 offen
    s_add_u32 s22, s21, 311296
    buffer_load_dwordx4 v[104:107], v3, s[84:87], s22 offen
    s_add_u32 s22, s21, 319488
    buffer_load_dwordx4 v[108:111], v3, s[84:87], s22 offen
    s_waitcnt lgkmcnt(0)
    s_barrier
    s_cmp_ge_u32 s16, 2
    s_cbranch_scc1 L_rb_7
    ds_read_b128 a[0:3], v8 offset:0
    ds_read_b128 a[4:7], v8 offset:1024
    ds_read_b128 a[8:11], v8 offset:16384
    ds_read_b128 a[12:15], v8 offset:17408
    ds_read_b128 a[16:19], v8 offset:32768
    ds_read_b128 a[20:23], v8 offset:33792
    ds_read_b128 a[24:27], v8 offset:49152
    ds_read_b128 a[28:31], v8 offset:50176
    s_waitcnt lgkmcnt(6)
    ds_read_b128 a[32:35], v8 offset:2048
    ds_read_b128 a[36:39], v8 offset:3072
    ds_read_b128 a[40:43], v8 offset:18432
    ds_read_b128 a[44:47], v8 offset:19456
    ds_read_b128 a[48:51], v8 offset:34816
    ds_read_b128 a[52:55], v8 offset:35840
    ds_read_b128 a[56:59], v8 offset:51200
    ds_read_b128 a[60:63], v8 offset:52224
    s_waitcnt lgkmcnt(6)
    ds_read_b128 a[64:67], v9 offset:0
    ds_read_b128 a[68:71], v9 offset:1024
    ds_read_b128 a[72:75], v9 offset:16384
    ds_read_b128 a[76:79], v9 offset:17408
    ds_read_b128 a[80:83], v9 offset:32768
    ds_read_b128 a[84:87], v9 offset:33792
    ds_read_b128 a[88:91], v9 offset:49152
    ds_read_b128 a[92:95], v9 offset:50176
    s_waitcnt lgkmcnt(6)
    ds_read_b128 a[96:99], v9 offset:2048
    ds_read_b128 a[100:103], v9 offset:3072
    ds_read_b128 a[104:107], v9 offset:18432
    ds_read_b128 a[108:111], v9 offset:19456
    ds_read_b128 a[112:115], v9 offset:34816
    ds_read_b128 a[116:119], v9 offset:35840
    ds_read_b128 a[120:123], v9 offset:51200
    ds_read_b128 a[124:127], v9 offset:52224
    s_waitcnt lgkmcnt(6)
    ds_read_b128 a[128:131], v10 offset:0
    ds_read_b128 a[132:135], v10 offset:1024
    ds_read_b128 a[136:139], v10 offset:16384
    ds_read_b128 a[140:143], v10 offset:17408
    ds_read_b128 a[144:147], v10 offset:32768
    ds_read_b128 a[148:151], v10 offset:33792
    ds_read_b128 a[152:155], v10 offset:49152
    ds_read_b128 a[156:159], v10 offset:50176
    s_waitcnt lgkmcnt(6)
    ds_read_b128 a[160:163], v10 offset:2048
    ds_read_b128 a[164:167], v10 offset:3072
    ds_read_b128 a[168:171], v10 offset:18432
    ds_read_b128 a[172:175], v10 offset:19456
    ds_read_b128 a[176:179], v10 offset:34816
    ds_read_b128 a[180:183], v10 offset:35840
    ds_read_b128 a[184:187], v10 offset:51200
    ds_read_b128 a[188:191], v10 offset:52224
    s_waitcnt lgkmcnt(6)
    ds_read_b128 a[192:195], v11 offset:0
    ds_read_b128 a[196:199], v11 offset:1024
    ds_read_b128 a[200:203], v11 offset:16384
    ds_read_b128 a[204:207], v11 offset:17408
    ds_read_b128 a[208:211], v11 offset:32768
    ds_read_b128 a[212:215], v11 offset:33792
    ds_read_b128 a[216:219], v11 offset:49152
    ds_read_b128 a[220:223], v11 offset:50176
    s_waitcnt lgkmcnt(6)
    ds_read_b128 a[224:227], v11 offset:2048
    ds_read_b128 a[228:231], v11 offset:3072
    ds_read_b128 a[232:235], v11 offset:18432
    ds_read_b128 a[236:239], v11 offset:19456
    ds_read_b128 a[240:243], v11 offset:34816
    ds_read_b128 a[244:247], v11 offset:35840
    ds_read_b128 a[248:251], v11 offset:51200
    ds_read_b128 a[252:255], v11 offset:52224
    s_waitcnt lgkmcnt(6)
L_rb_7:
    s_waitcnt vmcnt(8)
    s_waitcnt lgkmcnt(0)
    s_barrier
    v_perm_b32 v16, v52, v48, s28
    v_perm_b32 v17, v60, v56, s28
    v_perm_b32 v18, v68, v64, s28
    v_perm_b32 v19, v76, v72, s28
    ds_write_b128 v5, v[16:19] offset:0
    v_perm_b32 v20, v52, v48, s29
    v_perm_b32 v21, v60, v56, s29
    v_perm_b32 v22, v68, v64, s29
    v_perm_b32 v23, v76, v72, s29
    ds_write_b128 v5, v[20:23] offset:16384
    v_perm_b32 v24, v53, v49, s28
    v_perm_b32 v25, v61, v57, s28
    v_perm_b32 v26, v69, v65, s28
    v_perm_b32 v27, v77, v73, s28
    ds_write_b128 v5, v[24:27] offset:32768
    v_perm_b32 v28, v53, v49, s29
    v_perm_b32 v29, v61, v57, s29
    v_perm_b32 v30, v69, v65, s29
    v_perm_b32 v31, v77, v73, s29
    ds_write_b128 v5, v[28:31] offset:49152
    v_perm_b32 v32, v54, v50, s28
    v_perm_b32 v33, v62, v58, s28
    v_perm_b32 v34, v70, v66, s28
    v_perm_b32 v35, v78, v74, s28
    ds_write_b128 v6, v[32:35] offset:0
    v_perm_b32 v36, v54, v50, s29
    v_perm_b32 v37, v62, v58, s29
    v_perm_b32 v38, v70, v66, s29
    v_perm_b32 v39, v78, v74, s29
    ds_write_b128 v6, v[36:39] offset:16384
    v_perm_b32 v40, v55, v51, s28
    v_perm_b32 v41, v63, v59, s28
    v_perm_b32 v42, v71, v67, s28
    v_perm_b32 v43, v79, v75, s28
    ds_write_b128 v6, v[40:43] offset:32768
    v_perm_b32 v44, v55, v51, s29
    v_perm_b32 v45, v63, v59, s29
    v_perm_b32 v46, v71, v67, s29
    v_perm_b32 v47, v79, v75, s29
    ds_write_b128 v6, v[44:47] offset:49152
    s_add_u32 s22, s21, 524288
    buffer_load_dwordx4 v[128:131], v3, s[84:87], s22 offen
    s_add_u32 s22, s21, 532480
    buffer_load_dwordx4 v[132:135], v3, s[84:87], s22 offen
    s_add_u32 s22, s21, 540672
    buffer_load_dwordx4 v[136:139], v3, s[84:87], s22 offen
    s_add_u32 s22, s21, 548864
    buffer_load_dwordx4 v[140:143], v3, s[84:87], s22 offen
    s_add_u32 s22, s21, 557056
    buffer_load_dwordx4 v[144:147], v3, s[84:87], s22 offen
    s_add_u32 s22, s21, 565248
    buffer_load_dwordx4 v[148:151], v3, s[84:87], s22 offen
    s_add_u32 s22, s21, 573440
    buffer_load_dwordx4 v[152:155], v3, s[84:87], s22 offen
    s_add_u32 s22, s21, 581632
    buffer_load_dwordx4 v[156:159], v3, s[84:87], s22 offen
    s_mov_b32 s92, s56
    s_and_b32 s93, s57, 0xffff
    s_mov_b32 s94, 0x400000
    s_mov_b32 s95, 0x20000
    s_lshl_b32 s19, s17, 2
    s_add_u32 s19, s19, s18
    s_sub_u32 s19, s19, 3
    s_lshl_b32 s19, s19, 15
    s_lshl_b32 s20, s16, 13
    s_add_u32 s19, s19, s20
    s_cmp_lt_u32 s18, 3
    s_cselect_b32 s19, 0x7f000000, s19
    buffer_load_dwordx4 v[122:125], v0, s[92:95], s19 offen offset:0
    buffer_load_dwordx4 v[122:125], v0, s[92:95], s19 offen offset:1024
    buffer_load_dwordx4 v[122:125], v0, s[92:95], s19 offen offset:2048
    buffer_load_dwordx4 v[122:125], v0, s[92:95], s19 offen offset:3072
    s_add_u32 s19, s19, 4096
    buffer_load_dwordx4 v[122:125], v0, s[92:95], s19 offen offset:0
    buffer_load_dwordx4 v[122:125], v0, s[92:95], s19 offen offset:1024
    buffer_load_dwordx4 v[122:125], v0, s[92:95], s19 offen offset:2048
    buffer_load_dwordx4 v[122:125], v0, s[92:95], s19 offen offset:3072
    s_waitcnt vmcnt(16)
    s_waitcnt lgkmcnt(0)
    v_perm_b32 v16, v84, v80, s28
    v_perm_b32 v17, v92, v88, s28
    v_perm_b32 v18, v100, v96, s28
    v_perm_b32 v19, v108, v104, s28
    ds_write_b128 v5, v[16:19] offset:1024
    v_perm_b32 v20, v84, v80, s29
    v_perm_b32 v21, v92, v88, s29
    v_perm_b32 v22, v100, v96, s29
    v_perm_b32 v23, v108, v104, s29
    ds_write_b128 v5, v[20:23] offset:17408
    v_perm_b32 v24, v85, v81, s28
    v_perm_b32 v25, v93, v89, s28
    v_perm_b32 v26, v101, v97, s28
    v_perm_b32 v27, v109, v105, s28
    ds_write_b128 v5, v[24:27] offset:33792
    v_perm_b32 v28, v85, v81, s29
    v_perm_b32 v29, v93, v89, s29
    v_perm_b32 v30, v101, v97, s29
    v_perm_b32 v31, v109, v105, s29
    ds_write_b128 v5, v[28:31] offset:50176
    v_perm_b32 v32, v86, v82, s28
    v_perm_b32 v33, v94, v90, s28
    v_perm_b32 v34, v102, v98, s28
    v_perm_b32 v35, v110, v106, s28
    ds_write_b128 v6, v[32:35] offset:1024
    v_perm_b32 v36, v86, v82, s29
    v_perm_b32 v37, v94, v90, s29
    v_perm_b32 v38, v102, v98, s29
    v_perm_b32 v39, v110, v106, s29
    ds_write_b128 v6, v[36:39] offset:17408
    v_perm_b32 v40, v87, v83, s28
    v_perm_b32 v41, v95, v91, s28
    v_perm_b32 v42, v103, v99, s28
    v_perm_b32 v43, v111, v107, s28
    ds_write_b128 v6, v[40:43] offset:33792
    v_perm_b32 v44, v87, v83, s29
    v_perm_b32 v45, v95, v91, s29
    v_perm_b32 v46, v103, v99, s29
    v_perm_b32 v47, v111, v107, s29
    ds_write_b128 v6, v[44:47] offset:50176
    s_add_u32 s22, s21, 786432
    buffer_load_dwordx4 v[160:163], v3, s[84:87], s22 offen
    s_add_u32 s22, s21, 794624
    buffer_load_dwordx4 v[164:167], v3, s[84:87], s22 offen
    s_add_u32 s22, s21, 802816
    buffer_load_dwordx4 v[168:171], v3, s[84:87], s22 offen
    s_add_u32 s22, s21, 811008
    buffer_load_dwordx4 v[172:175], v3, s[84:87], s22 offen
    s_add_u32 s22, s21, 819200
    buffer_load_dwordx4 v[176:179], v3, s[84:87], s22 offen
    s_add_u32 s22, s21, 827392
    buffer_load_dwordx4 v[180:183], v3, s[84:87], s22 offen
    s_add_u32 s22, s21, 835584
    buffer_load_dwordx4 v[184:187], v3, s[84:87], s22 offen
    s_add_u32 s22, s21, 843776
    buffer_load_dwordx4 v[188:191], v3, s[84:87], s22 offen
    s_mov_b32 s92, s46
    s_and_b32 s93, s47, 0xffff
    s_mov_b32 s94, 0x200000
    s_mov_b32 s95, 0x20000
    s_add_u32 s34, s30, 0
    s_lshl_b32 s34, s34, 15
    s_lshl_b32 s19, s16, 13
    s_add_u32 s34, s34, s19
    buffer_load_dwordx4 v[112:115], v0, s[92:95], s34 offen offset:0
    buffer_load_dwordx4 v[112:115], v0, s[92:95], s34 offen offset:1024
    buffer_load_dwordx4 v[112:115], v0, s[92:95], s34 offen offset:2048
    buffer_load_dwordx4 v[112:115], v0, s[92:95], s34 offen offset:3072
    s_add_u32 s34, s34, 4096
    buffer_load_dwordx4 v[112:115], v0, s[92:95], s34 offen offset:0
    buffer_load_dwordx4 v[112:115], v0, s[92:95], s34 offen offset:1024
    buffer_load_dwordx4 v[112:115], v0, s[92:95], s34 offen offset:2048
    buffer_load_dwordx4 v[112:115], v0, s[92:95], s34 offen offset:3072
    s_waitcnt vmcnt(24)
    s_waitcnt lgkmcnt(0)
    v_perm_b32 v16, v132, v128, s28
    v_perm_b32 v17, v140, v136, s28
    v_perm_b32 v18, v148, v144, s28
    v_perm_b32 v19, v156, v152, s28
    ds_write_b128 v5, v[16:19] offset:2048
    v_perm_b32 v20, v132, v128, s29
    v_perm_b32 v21, v140, v136, s29
    v_perm_b32 v22, v148, v144, s29
    v_perm_b32 v23, v156, v152, s29
    ds_write_b128 v5, v[20:23] offset:18432
    v_perm_b32 v24, v133, v129, s28
    v_perm_b32 v25, v141, v137, s28
    v_perm_b32 v26, v149, v145, s28
    v_perm_b32 v27, v157, v153, s28
    ds_write_b128 v5, v[24:27] offset:34816
    v_perm_b32 v28, v133, v129, s29
    v_perm_b32 v29, v141, v137, s29
    v_perm_b32 v30, v149, v145, s29
    v_perm_b32 v31, v157, v153, s29
    ds_write_b128 v5, v[28:31] offset:51200
    v_perm_b32 v32, v134, v130, s28
    v_perm_b32 v33, v142, v138, s28
    v_perm_b32 v34, v150, v146, s28
    v_perm_b32 v35, v158, v154, s28
    ds_write_b128 v6, v[32:35] offset:2048
    v_perm_b32 v36, v134, v130, s29
    v_perm_b32 v37, v142, v138, s29
    v_perm_b32 v38, v150, v146, s29
    v_perm_b32 v39, v158, v154, s29
    ds_write_b128 v6, v[36:39] offset:18432
    v_perm_b32 v40, v135, v131, s28
    v_perm_b32 v41, v143, v139, s28
    v_perm_b32 v42, v151, v147, s28
    v_perm_b32 v43, v159, v155, s28
    ds_write_b128 v6, v[40:43] offset:34816
    v_perm_b32 v44, v135, v131, s29
    v_perm_b32 v45, v143, v139, s29
    v_perm_b32 v46, v151, v147, s29
    v_perm_b32 v47, v159, v155, s29
    ds_write_b128 v6, v[44:47] offset:51200
    s_add_u32 s22, s21, 0
    buffer_load_dwordx4 v[192:195], v3, s[88:91], s22 offen
    s_add_u32 s22, s21, 8192
    buffer_load_dwordx4 v[196:199], v3, s[88:91], s22 offen
    s_add_u32 s22, s21, 16384
    buffer_load_dwordx4 v[200:203], v3, s[88:91], s22 offen
    s_add_u32 s22, s21, 24576
    buffer_load_dwordx4 v[204:207], v3, s[88:91], s22 offen
    s_add_u32 s22, s21, 32768
    buffer_load_dwordx4 v[208:211], v3, s[88:91], s22 offen
    s_add_u32 s22, s21, 40960
    buffer_load_dwordx4 v[212:215], v3, s[88:91], s22 offen
    s_add_u32 s22, s21, 49152
    buffer_load_dwordx4 v[216:219], v3, s[88:91], s22 offen
    s_add_u32 s22, s21, 57344
    buffer_load_dwordx4 v[220:223], v3, s[88:91], s22 offen
    s_waitcnt vmcnt(16)
    s_waitcnt lgkmcnt(0)
    v_perm_b32 v16, v164, v160, s28
    v_perm_b32 v17, v172, v168, s28
    v_perm_b32 v18, v180, v176, s28
    v_perm_b32 v19, v188, v184, s28
    ds_write_b128 v5, v[16:19] offset:3072
    v_perm_b32 v20, v164, v160, s29
    v_perm_b32 v21, v172, v168, s29
    v_perm_b32 v22, v180, v176, s29
    v_perm_b32 v23, v188, v184, s29
    ds_write_b128 v5, v[20:23] offset:19456
    v_perm_b32 v24, v165, v161, s28
    v_perm_b32 v25, v173, v169, s28
    v_perm_b32 v26, v181, v177, s28
    v_perm_b32 v27, v189, v185, s28
    ds_write_b128 v5, v[24:27] offset:35840
    v_perm_b32 v28, v165, v161, s29
    v_perm_b32 v29, v173, v169, s29
    v_perm_b32 v30, v181, v177, s29
    v_perm_b32 v31, v189, v185, s29
    ds_write_b128 v5, v[28:31] offset:52224
    v_perm_b32 v32, v166, v162, s28
    v_perm_b32 v33, v174, v170, s28
    v_perm_b32 v34, v182, v178, s28
    v_perm_b32 v35, v190, v186, s28
    ds_write_b128 v6, v[32:35] offset:3072
    v_perm_b32 v36, v166, v162, s29
    v_perm_b32 v37, v174, v170, s29
    v_perm_b32 v38, v182, v178, s29
    v_perm_b32 v39, v190, v186, s29
    ds_write_b128 v6, v[36:39] offset:19456
    v_perm_b32 v40, v167, v163, s28
    v_perm_b32 v41, v175, v171, s28
    v_perm_b32 v42, v183, v179, s28
    v_perm_b32 v43, v191, v187, s28
    ds_write_b128 v6, v[40:43] offset:35840
    v_perm_b32 v44, v167, v163, s29
    v_perm_b32 v45, v175, v171, s29
    v_perm_b32 v46, v183, v179, s29
    v_perm_b32 v47, v191, v187, s29
    ds_write_b128 v6, v[44:47] offset:52224
    s_add_u32 s22, s21, 262144
    buffer_load_dwordx4 v[224:227], v3, s[88:91], s22 offen
    s_add_u32 s22, s21, 270336
    buffer_load_dwordx4 v[228:231], v3, s[88:91], s22 offen
    s_add_u32 s22, s21, 278528
    buffer_load_dwordx4 v[232:235], v3, s[88:91], s22 offen
    s_add_u32 s22, s21, 286720
    buffer_load_dwordx4 v[236:239], v3, s[88:91], s22 offen
    s_add_u32 s22, s21, 294912
    buffer_load_dwordx4 v[240:243], v3, s[88:91], s22 offen
    s_add_u32 s22, s21, 303104
    buffer_load_dwordx4 v[244:247], v3, s[88:91], s22 offen
    s_add_u32 s22, s21, 311296
    buffer_load_dwordx4 v[248:251], v3, s[88:91], s22 offen
    s_add_u32 s22, s21, 319488
    buffer_load_dwordx4 v[252:255], v3, s[88:91], s22 offen
    s_waitcnt lgkmcnt(0)
    s_barrier
    s_cmp_lt_u32 s16, 2
    s_cbranch_scc1 L_rb_9
    ds_read_b128 a[0:3], v8 offset:0
    ds_read_b128 a[4:7], v8 offset:1024
    ds_read_b128 a[8:11], v8 offset:16384
    ds_read_b128 a[12:15], v8 offset:17408
    ds_read_b128 a[16:19], v8 offset:32768
    ds_read_b128 a[20:23], v8 offset:33792
    ds_read_b128 a[24:27], v8 offset:49152
    ds_read_b128 a[28:31], v8 offset:50176
    s_waitcnt lgkmcnt(6)
    ds_read_b128 a[32:35], v8 offset:2048
    ds_read_b128 a[36:39], v8 offset:3072
    ds_read_b128 a[40:43], v8 offset:18432
    ds_read_b128 a[44:47], v8 offset:19456
    ds_read_b128 a[48:51], v8 offset:34816
    ds_read_b128 a[52:55], v8 offset:35840
    ds_read_b128 a[56:59], v8 offset:51200
    ds_read_b128 a[60:63], v8 offset:52224
    s_waitcnt lgkmcnt(6)
    ds_read_b128 a[64:67], v9 offset:0
    ds_read_b128 a[68:71], v9 offset:1024
    ds_read_b128 a[72:75], v9 offset:16384
    ds_read_b128 a[76:79], v9 offset:17408
    ds_read_b128 a[80:83], v9 offset:32768
    ds_read_b128 a[84:87], v9 offset:33792
    ds_read_b128 a[88:91], v9 offset:49152
    ds_read_b128 a[92:95], v9 offset:50176
    s_waitcnt lgkmcnt(6)
    ds_read_b128 a[96:99], v9 offset:2048
    ds_read_b128 a[100:103], v9 offset:3072
    ds_read_b128 a[104:107], v9 offset:18432
    ds_read_b128 a[108:111], v9 offset:19456
    ds_read_b128 a[112:115], v9 offset:34816
    ds_read_b128 a[116:119], v9 offset:35840
    ds_read_b128 a[120:123], v9 offset:51200
    ds_read_b128 a[124:127], v9 offset:52224
    s_waitcnt lgkmcnt(6)
    ds_read_b128 a[128:131], v10 offset:0
    ds_read_b128 a[132:135], v10 offset:1024
    ds_read_b128 a[136:139], v10 offset:16384
    ds_read_b128 a[140:143], v10 offset:17408
    ds_read_b128 a[144:147], v10 offset:32768
    ds_read_b128 a[148:151], v10 offset:33792
    ds_read_b128 a[152:155], v10 offset:49152
    ds_read_b128 a[156:159], v10 offset:50176
    s_waitcnt lgkmcnt(6)
    ds_read_b128 a[160:163], v10 offset:2048
    ds_read_b128 a[164:167], v10 offset:3072
    ds_read_b128 a[168:171], v10 offset:18432
    ds_read_b128 a[172:175], v10 offset:19456
    ds_read_b128 a[176:179], v10 offset:34816
    ds_read_b128 a[180:183], v10 offset:35840
    ds_read_b128 a[184:187], v10 offset:51200
    ds_read_b128 a[188:191], v10 offset:52224
    s_waitcnt lgkmcnt(6)
    ds_read_b128 a[192:195], v11 offset:0
    ds_read_b128 a[196:199], v11 offset:1024
    ds_read_b128 a[200:203], v11 offset:16384
    ds_read_b128 a[204:207], v11 offset:17408
    ds_read_b128 a[208:211], v11 offset:32768
    ds_read_b128 a[212:215], v11 offset:33792
    ds_read_b128 a[216:219], v11 offset:49152
    ds_read_b128 a[220:223], v11 offset:50176
    s_waitcnt lgkmcnt(6)
    ds_read_b128 a[224:227], v11 offset:2048
    ds_read_b128 a[228:231], v11 offset:3072
    ds_read_b128 a[232:235], v11 offset:18432
    ds_read_b128 a[236:239], v11 offset:19456
    ds_read_b128 a[240:243], v11 offset:34816
    ds_read_b128 a[244:247], v11 offset:35840
    ds_read_b128 a[248:251], v11 offset:51200
    ds_read_b128 a[252:255], v11 offset:52224
    s_waitcnt lgkmcnt(6)
L_rb_9:
    s_waitcnt vmcnt(8)
    s_waitcnt lgkmcnt(0)
    s_barrier
    v_perm_b32 v16, v196, v192, s28
    v_perm_b32 v17, v204, v200, s28
    v_perm_b32 v18, v212, v208, s28
    v_perm_b32 v19, v220, v216, s28
    ds_write_b128 v12, v[16:19] offset:0
    v_perm_b32 v20, v196, v192, s29
    v_perm_b32 v21, v204, v200, s29
    v_perm_b32 v22, v212, v208, s29
    v_perm_b32 v23, v220, v216, s29
    ds_write_b128 v12, v[20:23] offset:8192
    v_perm_b32 v24, v197, v193, s28
    v_perm_b32 v25, v205, v201, s28
    v_perm_b32 v26, v213, v209, s28
    v_perm_b32 v27, v221, v217, s28
    ds_write_b128 v13, v[24:27] offset:0
    v_perm_b32 v28, v197, v193, s29
    v_perm_b32 v29, v205, v201, s29
    v_perm_b32 v30, v213, v209, s29
    v_perm_b32 v31, v221, v217, s29
    ds_write_b128 v13, v[28:31] offset:8192
    v_perm_b32 v32, v198, v194, s28
    v_perm_b32 v33, v206, v202, s28
    v_perm_b32 v34, v214, v210, s28
    v_perm_b32 v35, v222, v218, s28
    ds_write_b128 v14, v[32:35] offset:0
    v_perm_b32 v36, v198, v194, s29
    v_perm_b32 v37, v206, v202, s29
    v_perm_b32 v38, v214, v210, s29
    v_perm_b32 v39, v222, v218, s29
    ds_write_b128 v14, v[36:39] offset:8192
    v_perm_b32 v40, v199, v195, s28
    v_perm_b32 v41, v207, v203, s28
    v_perm_b32 v42, v215, v211, s28
    v_perm_b32 v43, v223, v219, s28
    ds_write_b128 v15, v[40:43] offset:0
    v_perm_b32 v44, v199, v195, s29
    v_perm_b32 v45, v207, v203, s29
    v_perm_b32 v46, v215, v211, s29
    v_perm_b32 v47, v223, v219, s29
    ds_write_b128 v15, v[44:47] offset:8192
    s_add_u32 s22, s21, 524288
    buffer_load_dwordx4 v[48:51], v3, s[88:91], s22 offen
    s_add_u32 s22, s21, 532480
    buffer_load_dwordx4 v[52:55], v3, s[88:91], s22 offen
    s_add_u32 s22, s21, 540672
    buffer_load_dwordx4 v[56:59], v3, s[88:91], s22 offen
    s_add_u32 s22, s21, 548864
    buffer_load_dwordx4 v[60:63], v3, s[88:91], s22 offen
    s_add_u32 s22, s21, 557056
    buffer_load_dwordx4 v[64:67], v3, s[88:91], s22 offen
    s_add_u32 s22, s21, 565248
    buffer_load_dwordx4 v[68:71], v3, s[88:91], s22 offen
    s_add_u32 s22, s21, 573440
    buffer_load_dwordx4 v[72:75], v3, s[88:91], s22 offen
    s_add_u32 s22, s21, 581632
    buffer_load_dwordx4 v[76:79], v3, s[88:91], s22 offen
    s_waitcnt vmcnt(8)
    s_waitcnt lgkmcnt(0)
    v_perm_b32 v16, v228, v224, s28
    v_perm_b32 v17, v236, v232, s28
    v_perm_b32 v18, v244, v240, s28
    v_perm_b32 v19, v252, v248, s28
    ds_write_b128 v12, v[16:19] offset:4096
    v_perm_b32 v20, v228, v224, s29
    v_perm_b32 v21, v236, v232, s29
    v_perm_b32 v22, v244, v240, s29
    v_perm_b32 v23, v252, v248, s29
    ds_write_b128 v12, v[20:23] offset:12288
    v_perm_b32 v24, v229, v225, s28
    v_perm_b32 v25, v237, v233, s28
    v_perm_b32 v26, v245, v241, s28
    v_perm_b32 v27, v253, v249, s28
    ds_write_b128 v13, v[24:27] offset:4096
    v_perm_b32 v28, v229, v225, s29
    v_perm_b32 v29, v237, v233, s29
    v_perm_b32 v30, v245, v241, s29
    v_perm_b32 v31, v253, v249, s29
    ds_write_b128 v13, v[28:31] offset:12288
    v_perm_b32 v32, v230, v226, s28
    v_perm_b32 v33, v238, v234, s28
    v_perm_b32 v34, v246, v242, s28
    v_perm_b32 v35, v254, v250, s28
    ds_write_b128 v14, v[32:35] offset:4096
    v_perm_b32 v36, v230, v226, s29
    v_perm_b32 v37, v238, v234, s29
    v_perm_b32 v38, v246, v242, s29
    v_perm_b32 v39, v254, v250, s29
    ds_write_b128 v14, v[36:39] offset:12288
    v_perm_b32 v40, v231, v227, s28
    v_perm_b32 v41, v239, v235, s28
    v_perm_b32 v42, v247, v243, s28
    v_perm_b32 v43, v255, v251, s28
    ds_write_b128 v15, v[40:43] offset:4096
    v_perm_b32 v44, v231, v227, s29
    v_perm_b32 v45, v239, v235, s29
    v_perm_b32 v46, v247, v243, s29
    v_perm_b32 v47, v255, v251, s29
    ds_write_b128 v15, v[44:47] offset:12288
    s_add_u32 s22, s21, 786432
    buffer_load_dwordx4 v[80:83], v3, s[88:91], s22 offen
    s_add_u32 s22, s21, 794624
    buffer_load_dwordx4 v[84:87], v3, s[88:91], s22 offen
    s_add_u32 s22, s21, 802816
    buffer_load_dwordx4 v[88:91], v3, s[88:91], s22 offen
    s_add_u32 s22, s21, 811008
    buffer_load_dwordx4 v[92:95], v3, s[88:91], s22 offen
    s_add_u32 s22, s21, 819200
    buffer_load_dwordx4 v[96:99], v3, s[88:91], s22 offen
    s_add_u32 s22, s21, 827392
    buffer_load_dwordx4 v[100:103], v3, s[88:91], s22 offen
    s_add_u32 s22, s21, 835584
    buffer_load_dwordx4 v[104:107], v3, s[88:91], s22 offen
    s_add_u32 s22, s21, 843776
    buffer_load_dwordx4 v[108:111], v3, s[88:91], s22 offen
    s_add_u32 s34, s30, 7
    s_lshl_b32 s34, s34, 15
    s_lshl_b32 s19, s16, 13
    s_add_u32 s34, s34, s19
    buffer_load_dwordx4 v[112:115], v0, s[92:95], s34 offen offset:0
    buffer_load_dwordx4 v[112:115], v0, s[92:95], s34 offen offset:1024
    buffer_load_dwordx4 v[112:115], v0, s[92:95], s34 offen offset:2048
    buffer_load_dwordx4 v[112:115], v0, s[92:95], s34 offen offset:3072
    s_add_u32 s34, s34, 4096
    buffer_load_dwordx4 v[112:115], v0, s[92:95], s34 offen offset:0
    buffer_load_dwordx4 v[112:115], v0, s[92:95], s34 offen offset:1024
    buffer_load_dwordx4 v[112:115], v0, s[92:95], s34 offen offset:2048
    buffer_load_dwordx4 v[112:115], v0, s[92:95], s34 offen offset:3072
    s_waitcnt vmcnt(16)
    s_waitcnt lgkmcnt(0)
    v_perm_b32 v16, v52, v48, s28
    v_perm_b32 v17, v60, v56, s28
    v_perm_b32 v18, v68, v64, s28
    v_perm_b32 v19, v76, v72, s28
    ds_write_b128 v12, v[16:19] offset:16384
    v_perm_b32 v20, v52, v48, s29
    v_perm_b32 v21, v60, v56, s29
    v_perm_b32 v22, v68, v64, s29
    v_perm_b32 v23, v76, v72, s29
    ds_write_b128 v12, v[20:23] offset:24576
    v_perm_b32 v24, v53, v49, s28
    v_perm_b32 v25, v61, v57, s28
    v_perm_b32 v26, v69, v65, s28
    v_perm_b32 v27, v77, v73, s28
    ds_write_b128 v13, v[24:27] offset:16384
    v_perm_b32 v28, v53, v49, s29
    v_perm_b32 v29, v61, v57, s29
    v_perm_b32 v30, v69, v65, s29
    v_perm_b32 v31, v77, v73, s29
    ds_write_b128 v13, v[28:31] offset:24576
    v_perm_b32 v32, v54, v50, s28
    v_perm_b32 v33, v62, v58, s28
    v_perm_b32 v34, v70, v66, s28
    v_perm_b32 v35, v78, v74, s28
    ds_write_b128 v14, v[32:35] offset:16384
    v_perm_b32 v36, v54, v50, s29
    v_perm_b32 v37, v62, v58, s29
    v_perm_b32 v38, v70, v66, s29
    v_perm_b32 v39, v78, v74, s29
    ds_write_b128 v14, v[36:39] offset:24576
    v_perm_b32 v40, v55, v51, s28
    v_perm_b32 v41, v63, v59, s28
    v_perm_b32 v42, v71, v67, s28
    v_perm_b32 v43, v79, v75, s28
    ds_write_b128 v15, v[40:43] offset:16384
    v_perm_b32 v44, v55, v51, s29
    v_perm_b32 v45, v63, v59, s29
    v_perm_b32 v46, v71, v67, s29
    v_perm_b32 v47, v79, v75, s29
    ds_write_b128 v15, v[44:47] offset:24576
    s_waitcnt vmcnt(8)
    s_waitcnt lgkmcnt(0)
    v_perm_b32 v16, v84, v80, s28
    v_perm_b32 v17, v92, v88, s28
    v_perm_b32 v18, v100, v96, s28
    v_perm_b32 v19, v108, v104, s28
    ds_write_b128 v12, v[16:19] offset:20480
    v_perm_b32 v20, v84, v80, s29
    v_perm_b32 v21, v92, v88, s29
    v_perm_b32 v22, v100, v96, s29
    v_perm_b32 v23, v108, v104, s29
    ds_write_b128 v12, v[20:23] offset:28672
    v_perm_b32 v24, v85, v81, s28
    v_perm_b32 v25, v93, v89, s28
    v_perm_b32 v26, v101, v97, s28
    v_perm_b32 v27, v109, v105, s28
    ds_write_b128 v13, v[24:27] offset:20480
    v_perm_b32 v28, v85, v81, s29
    v_perm_b32 v29, v93, v89, s29
    v_perm_b32 v30, v101, v97, s29
    v_perm_b32 v31, v109, v105, s29
    ds_write_b128 v13, v[28:31] offset:28672
    v_perm_b32 v32, v86, v82, s28
    v_perm_b32 v33, v94, v90, s28
    v_perm_b32 v34, v102, v98, s28
    v_perm_b32 v35, v110, v106, s28
    ds_write_b128 v14, v[32:35] offset:20480
    v_perm_b32 v36, v86, v82, s29
    v_perm_b32 v37, v94, v90, s29
    v_perm_b32 v38, v102, v98, s29
    v_perm_b32 v39, v110, v106, s29
    ds_write_b128 v14, v[36:39] offset:28672
    v_perm_b32 v40, v87, v83, s28
    v_perm_b32 v41, v95, v91, s28
    v_perm_b32 v42, v103, v99, s28
    v_perm_b32 v43, v111, v107, s28
    ds_write_b128 v15, v[40:43] offset:20480
    v_perm_b32 v44, v87, v83, s29
    v_perm_b32 v45, v95, v91, s29
    v_perm_b32 v46, v103, v99, s29
    v_perm_b32 v47, v111, v107, s29
    ds_write_b128 v15, v[44:47] offset:28672
    s_waitcnt lgkmcnt(0)
    s_barrier
    ds_read_b128 v[128:131], v7 offset:0
    ds_read_b128 v[132:135], v7 offset:4096
    ds_read_b128 v[136:139], v7 offset:8192
    ds_read_b128 v[140:143], v7 offset:12288
    ds_read_b128 v[144:147], v7 offset:16384
    ds_read_b128 v[148:151], v7 offset:20480
    ds_read_b128 v[152:155], v7 offset:24576
    ds_read_b128 v[156:159], v7 offset:28672
    s_waitcnt lgkmcnt(6)
    ds_read_b128 v[160:163], v7 offset:1024
    ds_read_b128 v[164:167], v7 offset:5120
    ds_read_b128 v[168:171], v7 offset:9216
    ds_read_b128 v[172:175], v7 offset:13312
    ds_read_b128 v[176:179], v7 offset:17408
    ds_read_b128 v[180:183], v7 offset:21504
    ds_read_b128 v[184:187], v7 offset:25600
    ds_read_b128 v[188:191], v7 offset:29696
    s_waitcnt lgkmcnt(6)
    ds_read_b128 v[192:195], v7 offset:2048
    ds_read_b128 v[196:199], v7 offset:6144
    ds_read_b128 v[200:203], v7 offset:10240
    ds_read_b128 v[204:207], v7 offset:14336
    ds_read_b128 v[208:211], v7 offset:18432
    ds_read_b128 v[212:215], v7 offset:22528
    ds_read_b128 v[216:219], v7 offset:26624
    ds_read_b128 v[220:223], v7 offset:30720
    s_waitcnt lgkmcnt(6)
    ds_read_b128 v[224:227], v7 offset:3072
    ds_read_b128 v[228:231], v7 offset:7168
    ds_read_b128 v[232:235], v7 offset:11264
    ds_read_b128 v[236:239], v7 offset:15360
    ds_read_b128 v[240:243], v7 offset:19456
    ds_read_b128 v[244:247], v7 offset:23552
    ds_read_b128 v[248:251], v7 offset:27648
    ds_read_b128 v[252:255], v7 offset:31744
    s_waitcnt lgkmcnt(6)
    s_waitcnt lgkmcnt(0)
    s_barrier
    s_mov_b32 s84, s46
    s_and_b32 s85, s47, 0xffff
    s_mov_b32 s86, 0x200000
    s_mov_b32 s87, 0x20000
    s_mul_i32 s32, s16, 8448
    s_add_u32 s33, s32, 0
    s_add_u32 s34, s30, 0
    s_lshl_b32 s34, s34, 15
    s_lshl_b32 s19, s16, 13
    s_add_u32 s34, s34, s19
    s_mov_b32 m0, s33
    s_nop 0
    buffer_load_dwordx4 v0, s[84:87], s34 offen offset:0 lds
    s_add_u32 m0, m0, 32
    s_nop 0
    buffer_load_dwordx4 v0, s[84:87], s34 offen offset:1024 lds
    s_add_u32 m0, m0, 32
    s_nop 0
    buffer_load_dwordx4 v0, s[84:87], s34 offen offset:2048 lds
    s_add_u32 m0, m0, 32
    s_nop 0
    buffer_load_dwordx4 v0, s[84:87], s34 offen offset:3072 lds
    s_add_u32 m0, m0, 4128
    s_add_u32 s34, s34, 4096
    buffer_load_dwordx4 v0, s[84:87], s34 offen offset:0 lds
    s_add_u32 m0, m0, 32
    s_nop 0
    buffer_load_dwordx4 v0, s[84:87], s34 offen offset:1024 lds
    s_add_u32 m0, m0, 32
    s_nop 0
    buffer_load_dwordx4 v0, s[84:87], s34 offen offset:2048 lds
    s_add_u32 m0, m0, 32
    s_nop 0
    buffer_load_dwordx4 v0, s[84:87], s34 offen offset:3072 lds
    s_add_u32 s33, s32, 33792
    s_add_u32 s34, s30, 7
    s_lshl_b32 s34, s34, 15
    s_lshl_b32 s19, s16, 13
    s_add_u32 s34, s34, s19
    s_mov_b32 m0, s33
    s_nop 0
    buffer_load_dwordx4 v0, s[84:87], s34 offen offset:0 lds
    s_add_u32 m0, m0, 32
    s_nop 0
    buffer_load_dwordx4 v0, s[84:87], s34 offen offset:1024 lds
    s_add_u32 m0, m0, 32
    s_nop 0
    buffer_load_dwordx4 v0, s[84:87], s34 offen offset:2048 lds
    s_add_u32 m0, m0, 32
    s_nop 0
    buffer_load_dwordx4 v0, s[84:87], s34 offen offset:3072 lds
    s_add_u32 m0, m0, 4128
    s_add_u32 s34, s34, 4096
    buffer_load_dwordx4 v0, s[84:87], s34 offen offset:0 lds
    s_add_u32 m0, m0, 32
    s_nop 0
    buffer_load_dwordx4 v0, s[84:87], s34 offen offset:1024 lds
    s_add_u32 m0, m0, 32
    s_nop 0
    buffer_load_dwordx4 v0, s[84:87], s34 offen offset:2048 lds
    s_add_u32 m0, m0, 32
    s_nop 0
    buffer_load_dwordx4 v0, s[84:87], s34 offen offset:3072 lds
    v_mov_b32 v20, 0
L_ww_10:
    buffer_load_dword v21, v20, s[12:15], 44 offen sc1
    s_waitcnt vmcnt(0)
    v_readfirstlane_b32 s19, v21
    s_nop 0
    s_cmp_ge_u32 s19, 32
    s_cbranch_scc1 L_wd_11
    s_add_u32 s71, s71, 1
    s_cmp_gt_u32 s71, 0x200000
    s_cbranch_scc1 L_work_fail
    s_sleep 2
    s_branch L_ww_10
L_wd_11:
    s_barrier
    v_lshrrev_b32 v20, 4, v0
    v_lshrrev_b32 v21, 4, v20
    v_and_b32 v20, 15, v20
    v_mul_u32_u24 v4, 1056, v20
    v_lshl_add_u32 v4, v21, 4, v4
    s_lshl_b32 s19, s16, 10
    v_add_u32 v22, s19, v0
    v_mov_b32 v2, 0x7f000000
    v_cmp_eq_u32 vcc, 0, v22
    s_nop 1
    v_cndmask_b32 v2, v2, 0, vcc
    v_mov_b32 v3, 1
    s_add_u32 s33, s32, 67584
    s_mov_b32 s32, 0
    s_mov_b32 s37, 0x7f000000
L_p1_top:
    v_add_u32 v1, s32, v4
    s_add_u32 s34, s30, 14
    s_lshl_b32 s34, s34, 15
    s_lshl_b32 s19, s16, 13
    s_add_u32 s34, s34, s19
    ds_read_b128 v[16:19], v1 offset:0
    ds_read_b128 v[20:23], v1 offset:16896
    ds_read_b128 v[24:27], v1 offset:64
    ds_read_b128 v[28:31], v1 offset:16960
    s_waitcnt lgkmcnt(2)
    v_mfma_f32_16x16x32_bf16 v[48:51], a[0:3], v[16:19], 0
    ds_read_b128 v[32:35], v1 offset:128
    v_mfma_f32_16x16x32_bf16 v[56:59], a[8:11], v[16:19], 0
    ds_read_b128 v[36:39], v1 offset:17024
    v_mfma_f32_16x16x32_bf16 v[64:67], a[16:19], v[16:19], 0
    v_mfma_f32_16x16x32_bf16 v[72:75], a[24:27], v[16:19], 0
    v_mfma_f32_16x16x32_bf16 v[80:83], v[16:19], v[128:131], 0
    v_mfma_f32_16x16x32_bf16 v[88:91], v[16:19], v[136:139], 0
    v_mfma_f32_16x16x32_bf16 v[52:55], a[0:3], v[20:23], 0
    v_mfma_f32_16x16x32_bf16 v[60:63], a[8:11], v[20:23], 0
    v_mfma_f32_16x16x32_bf16 v[68:71], a[16:19], v[20:23], 0
    v_mfma_f32_16x16x32_bf16 v[76:79], a[24:27], v[20:23], 0
    v_mfma_f32_16x16x32_bf16 v[84:87], v[20:23], v[128:131], 0
    v_mfma_f32_16x16x32_bf16 v[92:95], v[20:23], v[136:139], 0
    s_waitcnt lgkmcnt(2)
    v_mfma_f32_16x16x32_bf16 v[48:51], a[4:7], v[24:27], v[48:51]
    ds_read_b128 v[16:19], v1 offset:192
    v_mfma_f32_16x16x32_bf16 v[56:59], a[12:15], v[24:27], v[56:59]
    ds_read_b128 v[20:23], v1 offset:17088
    v_mfma_f32_16x16x32_bf16 v[64:67], a[20:23], v[24:27], v[64:67]
    v_mfma_f32_16x16x32_bf16 v[72:75], a[28:31], v[24:27], v[72:75]
    v_mfma_f32_16x16x32_bf16 v[80:83], v[24:27], v[132:135], v[80:83]
    v_mfma_f32_16x16x32_bf16 v[88:91], v[24:27], v[140:143], v[88:91]
    v_mfma_f32_16x16x32_bf16 v[52:55], a[4:7], v[28:31], v[52:55]
    v_mfma_f32_16x16x32_bf16 v[60:63], a[12:15], v[28:31], v[60:63]
    v_mfma_f32_16x16x32_bf16 v[68:71], a[20:23], v[28:31], v[68:71]
    v_mfma_f32_16x16x32_bf16 v[76:79], a[28:31], v[28:31], v[76:79]
    v_mfma_f32_16x16x32_bf16 v[84:87], v[28:31], v[132:135], v[84:87]
    v_mfma_f32_16x16x32_bf16 v[92:95], v[28:31], v[140:143], v[92:95]
    s_waitcnt lgkmcnt(2)
    v_mfma_f32_16x16x32_bf16 v[48:51], a[32:35], v[32:35], v[48:51]
    ds_read_b128 v[24:27], v1 offset:256
    v_mfma_f32_16x16x32_bf16 v[56:59], a[40:43], v[32:35], v[56:59]
    ds_read_b128 v[28:31], v1 offset:17152
    v_mfma_f32_16x16x32_bf16 v[64:67], a[48:51], v[32:35], v[64:67]
    v_mfma_f32_16x16x32_bf16 v[72:75], a[56:59], v[32:35], v[72:75]
    v_mfma_f32_16x16x32_bf16 v[80:83], v[32:35], v[144:147], v[80:83]
    v_mfma_f32_16x16x32_bf16 v[88:91], v[32:35], v[152:155], v[88:91]
    v_mfma_f32_16x16x32_bf16 v[52:55], a[32:35], v[36:39], v[52:55]
    v_mfma_f32_16x16x32_bf16 v[60:63], a[40:43], v[36:39], v[60:63]
    v_mfma_f32_16x16x32_bf16 v[68:71], a[48:51], v[36:39], v[68:71]
    v_mfma_f32_16x16x32_bf16 v[76:79], a[56:59], v[36:39], v[76:79]
    v_mfma_f32_16x16x32_bf16 v[84:87], v[36:39], v[144:147], v[84:87]
    v_mfma_f32_16x16x32_bf16 v[92:95], v[36:39], v[152:155], v[92:95]
    s_waitcnt lgkmcnt(2)
    v_mfma_f32_16x16x32_bf16 v[48:51], a[36:39], v[16:19], v[48:51]
    ds_read_b128 v[32:35], v1 offset:320
    v_mfma_f32_16x16x32_bf16 v[56:59], a[44:47], v[16:19], v[56:59]
    ds_read_b128 v[36:39], v1 offset:17216
    v_mfma_f32_16x16x32_bf16 v[64:67], a[52:55], v[16:19], v[64:67]
    v_mfma_f32_16x16x32_bf16 v[72:75], a[60:63], v[16:19], v[72:75]
    v_mfma_f32_16x16x32_bf16 v[80:83], v[16:19], v[148:151], v[80:83]
    v_mfma_f32_16x16x32_bf16 v[88:91], v[16:19], v[156:159], v[88:91]
    v_mfma_f32_16x16x32_bf16 v[52:55], a[36:39], v[20:23], v[52:55]
    v_mfma_f32_16x16x32_bf16 v[60:63], a[44:47], v[20:23], v[60:63]
    v_mfma_f32_16x16x32_bf16 v[68:71], a[52:55], v[20:23], v[68:71]
    v_mfma_f32_16x16x32_bf16 v[76:79], a[60:63], v[20:23], v[76:79]
    v_mfma_f32_16x16x32_bf16 v[84:87], v[20:23], v[148:151], v[84:87]
    v_mfma_f32_16x16x32_bf16 v[92:95], v[20:23], v[156:159], v[92:95]
    s_waitcnt lgkmcnt(2)
    v_mfma_f32_16x16x32_bf16 v[48:51], a[64:67], v[24:27], v[48:51]
    ds_read_b128 v[16:19], v1 offset:384
    v_mfma_f32_16x16x32_bf16 v[56:59], a[72:75], v[24:27], v[56:59]
    ds_read_b128 v[20:23], v1 offset:17280
    v_mfma_f32_16x16x32_bf16 v[64:67], a[80:83], v[24:27], v[64:67]
    v_mfma_f32_16x16x32_bf16 v[72:75], a[88:91], v[24:27], v[72:75]
    s_waitcnt vmcnt(0)
    s_barrier
    buffer_store_dword v3, v2, s[8:11], s37 offen sc1
    v_mfma_f32_16x16x32_bf16 v[80:83], v[24:27], v[160:163], v[80:83]
    v_mfma_f32_16x16x32_bf16 v[88:91], v[24:27], v[168:171], v[88:91]
    v_mfma_f32_16x16x32_bf16 v[52:55], a[64:67], v[28:31], v[52:55]
    v_mfma_f32_16x16x32_bf16 v[60:63], a[72:75], v[28:31], v[60:63]
    v_mfma_f32_16x16x32_bf16 v[68:71], a[80:83], v[28:31], v[68:71]
    v_mfma_f32_16x16x32_bf16 v[76:79], a[88:91], v[28:31], v[76:79]
    v_mfma_f32_16x16x32_bf16 v[84:87], v[28:31], v[160:163], v[84:87]
    v_mfma_f32_16x16x32_bf16 v[92:95], v[28:31], v[168:171], v[92:95]
    s_waitcnt lgkmcnt(2)
    v_mfma_f32_16x16x32_bf16 v[48:51], a[68:71], v[32:35], v[48:51]
    ds_read_b128 v[24:27], v1 offset:448
    v_mfma_f32_16x16x32_bf16 v[56:59], a[76:79], v[32:35], v[56:59]
    ds_read_b128 v[28:31], v1 offset:17344
    v_mfma_f32_16x16x32_bf16 v[64:67], a[84:87], v[32:35], v[64:67]
    v_mfma_f32_16x16x32_bf16 v[72:75], a[92:95], v[32:35], v[72:75]
    v_mfma_f32_16x16x32_bf16 v[80:83], v[32:35], v[164:167], v[80:83]
    s_mov_b32 m0, s33
    s_nop 0
    buffer_load_dwordx4 v0, s[84:87], s34 offen offset:0 lds
    v_mfma_f32_16x16x32_bf16 v[88:91], v[32:35], v[172:175], v[88:91]
    v_mfma_f32_16x16x32_bf16 v[52:55], a[68:71], v[36:39], v[52:55]
    v_mfma_f32_16x16x32_bf16 v[60:63], a[76:79], v[36:39], v[60:63]
    v_mfma_f32_16x16x32_bf16 v[68:71], a[84:87], v[36:39], v[68:71]
    v_mfma_f32_16x16x32_bf16 v[76:79], a[92:95], v[36:39], v[76:79]
    s_add_u32 m0, m0, 32
    s_nop 0
    buffer_load_dwordx4 v0, s[84:87], s34 offen offset:1024 lds
    v_mfma_f32_16x16x32_bf16 v[84:87], v[36:39], v[164:167], v[84:87]
    v_mfma_f32_16x16x32_bf16 v[92:95], v[36:39], v[172:175], v[92:95]
    s_waitcnt lgkmcnt(2)
    v_mfma_f32_16x16x32_bf16 v[48:51], a[96:99], v[16:19], v[48:51]
    ds_read_b128 v[32:35], v1 offset:512
    v_mfma_f32_16x16x32_bf16 v[56:59], a[104:107], v[16:19], v[56:59]
    ds_read_b128 v[36:39], v1 offset:17408
    v_mfma_f32_16x16x32_bf16 v[64:67], a[112:115], v[16:19], v[64:67]
    v_mfma_f32_16x16x32_bf16 v[72:75], a[120:123], v[16:19], v[72:75]
    v_mfma_f32_16x16x32_bf16 v[80:83], v[16:19], v[176:179], v[80:83]
    s_add_u32 m0, m0, 32
    s_nop 0
    buffer_load_dwordx4 v0, s[84:87], s34 offen offset:2048 lds
    v_mfma_f32_16x16x32_bf16 v[88:91], v[16:19], v[184:187], v[88:91]
    v_mfma_f32_16x16x32_bf16 v[52:55], a[96:99], v[20:23], v[52:55]
    v_mfma_f32_16x16x32_bf16 v[60:63], a[104:107], v[20:23], v[60:63]
    v_mfma_f32_16x16x32_bf16 v[68:71], a[112:115], v[20:23], v[68:71]
    v_mfma_f32_16x16x32_bf16 v[76:79], a[120:123], v[20:23], v[76:79]
    s_add_u32 m0, m0, 32
    s_nop 0
    buffer_load_dwordx4 v0, s[84:87], s34 offen offset:3072 lds
    v_mfma_f32_16x16x32_bf16 v[84:87], v[20:23], v[176:179], v[84:87]
    v_mfma_f32_16x16x32_bf16 v[92:95], v[20:23], v[184:187], v[92:95]
    s_waitcnt lgkmcnt(2)
    v_mfma_f32_16x16x32_bf16 v[48:51], a[100:103], v[24:27], v[48:51]
    ds_read_b128 v[16:19], v1 offset:576
    v_mfma_f32_16x16x32_bf16 v[56:59], a[108:111], v[24:27], v[56:59]
    ds_read_b128 v[20:23], v1 offset:17472
    v_mfma_f32_16x16x32_bf16 v[64:67], a[116:119], v[24:27], v[64:67]
    v_mfma_f32_16x16x32_bf16 v[72:75], a[124:127], v[24:27], v[72:75]
    v_mfma_f32_16x16x32_bf16 v[80:83], v[24:27], v[180:183], v[80:83]
    s_add_u32 m0, m0, 4128
    s_add_u32 s34, s34, 4096
    buffer_load_dwordx4 v0, s[84:87], s34 offen offset:0 lds
    v_mfma_f32_16x16x32_bf16 v[88:91], v[24:27], v[188:191], v[88:91]
    v_mfma_f32_16x16x32_bf16 v[52:55], a[100:103], v[28:31], v[52:55]
    v_mfma_f32_16x16x32_bf16 v[60:63], a[108:111], v[28:31], v[60:63]
    v_mfma_f32_16x16x32_bf16 v[68:71], a[116:119], v[28:31], v[68:71]
    v_mfma_f32_16x16x32_bf16 v[76:79], a[124:127], v[28:31], v[76:79]
    s_add_u32 m0, m0, 32
    s_nop 0
    buffer_load_dwordx4 v0, s[84:87], s34 offen offset:1024 lds
    v_mfma_f32_16x16x32_bf16 v[84:87], v[28:31], v[180:183], v[84:87]
    v_mfma_f32_16x16x32_bf16 v[92:95], v[28:31], v[188:191], v[92:95]
    s_waitcnt lgkmcnt(2)
    v_mfma_f32_16x16x32_bf16 v[48:51], a[128:131], v[32:35], v[48:51]
    ds_read_b128 v[24:27], v1 offset:640
    v_mfma_f32_16x16x32_bf16 v[56:59], a[136:139], v[32:35], v[56:59]
    ds_read_b128 v[28:31], v1 offset:17536
    v_mfma_f32_16x16x32_bf16 v[64:67], a[144:147], v[32:35], v[64:67]
    v_mfma_f32_16x16x32_bf16 v[72:75], a[152:155], v[32:35], v[72:75]
    v_mfma_f32_16x16x32_bf16 v[80:83], v[32:35], v[192:195], v[80:83]
    s_add_u32 m0, m0, 32
    s_nop 0
    buffer_load_dwordx4 v0, s[84:87], s34 offen offset:2048 lds
    v_mfma_f32_16x16x32_bf16 v[88:91], v[32:35], v[200:203], v[88:91]
    v_mfma_f32_16x16x32_bf16 v[52:55], a[128:131], v[36:39], v[52:55]
    v_mfma_f32_16x16x32_bf16 v[60:63], a[136:139], v[36:39], v[60:63]
    v_mfma_f32_16x16x32_bf16 v[68:71], a[144:147], v[36:39], v[68:71]
    v_mfma_f32_16x16x32_bf16 v[76:79], a[152:155], v[36:39], v[76:79]
    s_add_u32 m0, m0, 32
    s_nop 0
    buffer_load_dwordx4 v0, s[84:87], s34 offen offset:3072 lds
    v_mfma_f32_16x16x32_bf16 v[84:87], v[36:39], v[192:195], v[84:87]
    v_mfma_f32_16x16x32_bf16 v[92:95], v[36:39], v[200:203], v[92:95]
    s_waitcnt lgkmcnt(2)
    v_mfma_f32_16x16x32_bf16 v[48:51], a[132:135], v[16:19], v[48:51]
    ds_read_b128 v[32:35], v1 offset:704
    v_mfma_f32_16x16x32_bf16 v[56:59], a[140:143], v[16:19], v[56:59]
    ds_read_b128 v[36:39], v1 offset:17600
    v_mfma_f32_16x16x32_bf16 v[64:67], a[148:151], v[16:19], v[64:67]
    v_mfma_f32_16x16x32_bf16 v[72:75], a[156:159], v[16:19], v[72:75]
    v_mfma_f32_16x16x32_bf16 v[80:83], v[16:19], v[196:199], v[80:83]
    v_mfma_f32_16x16x32_bf16 v[88:91], v[16:19], v[204:207], v[88:91]
    v_mfma_f32_16x16x32_bf16 v[52:55], a[132:135], v[20:23], v[52:55]
    v_mfma_f32_16x16x32_bf16 v[60:63], a[140:143], v[20:23], v[60:63]
    v_mfma_f32_16x16x32_bf16 v[68:71], a[148:151], v[20:23], v[68:71]
    v_mfma_f32_16x16x32_bf16 v[76:79], a[156:159], v[20:23], v[76:79]
    v_mfma_f32_16x16x32_bf16 v[84:87], v[20:23], v[196:199], v[84:87]
    v_mfma_f32_16x16x32_bf16 v[92:95], v[20:23], v[204:207], v[92:95]
    s_waitcnt lgkmcnt(2)
    v_mfma_f32_16x16x32_bf16 v[48:51], a[160:163], v[24:27], v[48:51]
    ds_read_b128 v[16:19], v1 offset:768
    v_mfma_f32_16x16x32_bf16 v[56:59], a[168:171], v[24:27], v[56:59]
    ds_read_b128 v[20:23], v1 offset:17664
    v_mfma_f32_16x16x32_bf16 v[64:67], a[176:179], v[24:27], v[64:67]
    v_mfma_f32_16x16x32_bf16 v[72:75], a[184:187], v[24:27], v[72:75]
    v_mfma_f32_16x16x32_bf16 v[80:83], v[24:27], v[208:211], v[80:83]
    v_mfma_f32_16x16x32_bf16 v[88:91], v[24:27], v[216:219], v[88:91]
    v_mfma_f32_16x16x32_bf16 v[52:55], a[160:163], v[28:31], v[52:55]
    v_mfma_f32_16x16x32_bf16 v[60:63], a[168:171], v[28:31], v[60:63]
    v_mfma_f32_16x16x32_bf16 v[68:71], a[176:179], v[28:31], v[68:71]
    v_mfma_f32_16x16x32_bf16 v[76:79], a[184:187], v[28:31], v[76:79]
    v_mfma_f32_16x16x32_bf16 v[84:87], v[28:31], v[208:211], v[84:87]
    v_mfma_f32_16x16x32_bf16 v[92:95], v[28:31], v[216:219], v[92:95]
    s_waitcnt lgkmcnt(2)
    v_mfma_f32_16x16x32_bf16 v[48:51], a[164:167], v[32:35], v[48:51]
    ds_read_b128 v[24:27], v1 offset:832
    v_mfma_f32_16x16x32_bf16 v[56:59], a[172:175], v[32:35], v[56:59]
    ds_read_b128 v[28:31], v1 offset:17728
    v_mfma_f32_16x16x32_bf16 v[64:67], a[180:183], v[32:35], v[64:67]
    v_mfma_f32_16x16x32_bf16 v[72:75], a[188:191], v[32:35], v[72:75]
    v_mfma_f32_16x16x32_bf16 v[80:83], v[32:35], v[212:215], v[80:83]
    v_mfma_f32_16x16x32_bf16 v[88:91], v[32:35], v[220:223], v[88:91]
    v_mfma_f32_16x16x32_bf16 v[52:55], a[164:167], v[36:39], v[52:55]
    v_mfma_f32_16x16x32_bf16 v[60:63], a[172:175], v[36:39], v[60:63]
    v_mfma_f32_16x16x32_bf16 v[68:71], a[180:183], v[36:39], v[68:71]
    v_mfma_f32_16x16x32_bf16 v[76:79], a[188:191], v[36:39], v[76:79]
    v_mfma_f32_16x16x32_bf16 v[84:87], v[36:39], v[212:215], v[84:87]
    v_mfma_f32_16x16x32_bf16 v[92:95], v[36:39], v[220:223], v[92:95]
    s_waitcnt lgkmcnt(2)
    v_mfma_f32_16x16x32_bf16 v[48:51], a[192:195], v[16:19], v[48:51]
    ds_read_b128 v[32:35], v1 offset:896
    v_mfma_f32_16x16x32_bf16 v[56:59], a[200:203], v[16:19], v[56:59]
    ds_read_b128 v[36:39], v1 offset:17792
    v_mfma_f32_16x16x32_bf16 v[64:67], a[208:211], v[16:19], v[64:67]
    v_mfma_f32_16x16x32_bf16 v[72:75], a[216:219], v[16:19], v[72:75]
    v_mfma_f32_16x16x32_bf16 v[80:83], v[16:19], v[224:227], v[80:83]
    v_mfma_f32_16x16x32_bf16 v[88:91], v[16:19], v[232:235], v[88:91]
    v_mfma_f32_16x16x32_bf16 v[52:55], a[192:195], v[20:23], v[52:55]
    v_mfma_f32_16x16x32_bf16 v[60:63], a[200:203], v[20:23], v[60:63]
    v_mfma_f32_16x16x32_bf16 v[68:71], a[208:211], v[20:23], v[68:71]
    v_mfma_f32_16x16x32_bf16 v[76:79], a[216:219], v[20:23], v[76:79]
    v_mfma_f32_16x16x32_bf16 v[84:87], v[20:23], v[224:227], v[84:87]
    v_mfma_f32_16x16x32_bf16 v[92:95], v[20:23], v[232:235], v[92:95]
    s_waitcnt lgkmcnt(2)
    v_mfma_f32_16x16x32_bf16 v[48:51], a[196:199], v[24:27], v[48:51]
    ds_read_b128 v[16:19], v1 offset:960
    v_mfma_f32_16x16x32_bf16 v[56:59], a[204:207], v[24:27], v[56:59]
    ds_read_b128 v[20:23], v1 offset:17856
    v_mfma_f32_16x16x32_bf16 v[64:67], a[212:215], v[24:27], v[64:67]
    v_mfma_f32_16x16x32_bf16 v[72:75], a[220:223], v[24:27], v[72:75]
    v_mfma_f32_16x16x32_bf16 v[80:83], v[24:27], v[228:231], v[80:83]
    v_mfma_f32_16x16x32_bf16 v[88:91], v[24:27], v[236:239], v[88:91]
    v_mfma_f32_16x16x32_bf16 v[52:55], a[196:199], v[28:31], v[52:55]
    v_mfma_f32_16x16x32_bf16 v[60:63], a[204:207], v[28:31], v[60:63]
    v_mfma_f32_16x16x32_bf16 v[68:71], a[212:215], v[28:31], v[68:71]
    v_mfma_f32_16x16x32_bf16 v[76:79], a[220:223], v[28:31], v[76:79]
    v_mfma_f32_16x16x32_bf16 v[84:87], v[28:31], v[228:231], v[84:87]
    v_mfma_f32_16x16x32_bf16 v[92:95], v[28:31], v[236:239], v[92:95]
    s_waitcnt lgkmcnt(2)
    v_mfma_f32_16x16x32_bf16 v[48:51], a[224:227], v[32:35], v[48:51]
    v_mfma_f32_16x16x32_bf16 v[56:59], a[232:235], v[32:35], v[56:59]
    v_mfma_f32_16x16x32_bf16 v[64:67], a[240:243], v[32:35], v[64:67]
    v_mfma_f32_16x16x32_bf16 v[72:75], a[248:251], v[32:35], v[72:75]
    v_mfma_f32_16x16x32_bf16 v[80:83], v[32:35], v[240:243], v[80:83]
    v_mfma_f32_16x16x32_bf16 v[88:91], v[32:35], v[248:251], v[88:91]
    v_mfma_f32_16x16x32_bf16 v[52:55], a[224:227], v[36:39], v[52:55]
    v_mfma_f32_16x16x32_bf16 v[60:63], a[232:235], v[36:39], v[60:63]
    v_mfma_f32_16x16x32_bf16 v[68:71], a[240:243], v[36:39], v[68:71]
    v_mfma_f32_16x16x32_bf16 v[76:79], a[248:251], v[36:39], v[76:79]
    v_mfma_f32_16x16x32_bf16 v[84:87], v[36:39], v[240:243], v[84:87]
    v_mfma_f32_16x16x32_bf16 v[92:95], v[36:39], v[248:251], v[92:95]
    s_waitcnt lgkmcnt(0)
    v_mfma_f32_16x16x32_bf16 v[48:51], a[228:231], v[16:19], v[48:51]
    v_mfma_f32_16x16x32_bf16 v[56:59], a[236:239], v[16:19], v[56:59]
    v_mfma_f32_16x16x32_bf16 v[64:67], a[244:247], v[16:19], v[64:67]
    v_mfma_f32_16x16x32_bf16 v[72:75], a[252:255], v[16:19], v[72:75]
    v_mfma_f32_16x16x32_bf16 v[80:83], v[16:19], v[244:247], v[80:83]
    v_mfma_f32_16x16x32_bf16 v[88:91], v[16:19], v[252:255], v[88:91]
    v_mfma_f32_16x16x32_bf16 v[52:55], a[228:231], v[20:23], v[52:55]
    v_mfma_f32_16x16x32_bf16 v[60:63], a[236:239], v[20:23], v[60:63]
    v_mfma_f32_16x16x32_bf16 v[68:71], a[244:247], v[20:23], v[68:71]
    v_mfma_f32_16x16x32_bf16 v[76:79], a[252:255], v[20:23], v[76:79]
    v_mfma_f32_16x16x32_bf16 v[84:87], v[20:23], v[244:247], v[84:87]
    v_mfma_f32_16x16x32_bf16 v[92:95], v[20:23], v[252:255], v[92:95]
    s_lshl_b32 s19, s30, 5
    s_add_u32 s19, s19, s17
    s_lshl_b32 s35, s19, 14
    s_lshl_b32 s36, s19, 13
    s_add_u32 s36, s36, 33554432
    s_cmp_lt_u32 s16, 2
    s_cselect_b32 s36, s36, s35
    s_and_b32 s19, s16, 1
    s_lshl_b32 s19, s19, 11
    s_add_u32 s36, s36, s19
    s_add_u32 s20, s36, 4096
    s_lshl_b32 s19, s16, 11
    s_add_u32 s35, s35, s19
    s_add_u32 s35, s35, 8192
    v_cvt_pk_bf16_f32 v96, v48, v56
    v_cvt_pk_bf16_f32 v97, v64, v72
    v_cvt_pk_bf16_f32 v98, v49, v57
    v_cvt_pk_bf16_f32 v99, v65, v73
    buffer_store_dwordx4 v[96:99], v0, s[8:11], s36 offen offset:0 sc1
    v_cvt_pk_bf16_f32 v100, v50, v58
    v_cvt_pk_bf16_f32 v101, v66, v74
    v_cvt_pk_bf16_f32 v102, v51, v59
    v_cvt_pk_bf16_f32 v103, v67, v75
    buffer_store_dwordx4 v[100:103], v0, s[8:11], s36 offen offset:1024 sc1
    v_cvt_pk_bf16_f32 v104, v52, v60
    v_cvt_pk_bf16_f32 v105, v68, v76
    v_cvt_pk_bf16_f32 v106, v53, v61
    v_cvt_pk_bf16_f32 v107, v69, v77
    buffer_store_dwordx4 v[104:107], v0, s[8:11], s20 offen offset:0 sc1
    v_cvt_pk_bf16_f32 v108, v54, v62
    v_cvt_pk_bf16_f32 v109, v70, v78
    v_cvt_pk_bf16_f32 v110, v55, v63
    v_cvt_pk_bf16_f32 v111, v71, v79
    buffer_store_dwordx4 v[108:111], v0, s[8:11], s20 offen offset:1024 sc1
    v_cvt_pk_bf16_f32 v112, v80, v81
    v_cvt_pk_bf16_f32 v113, v82, v83
    v_cvt_pk_bf16_f32 v114, v84, v85
    v_cvt_pk_bf16_f32 v115, v86, v87
    buffer_store_dwordx4 v[112:115], v0, s[8:11], s35 offen offset:0 sc1
    v_cvt_pk_bf16_f32 v116, v88, v89
    v_cvt_pk_bf16_f32 v117, v90, v91
    v_cvt_pk_bf16_f32 v118, v92, v93
    v_cvt_pk_bf16_f32 v119, v94, v95
    buffer_store_dwordx4 v[116:119], v0, s[8:11], s35 offen offset:1024 sc1
    s_lshl_b32 s37, s30, 2
    s_add_u32 s37, s37, s70
    s_add_u32 s32, s32, 33792
    s_cmp_ge_u32 s32, 101376
    s_cselect_b32 s32, 0, s32
    s_add_u32 s33, s33, 33792
    s_sub_u32 s19, s33, 101376
    s_cmp_ge_u32 s33, 101376
    s_cselect_b32 s33, s19, s33
    s_add_u32 s30, s30, 7
    s_cmp_lt_u32 s30, 64
    s_cbranch_scc1 L_p1_top
    s_waitcnt vmcnt(0)
    s_barrier
    buffer_store_dword v3, v2, s[8:11], s37 offen sc1
    s_cmp_ge_u32 s18, 3
    s_cbranch_scc1 L_partA
    v_lshrrev_b32 v20, 4, v0
    v_lshrrev_b32 v21, 4, v20
    v_and_b32 v20, 15, v20
    v_bfe_u32 v22, v20, 1, 1
    v_lshrrev_b32 v23, 2, v20
    v_and_b32 v24, 1, v20
    v_mov_b32 v25, 0xaaaa
    v_mul_u32_u24 v25, v25, v22
    v_add_u32 v4, 0x4444, v25
    v_lshrrev_b32 v25, 1, v21
    v_lshlrev_b32 v25, 8, v25
    v_lshl_add_u32 v25, v23, 6, v25
    v_and_b32 v26, 1, v21
    v_lshl_add_u32 v25, v26, 5, v25
    v_lshl_add_u32 v25, v24, 4, v25
    v_lshl_add_u32 v5, v22, 2, v25
    v_add_u32 v6, 8, v5
    v_lshl_add_u32 v23, v23, 1, v24
    v_mul_u32_u24 v25, 272, v23
    v_lshl_add_u32 v25, v21, 5, v25
    v_add_u32 v8, 8192, v25
    v_mul_u32_u24 v25, 544, v21
    v_lshl_add_u32 v25, v20, 3, v25
    s_and_b32 s19, s16, 1
    s_lshl_b32 s19, s19, 7
    s_add_u32 s19, s19, 8192
    v_add_u32 v7, s19, v25
    v_lshlrev_b32 v25, 10, v23
    v_lshl_add_u32 v25, v21, 6, v25
    v_lshl_add_u32 v25, v22, 5, v25
    s_lshl_b32 s19, s16, 8
    v_add_u32 v9, s19, v25
    s_lshl_b32 s19, s16, 10
    v_add_u32 v10, s19, v0
    v_lshrrev_b32 v11, 2, v0
    v_lshlrev_b32 v25, 2, v21
    v_add_u32 v26, 0, v25
    v_cmp_le_u32 s[76:77], v26, v20
    v_add_u32 v26, 1, v25
    v_cmp_le_u32 s[78:79], v26, v20
    v_add_u32 v26, 2, v25
    v_cmp_le_u32 s[80:81], v26, v20
    v_add_u32 v26, 3, v25
    v_cmp_le_u32 s[82:83], v26, v20
    s_and_b32 s19, s16, 1
    s_lshl_b32 s19, s19, 15
    v_add_u32 v25, s19, v0
    s_cmp_lt_u32 s16, 2
    s_cbranch_scc1 L_at_rx
    ds_write_b128 v25, a[0:3] offset:0
    ds_write_b128 v25, a[4:7] offset:1024
    ds_write_b128 v25, a[8:11] offset:2048
    ds_write_b128 v25, a[12:15] offset:3072
    s_waitcnt lgkmcnt(4)
    ds_write_b128 v25, a[32:35] offset:4096
    ds_write_b128 v25, a[36:39] offset:5120
    ds_write_b128 v25, a[40:43] offset:6144
    ds_write_b128 v25, a[44:47] offset:7168
    s_waitcnt lgkmcnt(4)
    ds_write_b128 v25, a[64:67] offset:8192
    ds_write_b128 v25, a[68:71] offset:9216
    ds_write_b128 v25, a[72:75] offset:10240
    ds_write_b128 v25, a[76:79] offset:11264
    s_waitcnt lgkmcnt(4)
    ds_write_b128 v25, a[96:99] offset:12288
    ds_write_b128 v25, a[100:103] offset:13312
    ds_write_b128 v25, a[104:107] offset:14336
    ds_write_b128 v25, a[108:111] offset:15360
    s_waitcnt lgkmcnt(4)
    ds_write_b128 v25, a[128:131] offset:16384
    ds_write_b128 v25, a[132:135] offset:17408
    ds_write_b128 v25, a[136:139] offset:18432
    ds_write_b128 v25, a[140:143] offset:19456
    s_waitcnt lgkmcnt(4)
    ds_write_b128 v25, a[160:163] offset:20480
    ds_write_b128 v25, a[164:167] offset:21504
    ds_write_b128 v25, a[168:171] offset:22528
    ds_write_b128 v25, a[172:175] offset:23552
    s_waitcnt lgkmcnt(4)
    ds_write_b128 v25, a[192:195] offset:24576
    ds_write_b128 v25, a[196:199] offset:25600
    ds_write_b128 v25, a[200:203] offset:26624
    ds_write_b128 v25, a[204:207] offset:27648
    s_waitcnt lgkmcnt(4)
    ds_write_b128 v25, a[224:227] offset:28672
    ds_write_b128 v25, a[228:231] offset:29696
    ds_write_b128 v25, a[232:235] offset:30720
    ds_write_b128 v25, a[236:239] offset:31744
    s_waitcnt lgkmcnt(4)
    s_waitcnt lgkmcnt(0)
L_at_rx:
    s_barrier
    s_cbranch_scc0 L_at_rd
    ds_read_b128 a[16:19], v25 offset:0
    ds_read_b128 a[20:23], v25 offset:1024
    ds_read_b128 a[24:27], v25 offset:2048
    ds_read_b128 a[28:31], v25 offset:3072
    s_waitcnt lgkmcnt(4)
    ds_read_b128 a[48:51], v25 offset:4096
    ds_read_b128 a[52:55], v25 offset:5120
    ds_read_b128 a[56:59], v25 offset:6144
    ds_read_b128 a[60:63], v25 offset:7168
    s_waitcnt lgkmcnt(4)
    ds_read_b128 a[80:83], v25 offset:8192
    ds_read_b128 a[84:87], v25 offset:9216
    ds_read_b128 a[88:91], v25 offset:10240
    ds_read_b128 a[92:95], v25 offset:11264
    s_waitcnt lgkmcnt(4)
    ds_read_b128 a[112:115], v25 offset:12288
    ds_read_b128 a[116:119], v25 offset:13312
    ds_read_b128 a[120:123], v25 offset:14336
    ds_read_b128 a[124:127], v25 offset:15360
    s_waitcnt lgkmcnt(4)
    ds_read_b128 a[144:147], v25 offset:16384
    ds_read_b128 a[148:151], v25 offset:17408
    ds_read_b128 a[152:155], v25 offset:18432
    ds_read_b128 a[156:159], v25 offset:19456
    s_waitcnt lgkmcnt(4)
    ds_read_b128 a[176:179], v25 offset:20480
    ds_read_b128 a[180:183], v25 offset:21504
    ds_read_b128 a[184:187], v25 offset:22528
    ds_read_b128 a[188:191], v25 offset:23552
    s_waitcnt lgkmcnt(4)
    ds_read_b128 a[208:211], v25 offset:24576
    ds_read_b128 a[212:215], v25 offset:25600
    ds_read_b128 a[216:219], v25 offset:26624
    ds_read_b128 a[220:223], v25 offset:27648
    s_waitcnt lgkmcnt(4)
    ds_read_b128 a[240:243], v25 offset:28672
    ds_read_b128 a[244:247], v25 offset:29696
    ds_read_b128 a[248:251], v25 offset:30720
    ds_read_b128 a[252:255], v25 offset:31744
    s_waitcnt lgkmcnt(4)
    s_waitcnt lgkmcnt(0)
L_at_rd:
    s_barrier
    s_lshr_b32 s19, s16, 1
    s_lshl_b32 s19, s19, 2
    v_add_u32 v7, s19, v7
    s_mov_b32 s88, s48
    s_and_b32 s89, s49, 0xffff
    s_mov_b32 s90, 0x2000
    s_mov_b32 s91, 0x20000
    s_mov_b32 s68, 0x3e0293ee
    s_mov_b32 s100, 0x7f817f81
    s_mov_b64 s[66:67], 0
    s_mov_b32 s30, s18
L_at_top:
    s_bitcmp1_b64 s[66:67], s30
    s_cbranch_scc1 L_at_have
    buffer_load_dword v12, v11, s[8:11], s70 offen sc1
    s_waitcnt vmcnt(0)
    v_cmp_ne_u32 s[66:67], 0, v12
    s_add_u32 s71, s71, 1
    s_cmp_gt_u32 s71, 0x200000
    s_cbranch_scc1 L_work_fail
    s_sleep 2
    s_branch L_at_top
L_at_have:
    s_lshl_b32 s19, s30, 5
    s_add_u32 s19, s19, s17
    s_lshl_b32 s34, s19, 14
    s_lshl_b32 s35, s19, 13
    s_add_u32 s35, s35, 33554432
    buffer_load_dwordx4 v[96:99], v0, s[8:11], s34 offen offset:0 sc1
    buffer_load_dwordx4 v[32:35], v0, s[8:11], s35 offen offset:0 sc1
    buffer_load_dwordx4 v[100:103], v0, s[8:11], s34 offen offset:1024 sc1
    buffer_load_dwordx4 v[36:39], v0, s[8:11], s35 offen offset:1024 sc1
    buffer_load_dwordx4 v[104:107], v0, s[8:11], s34 offen offset:2048 sc1
    buffer_load_dwordx4 v[40:43], v0, s[8:11], s35 offen offset:2048 sc1
    buffer_load_dwordx4 v[108:111], v0, s[8:11], s34 offen offset:3072 sc1
    buffer_load_dwordx4 v[44:47], v0, s[8:11], s35 offen offset:3072 sc1
    s_add_u32 s34, s34, 4096
    s_add_u32 s35, s35, 4096
    buffer_load_dwordx4 v[112:115], v0, s[8:11], s34 offen offset:0 sc1
    buffer_load_dwordx4 v[48:51], v0, s[8:11], s35 offen offset:0 sc1
    buffer_load_dwordx4 v[116:119], v0, s[8:11], s34 offen offset:1024 sc1
    buffer_load_dwordx4 v[52:55], v0, s[8:11], s35 offen offset:1024 sc1
    buffer_load_dwordx4 v[120:123], v0, s[8:11], s34 offen offset:2048 sc1
    buffer_load_dwordx4 v[56:59], v0, s[8:11], s35 offen offset:2048 sc1
    buffer_load_dwordx4 v[124:127], v0, s[8:11], s34 offen offset:3072 sc1
    buffer_load_dwordx4 v[60:63], v0, s[8:11], s35 offen offset:3072 sc1
    s_add_u32 s34, s34, 4096
    s_add_u32 s35, s35, 4096
    s_lshl_b32 s19, s16, 11
    s_add_u32 s34, s34, s19
    buffer_load_dwordx4 v[88:91], v0, s[8:11], s34 offen offset:0 sc1
    buffer_load_dwordx4 v[92:95], v0, s[8:11], s34 offen offset:1024 sc1
    v_mov_b64 v[64:65], 0
    v_mov_b64 v[66:67], 0
    v_mov_b64 v[68:69], 0
    v_mov_b64 v[70:71], 0
    v_mov_b64 v[72:73], 0
    v_mov_b64 v[74:75], 0
    v_mov_b64 v[76:77], 0
    v_mov_b64 v[78:79], 0
    v_mov_b64 v[80:81], 0
    v_mov_b64 v[82:83], 0
    v_mov_b64 v[84:85], 0
    v_mov_b64 v[86:87], 0
    s_lshl_b32 s36, s30, 13
    s_add_u32 s36, s36, 50331648
    s_add_u32 s35, s36, 4096
    s_waitcnt vmcnt(2)
    v_mfma_f32_16x16x32_bf16 v[16:19], v[96:99], v[32:35], 0
    v_mfma_f32_16x16x32_bf16 v[20:23], v[96:99], v[48:51], 0
    v_mfma_f32_16x16x32_bf16 v[24:27], v[112:115], v[48:51], 0
    v_mfma_f32_16x16x32_bf16 v[16:19], v[100:103], v[36:39], v[16:19]
    v_mfma_f32_16x16x32_bf16 v[20:23], v[100:103], v[52:55], v[20:23]
    v_mfma_f32_16x16x32_bf16 v[24:27], v[116:119], v[52:55], v[24:27]
    v_mfma_f32_16x16x32_bf16 v[16:19], v[104:107], v[40:43], v[16:19]
    v_mfma_f32_16x16x32_bf16 v[20:23], v[104:107], v[56:59], v[20:23]
    v_mfma_f32_16x16x32_bf16 v[24:27], v[120:123], v[56:59], v[24:27]
    v_mfma_f32_16x16x32_bf16 v[16:19], v[108:111], v[44:47], v[16:19]
    v_mfma_f32_16x16x32_bf16 v[20:23], v[108:111], v[60:63], v[20:23]
    v_mfma_f32_16x16x32_bf16 v[24:27], v[124:127], v[60:63], v[24:27]
    v_mov_b32 v12, 0xd028965f
    s_nop 7
    v_cndmask_b32 v16, v12, v16, s[76:77]
    v_cndmask_b32 v24, v12, v24, s[76:77]
    v_cndmask_b32 v17, v12, v17, s[78:79]
    v_cndmask_b32 v25, v12, v25, s[78:79]
    v_cndmask_b32 v18, v12, v18, s[80:81]
    v_cndmask_b32 v26, v12, v26, s[80:81]
    v_cndmask_b32 v19, v12, v19, s[82:83]
    v_cndmask_b32 v27, v12, v27, s[82:83]
    v_max3_f32 v14, v16, v17, v18
    v_max_f32 v14, v14, v19
    v_max3_f32 v15, v20, v21, v22
    v_max3_f32 v15, v15, v23, v24
    v_max3_f32 v15, v15, v25, v26
    v_max_f32 v15, v15, v27
    s_cmp_lg_u32 s30, 0
    s_cbranch_scc1 L_at_poll
    buffer_load_dwordx2 v[96:97], v9, s[88:91], 0 offen offset:0
    buffer_load_dwordx2 v[98:99], v9, s[88:91], 0 offen offset:16
    buffer_load_dwordx2 v[100:101], v9, s[88:91], 0 offen offset:8
    buffer_load_dwordx2 v[102:103], v9, s[88:91], 0 offen offset:24
    s_waitcnt vmcnt(0)
    s_branch L_at_mem
L_at_again:
    s_add_u32 s71, s71, 1
    s_cmp_gt_u32 s71, 0x200000
    s_cbranch_scc1 L_work_fail
    s_sleep 1
L_at_poll:
    buffer_load_dwordx4 v[96:99], v10, s[8:11], s36 offen sc1
    buffer_load_dwordx4 v[100:103], v10, s[8:11], s35 offen sc1
    s_mov_b64 s[72:73], 0
    s_waitcnt vmcnt(0)
    v_cmp_eq_u32 vcc, s100, v96
    s_or_b64 s[72:73], s[72:73], vcc
    v_cmp_eq_u32 vcc, s100, v97
    s_or_b64 s[72:73], s[72:73], vcc
    v_cmp_eq_u32 vcc, s100, v98
    s_or_b64 s[72:73], s[72:73], vcc
    v_cmp_eq_u32 vcc, s100, v99
    s_or_b64 s[72:73], s[72:73], vcc
    v_cmp_eq_u32 vcc, s100, v100
    s_or_b64 s[72:73], s[72:73], vcc
    v_cmp_eq_u32 vcc, s100, v101
    s_or_b64 s[72:73], s[72:73], vcc
    v_cmp_eq_u32 vcc, s100, v102
    s_or_b64 s[72:73], s[72:73], vcc
    v_cmp_eq_u32 vcc, s100, v103
    s_or_b64 s[72:73], s[72:73], vcc
    s_cbranch_scc1 L_at_again
L_at_mem:
    ds_write_b128 v10, v[96:99] offset:0
    ds_write_b128 v10, v[100:103] offset:4096
    s_waitcnt lgkmcnt(0)
    s_barrier
    ds_read2st64_b32 v[96:97], v5 offset0:0 offset1:16
    ds_read2st64_b32 v[98:99], v6 offset0:0 offset1:16
    ds_read2st64_b32 v[100:101], v5 offset0:2 offset1:18
    ds_read2st64_b32 v[102:103], v6 offset0:2 offset1:18
    ds_read2st64_b32 v[104:105], v5 offset0:4 offset1:20
    ds_read2st64_b32 v[106:107], v6 offset0:4 offset1:20
    ds_read2st64_b32 v[108:109], v5 offset0:6 offset1:22
    ds_read2st64_b32 v[110:111], v6 offset0:6 offset1:22
    ds_read2st64_b32 v[112:113], v5 offset0:8 offset1:24
    ds_read2st64_b32 v[114:115], v6 offset0:8 offset1:24
    ds_read2st64_b32 v[116:117], v5 offset0:10 offset1:26
    ds_read2st64_b32 v[118:119], v6 offset0:10 offset1:26
    s_waitcnt lgkmcnt(10)
    v_smfmac_f32_16x16x64_bf16 v[64:67], v[96:99], a[16:23], v4
    v_smfmac_f32_16x16x64_bf16 v[68:71], v[96:99], a[24:31], v4
    ds_read2st64_b32 v[120:121], v5 offset0:12 offset1:28
    ds_read2st64_b32 v[122:123], v6 offset0:12 offset1:28
    s_waitcnt lgkmcnt(10)
    v_smfmac_f32_16x16x64_bf16 v[64:67], v[100:103], a[48:55], v4
    v_smfmac_f32_16x16x64_bf16 v[68:71], v[100:103], a[56:63], v4
    ds_read2st64_b32 v[124:125], v5 offset0:14 offset1:30
    ds_read2st64_b32 v[126:127], v6 offset0:14 offset1:30
    s_waitcnt lgkmcnt(10)
    v_smfmac_f32_16x16x64_bf16 v[64:67], v[104:107], a[80:87], v4
    v_smfmac_f32_16x16x64_bf16 v[68:71], v[104:107], a[88:95], v4
    s_waitcnt lgkmcnt(8)
    v_smfmac_f32_16x16x64_bf16 v[64:67], v[108:111], a[112:119], v4
    v_smfmac_f32_16x16x64_bf16 v[68:71], v[108:111], a[120:127], v4
    s_waitcnt lgkmcnt(6)
    v_smfmac_f32_16x16x64_bf16 v[64:67], v[112:115], a[144:151], v4
    v_smfmac_f32_16x16x64_bf16 v[68:71], v[112:115], a[152:159], v4
    s_waitcnt lgkmcnt(4)
    v_smfmac_f32_16x16x64_bf16 v[64:67], v[116:119], a[176:183], v4
    v_smfmac_f32_16x16x64_bf16 v[68:71], v[116:119], a[184:191], v4
    s_waitcnt lgkmcnt(2)
    v_smfmac_f32_16x16x64_bf16 v[64:67], v[120:123], a[208:215], v4
    v_smfmac_f32_16x16x64_bf16 v[68:71], v[120:123], a[216:223], v4
    s_waitcnt lgkmcnt(0)
    v_smfmac_f32_16x16x64_bf16 v[64:67], v[124:127], a[240:247], v4
    v_smfmac_f32_16x16x64_bf16 v[68:71], v[124:127], a[248:255], v4
    v_smfmac_f32_16x16x64_bf16 v[80:83], v[96:99], v[128:135], v4
    v_smfmac_f32_16x16x64_bf16 v[84:87], v[96:99], v[136:143], v4
    v_add_f32 v64, v64, v66
    v_add_f32 v65, v65, v67
    v_add_f32 v68, v68, v70
    v_add_f32 v69, v69, v71
    v_cvt_pk_bf16_f32 v28, v64, v68
    v_cvt_pk_bf16_f32 v29, v65, v69
    ds_write2_b32 v7, v28, v29 offset0:0 offset1:68
    v_smfmac_f32_16x16x64_bf16 v[80:83], v[100:103], v[144:151], v4
    v_smfmac_f32_16x16x64_bf16 v[84:87], v[100:103], v[152:159], v4
    v_smfmac_f32_16x16x64_bf16 v[80:83], v[104:107], v[160:167], v4
    v_smfmac_f32_16x16x64_bf16 v[84:87], v[104:107], v[168:175], v4
    v_smfmac_f32_16x16x64_bf16 v[80:83], v[108:111], v[176:183], v4
    s_waitcnt lgkmcnt(0)
    s_barrier
    ds_read_b128 v[64:67], v8 offset:0
    ds_read_b128 v[68:71], v8 offset:16
    ds_read_b128 v[72:75], v8 offset:128
    ds_read_b128 v[76:79], v8 offset:144
    v_smfmac_f32_16x16x64_bf16 v[84:87], v[108:111], v[184:191], v4
    v_smfmac_f32_16x16x64_bf16 v[80:83], v[112:115], v[192:199], v4
    v_smfmac_f32_16x16x64_bf16 v[84:87], v[112:115], v[200:207], v4
    v_smfmac_f32_16x16x64_bf16 v[80:83], v[116:119], v[208:215], v4
    v_smfmac_f32_16x16x64_bf16 v[84:87], v[116:119], v[216:223], v4
    v_smfmac_f32_16x16x64_bf16 v[80:83], v[120:123], v[224:231], v4
    v_smfmac_f32_16x16x64_bf16 v[84:87], v[120:123], v[232:239], v4
    v_smfmac_f32_16x16x64_bf16 v[80:83], v[124:127], v[240:247], v4
    v_smfmac_f32_16x16x64_bf16 v[84:87], v[124:127], v[248:255], v4
    s_waitcnt lgkmcnt(0)
    v_mfma_f32_16x16x32_bf16 v[96:99], v[64:67], v[32:35], 0
    v_mfma_f32_16x16x32_bf16 v[100:103], v[64:67], v[48:51], 0
    v_mfma_f32_16x16x32_bf16 v[96:99], v[68:71], v[36:39], v[96:99]
    v_mfma_f32_16x16x32_bf16 v[100:103], v[68:71], v[52:55], v[100:103]
    v_mfma_f32_16x16x32_bf16 v[96:99], v[72:75], v[40:43], v[96:99]
    v_mfma_f32_16x16x32_bf16 v[100:103], v[72:75], v[56:59], v[100:103]
    v_mfma_f32_16x16x32_bf16 v[96:99], v[76:79], v[44:47], v[96:99]
    v_mfma_f32_16x16x32_bf16 v[100:103], v[76:79], v[60:63], v[100:103]
    v_add_f32 v80, v80, v82
    v_add_f32 v81, v81, v83
    v_cvt_pk_bf16_f32 v104, v80, v81
    v_mov_b32 v105, 0
    v_add_f32 v84, v84, v86
    v_add_f32 v85, v85, v87
    v_cvt_pk_bf16_f32 v106, v84, v85
    v_mov_b32 v107, 0
    v_mov_b32 v108, 0x3f803f80
    v_mov_b32 v109, 0x3f803f80
    v_mov_b32 v110, 0x3f803f80
    v_mov_b32 v111, 0x3f803f80
    v_max3_f32 v14, v14, v96, v97
    v_max3_f32 v15, v15, v100, v101
    v_mov_b32 v12, v14
    v_mov_b32 v13, v15
    s_nop 0
    v_permlane32_swap_b32 v12, v14
    v_permlane32_swap_b32 v13, v15
    v_max_f32 v14, v14, v12
    v_max_f32 v15, v15, v13
    v_mov_b32 v12, v14
    v_mov_b32 v13, v15
    s_nop 0
    v_permlane16_swap_b32 v12, v14
    v_permlane16_swap_b32 v13, v15
    v_max_f32 v14, v14, v12
    v_max_f32 v15, v15, v13
    v_mul_f32 v14, s68, v14
    v_mul_f32 v15, s68, v15
    v_fma_f32 v96, v96, s68, -v14
    v_fma_f32 v97, v97, s68, -v14
    v_fma_f32 v16, v16, s68, -v14
    v_fma_f32 v17, v17, s68, -v14
    v_fma_f32 v18, v18, s68, -v14
    v_fma_f32 v19, v19, s68, -v14
    v_fma_f32 v100, v100, s68, -v15
    v_fma_f32 v101, v101, s68, -v15
    v_fma_f32 v20, v20, s68, -v15
    v_fma_f32 v21, v21, s68, -v15
    v_fma_f32 v22, v22, s68, -v15
    v_fma_f32 v23, v23, s68, -v15
    v_fma_f32 v24, v24, s68, -v15
    v_fma_f32 v25, v25, s68, -v15
    v_fma_f32 v26, v26, s68, -v15
    v_fma_f32 v27, v27, s68, -v15
    v_exp_f32 v96, v96
    v_exp_f32 v97, v97
    v_exp_f32 v16, v16
    v_exp_f32 v17, v17
    v_exp_f32 v18, v18
    v_exp_f32 v19, v19
    v_exp_f32 v100, v100
    v_exp_f32 v101, v101
    v_exp_f32 v20, v20
    v_exp_f32 v21, v21
    v_exp_f32 v22, v22
    v_exp_f32 v23, v23
    v_exp_f32 v24, v24
    v_exp_f32 v25, v25
    v_exp_f32 v26, v26
    v_exp_f32 v27, v27
    v_cvt_pk_bf16_f32 v112, v96, v97
    v_mov_b32 v113, 0
    v_cvt_pk_bf16_f32 v114, v100, v101
    v_mov_b32 v115, 0
    v_cvt_pk_bf16_f32 v116, v16, v17
    v_cvt_pk_bf16_f32 v117, v18, v19
    v_cvt_pk_bf16_f32 v120, v20, v21
    v_cvt_pk_bf16_f32 v121, v22, v23
    v_cvt_pk_bf16_f32 v122, v24, v25
    v_cvt_pk_bf16_f32 v123, v26, v27
    s_nop 1
    v_mfma_f32_16x16x16_bf16 v[32:35], v[108:109], v[112:113], 0
    v_mfma_f32_16x16x16_bf16 v[36:39], v[108:109], v[114:115], 0
    v_mfma_f32_16x16x16_bf16 v[40:43], v[104:105], v[112:113], 0
    v_mfma_f32_16x16x16_bf16 v[48:51], v[104:105], v[114:115], 0
    v_mfma_f32_16x16x16_bf16 v[44:47], v[106:107], v[112:113], 0
    v_mfma_f32_16x16x16_bf16 v[52:55], v[106:107], v[114:115], 0
    v_mfma_f32_16x16x16_bf16 v[32:35], v[108:109], v[116:117], v[32:35]
    v_mfma_f32_16x16x32_bf16 v[36:39], v[108:111], v[120:123], v[36:39]
    v_mfma_f32_16x16x16_bf16 v[40:43], v[88:89], v[116:117], v[40:43]
    v_mfma_f32_16x16x32_bf16 v[48:51], v[88:91], v[120:123], v[48:51]
    v_mfma_f32_16x16x16_bf16 v[44:47], v[92:93], v[116:117], v[44:47]
    v_mfma_f32_16x16x32_bf16 v[52:55], v[92:95], v[120:123], v[52:55]
    v_rcp_f32 v32, v32
    v_rcp_f32 v36, v36
    s_lshl_b32 s34, s30, 18
    s_lshl_b32 s19, s17, 12
    s_add_u32 s34, s34, s19
    s_add_u32 s34, s34, 67108864
    s_add_u32 s35, s34, 131072
    s_nop 3
    v_mul_f32 v40, v40, v32
    v_mul_f32 v41, v41, v32
    v_mul_f32 v42, v42, v32
    v_mul_f32 v43, v43, v32
    v_mul_f32 v44, v44, v32
    v_mul_f32 v45, v45, v32
    v_mul_f32 v46, v46, v32
    v_mul_f32 v47, v47, v32
    v_cvt_pk_bf16_f32 v56, v40, v41
    v_cvt_pk_bf16_f32 v57, v42, v43
    v_cvt_pk_bf16_f32 v58, v44, v45
    v_cvt_pk_bf16_f32 v59, v46, v47
    buffer_store_dwordx4 v[56:59], v10, s[8:11], s34 offen sc1
    v_mul_f32 v48, v48, v36
    v_mul_f32 v49, v49, v36
    v_mul_f32 v50, v50, v36
    v_mul_f32 v51, v51, v36
    v_mul_f32 v52, v52, v36
    v_mul_f32 v53, v53, v36
    v_mul_f32 v54, v54, v36
    v_mul_f32 v55, v55, v36
    v_cvt_pk_bf16_f32 v60, v48, v49
    v_cvt_pk_bf16_f32 v61, v50, v51
    v_cvt_pk_bf16_f32 v62, v52, v53
    v_cvt_pk_bf16_f32 v63, v54, v55
    buffer_store_dwordx4 v[60:63], v10, s[8:11], s35 offen sc1
    s_and_b32 s19, s30, 31
    s_lshl_b32 s19, s19, 12
    s_lshr_b32 s20, s30, 5
    s_lshl_b32 s20, s20, 9
    s_add_u32 s19, s19, s20
    s_lshr_b32 s20, s17, 3
    s_lshl_b32 s20, s20, 7
    s_add_u32 s19, s19, s20
    s_add_u32 s19, s19, 63964160
    s_waitcnt vmcnt(0)
    s_barrier
    buffer_atomic_add v3, v2, s[8:11], s19 offen
    s_add_u32 s30, s30, 3
    s_cmp_lt_u32 s30, 64
    s_cbranch_scc1 L_at_top
    s_waitcnt vmcnt(0)
    s_endpgm
L_partA:
    s_lshl_b32 s19, s17, 2
    s_add_u32 s19, s19, s18
    s_sub_u32 s19, s19, 3
    s_lshr_b32 s30, s19, 4
    s_and_b32 s31, s19, 15
    v_lshrrev_b32 v20, 4, v0
    v_lshrrev_b32 v21, 4, v20
    v_and_b32 v22, 15, v20
    v_lshrrev_b32 v23, 3, v20
    v_and_b32 v24, 7, v20
    v_and_b32 v25, 2, v23
    v_xor_b32 v24, v24, v25
    v_lshlrev_b32 v24, 4, v24
    v_mul_u32_u24 v25, 3072, v23
    v_add_u32 v4, v25, v24
    v_xor_b32 v26, 64, v24
    v_add_u32 v5, v25, v26
    v_lshrrev_b32 v25, 2, v23
    v_lshlrev_b32 v25, 4, v25
    v_and_b32 v27, 3, v23
    v_add_u32 v25, v25, v27
    v_lshlrev_b32 v25, 10, v25
    v_add_u32 v6, v25, v24
    v_add_u32 v7, v25, v26
    v_lshrrev_b32 v23, 2, v22
    v_lshl_add_u32 v23, v21, 3, v23
    v_lshlrev_b32 v23, 7, v23
    v_and_b32 v24, 3, v22
    v_lshl_add_u32 v23, v24, 3, v23
    v_lshrrev_b32 v24, 3, v22
    v_and_b32 v25, 1, v21
    v_lshl_add_u32 v24, v25, 1, v24
    v_xor_b32 v25, 0, v24
    v_lshl_add_u32 v8, v25, 5, v23
    v_xor_b32 v25, 1, v24
    v_lshl_add_u32 v9, v25, 5, v23
    v_xor_b32 v25, 2, v24
    v_lshl_add_u32 v10, v25, 5, v23
    v_xor_b32 v25, 3, v24
    v_lshl_add_u32 v11, v25, 5, v23
    v_lshlrev_b32 v12, 10, v22
    v_lshl_add_u32 v12, v21, 4, v12
    s_lshl_b32 s19, s16, 10
    v_add_u32 v13, s19, v0
    v_lshlrev_b32 v14, 11, v22
    v_lshl_add_u32 v14, v21, 3, v14
    s_mov_b32 s84, s40
    s_and_b32 s85, s41, 0xffff
    s_mov_b32 s86, 0x200000
    s_mov_b32 s87, 0x20000
    s_mov_b32 s88, s42
    s_and_b32 s89, s43, 0xffff
    s_mov_b32 s90, 0x180000
    s_mov_b32 s91, 0x20000
    s_mov_b32 s4, s44
    s_and_b32 s5, s45, 0xffff
    s_mov_b32 s6, 0x80000
    s_mov_b32 s7, 0x20000
    s_mov_b32 s92, s60
    s_and_b32 s93, s61, 0xffff
    s_mov_b32 s94, 0x400000
    s_mov_b32 s95, 0x20000
    s_lshl_b32 s19, s16, 14
    s_add_u32 m0, s19, 0
    s_lshl_b32 s20, s30, 7
    s_mul_i32 s34, s16, 393216
    s_add_u32 s34, s34, 1024
    s_add_u32 s34, s34, s20
    buffer_load_dwordx4 v4, s[88:91], s34 offen lds
    s_add_u32 s34, s34, 24576
    s_add_u32 m0, m0, 1024
    s_nop 0
    buffer_load_dwordx4 v5, s[88:91], s34 offen lds
    s_add_u32 s34, s34, 24576
    s_add_u32 m0, m0, 1024
    s_nop 0
    buffer_load_dwordx4 v4, s[88:91], s34 offen lds
    s_add_u32 s34, s34, 24576
    s_add_u32 m0, m0, 1024
    s_nop 0
    buffer_load_dwordx4 v5, s[88:91], s34 offen lds
    s_add_u32 s34, s34, 24576
    s_add_u32 m0, m0, 1024
    s_nop 0
    buffer_load_dwordx4 v4, s[88:91], s34 offen lds
    s_add_u32 s34, s34, 24576
    s_add_u32 m0, m0, 1024
    s_nop 0
    buffer_load_dwordx4 v5, s[88:91], s34 offen lds
    s_add_u32 s34, s34, 24576
    s_add_u32 m0, m0, 1024
    s_nop 0
    buffer_load_dwordx4 v4, s[88:91], s34 offen lds
    s_add_u32 s34, s34, 24576
    s_add_u32 m0, m0, 1024
    s_nop 0
    buffer_load_dwordx4 v5, s[88:91], s34 offen lds
    s_add_u32 s34, s34, 24576
    s_add_u32 m0, m0, 1024
    s_nop 0
    buffer_load_dwordx4 v4, s[88:91], s34 offen lds
    s_add_u32 s34, s34, 24576
    s_add_u32 m0, m0, 1024
    s_nop 0
    buffer_load_dwordx4 v5, s[88:91], s34 offen lds
    s_add_u32 s34, s34, 24576
    s_add_u32 m0, m0, 1024
    s_nop 0
    buffer_load_dwordx4 v4, s[88:91], s34 offen lds
    s_add_u32 s34, s34, 24576
    s_add_u32 m0, m0, 1024
    s_nop 0
    buffer_load_dwordx4 v5, s[88:91], s34 offen lds
    s_add_u32 s34, s34, 24576
    s_add_u32 m0, m0, 1024
    s_nop 0
    buffer_load_dwordx4 v4, s[88:91], s34 offen lds
    s_add_u32 s34, s34, 24576
    s_add_u32 m0, m0, 1024
    s_nop 0
    buffer_load_dwordx4 v5, s[88:91], s34 offen lds
    s_add_u32 s34, s34, 24576
    s_add_u32 m0, m0, 1024
    s_nop 0
    buffer_load_dwordx4 v4, s[88:91], s34 offen lds
    s_add_u32 s34, s34, 24576
    s_add_u32 m0, m0, 1024
    s_nop 0
    buffer_load_dwordx4 v5, s[88:91], s34 offen lds
    s_add_u32 s34, s34, 24576
    s_add_u32 m0, m0, 1024
    s_nop 0
    s_lshl_b32 s35, s31, 17
    s_lshl_b32 s19, s16, 15
    s_add_u32 s35, s35, s19
    s_add_u32 s36, s35, 16384
    buffer_load_dwordx4 v[128:131], v12, s[84:87], s35 offen offset:0
    buffer_load_dwordx4 v[192:195], v12, s[84:87], s36 offen offset:0
    buffer_load_dwordx4 v[132:135], v12, s[84:87], s35 offen offset:64
    buffer_load_dwordx4 v[196:199], v12, s[84:87], s36 offen offset:64
    buffer_load_dwordx4 v[136:139], v12, s[84:87], s35 offen offset:128
    buffer_load_dwordx4 v[200:203], v12, s[84:87], s36 offen offset:128
    buffer_load_dwordx4 v[140:143], v12, s[84:87], s35 offen offset:192
    buffer_load_dwordx4 v[204:207], v12, s[84:87], s36 offen offset:192
    buffer_load_dwordx4 v[144:147], v12, s[84:87], s35 offen offset:256
    buffer_load_dwordx4 v[208:211], v12, s[84:87], s36 offen offset:256
    buffer_load_dwordx4 v[148:151], v12, s[84:87], s35 offen offset:320
    buffer_load_dwordx4 v[212:215], v12, s[84:87], s36 offen offset:320
    buffer_load_dwordx4 v[152:155], v12, s[84:87], s35 offen offset:384
    buffer_load_dwordx4 v[216:219], v12, s[84:87], s36 offen offset:384
    buffer_load_dwordx4 v[156:159], v12, s[84:87], s35 offen offset:448
    buffer_load_dwordx4 v[220:223], v12, s[84:87], s36 offen offset:448
    buffer_load_dwordx4 v[160:163], v12, s[84:87], s35 offen offset:512
    buffer_load_dwordx4 v[224:227], v12, s[84:87], s36 offen offset:512
    buffer_load_dwordx4 v[164:167], v12, s[84:87], s35 offen offset:576
    buffer_load_dwordx4 v[228:231], v12, s[84:87], s36 offen offset:576
    buffer_load_dwordx4 v[168:171], v12, s[84:87], s35 offen offset:640
    buffer_load_dwordx4 v[232:235], v12, s[84:87], s36 offen offset:640
    buffer_load_dwordx4 v[172:175], v12, s[84:87], s35 offen offset:704
    buffer_load_dwordx4 v[236:239], v12, s[84:87], s36 offen offset:704
    buffer_load_dwordx4 v[176:179], v12, s[84:87], s35 offen offset:768
    buffer_load_dwordx4 v[240:243], v12, s[84:87], s36 offen offset:768
    buffer_load_dwordx4 v[180:183], v12, s[84:87], s35 offen offset:832
    buffer_load_dwordx4 v[244:247], v12, s[84:87], s36 offen offset:832
    buffer_load_dwordx4 v[184:187], v12, s[84:87], s35 offen offset:896
    buffer_load_dwordx4 v[248:251], v12, s[84:87], s36 offen offset:896
    buffer_load_dwordx4 v[188:191], v12, s[84:87], s35 offen offset:960
    buffer_load_dwordx4 v[252:255], v12, s[84:87], s36 offen offset:960
    s_waitcnt vmcnt(40)
    s_lshl_b32 s19, s16, 14
    s_add_u32 m0, s19, 65536
    s_lshl_b32 s20, s30, 7
    s_mul_i32 s34, s16, 393216
    s_add_u32 s34, s34, 2048
    s_add_u32 s34, s34, s20
    buffer_load_dwordx4 v4, s[88:91], s34 offen lds
    s_add_u32 s34, s34, 24576
    s_add_u32 m0, m0, 1024
    s_nop 0
    buffer_load_dwordx4 v5, s[88:91], s34 offen lds
    s_add_u32 s34, s34, 24576
    s_add_u32 m0, m0, 1024
    s_nop 0
    buffer_load_dwordx4 v4, s[88:91], s34 offen lds
    s_add_u32 s34, s34, 24576
    s_add_u32 m0, m0, 1024
    s_nop 0
    buffer_load_dwordx4 v5, s[88:91], s34 offen lds
    s_add_u32 s34, s34, 24576
    s_add_u32 m0, m0, 1024
    s_nop 0
    buffer_load_dwordx4 v4, s[88:91], s34 offen lds
    s_add_u32 s34, s34, 24576
    s_add_u32 m0, m0, 1024
    s_nop 0
    buffer_load_dwordx4 v5, s[88:91], s34 offen lds
    s_add_u32 s34, s34, 24576
    s_add_u32 m0, m0, 1024
    s_nop 0
    buffer_load_dwordx4 v4, s[88:91], s34 offen lds
    s_add_u32 s34, s34, 24576
    s_add_u32 m0, m0, 1024
    s_nop 0
    buffer_load_dwordx4 v5, s[88:91], s34 offen lds
    s_add_u32 s34, s34, 24576
    s_add_u32 m0, m0, 1024
    s_nop 0
    buffer_load_dwordx4 v4, s[88:91], s34 offen lds
    s_add_u32 s34, s34, 24576
    s_add_u32 m0, m0, 1024
    s_nop 0
    buffer_load_dwordx4 v5, s[88:91], s34 offen lds
    s_add_u32 s34, s34, 24576
    s_add_u32 m0, m0, 1024
    s_nop 0
    buffer_load_dwordx4 v4, s[88:91], s34 offen lds
    s_add_u32 s34, s34, 24576
    s_add_u32 m0, m0, 1024
    s_nop 0
    buffer_load_dwordx4 v5, s[88:91], s34 offen lds
    s_add_u32 s34, s34, 24576
    s_add_u32 m0, m0, 1024
    s_nop 0
    buffer_load_dwordx4 v4, s[88:91], s34 offen lds
    s_add_u32 s34, s34, 24576
    s_add_u32 m0, m0, 1024
    s_nop 0
    buffer_load_dwordx4 v5, s[88:91], s34 offen lds
    s_add_u32 s34, s34, 24576
    s_add_u32 m0, m0, 1024
    s_nop 0
    buffer_load_dwordx4 v4, s[88:91], s34 offen lds
    s_add_u32 s34, s34, 24576
    s_add_u32 m0, m0, 1024
    s_nop 0
    buffer_load_dwordx4 v5, s[88:91], s34 offen lds
    s_add_u32 s34, s34, 24576
    s_add_u32 m0, m0, 1024
    s_nop 0
    s_waitcnt vmcnt(16)
    s_barrier
    ds_read_b64_tr_b16 v[48:49], v8 offset:0
    ds_read_b64_tr_b16 v[50:51], v8 offset:512
    ds_read_b64_tr_b16 v[52:53], v9 offset:0
    ds_read_b64_tr_b16 v[54:55], v9 offset:512
    ds_read_b64_tr_b16 v[56:57], v10 offset:0
    ds_read_b64_tr_b16 v[58:59], v10 offset:512
    ds_read_b64_tr_b16 v[60:61], v11 offset:0
    ds_read_b64_tr_b16 v[62:63], v11 offset:512
    s_waitcnt lgkmcnt(0)
    v_mfma_f32_16x16x32_bf16 v[16:19], v[128:131], v[48:51], 0
    ds_read_b64_tr_b16 v[64:65], v8 offset:4096
    ds_read_b64_tr_b16 v[66:67], v8 offset:4608
    v_mfma_f32_16x16x32_bf16 v[20:23], v[192:195], v[48:51], 0
    ds_read_b64_tr_b16 v[68:69], v9 offset:4096
    ds_read_b64_tr_b16 v[70:71], v9 offset:4608
    v_mfma_f32_16x16x32_bf16 v[24:27], v[128:131], v[52:55], 0
    ds_read_b64_tr_b16 v[72:73], v10 offset:4096
    ds_read_b64_tr_b16 v[74:75], v10 offset:4608
    v_mfma_f32_16x16x32_bf16 v[28:31], v[192:195], v[52:55], 0
    ds_read_b64_tr_b16 v[76:77], v11 offset:4096
    ds_read_b64_tr_b16 v[78:79], v11 offset:4608
    v_mfma_f32_16x16x32_bf16 v[32:35], v[128:131], v[56:59], 0
    v_mfma_f32_16x16x32_bf16 v[36:39], v[192:195], v[56:59], 0
    v_mfma_f32_16x16x32_bf16 v[40:43], v[128:131], v[60:63], 0
    v_mfma_f32_16x16x32_bf16 v[44:47], v[192:195], v[60:63], 0
    s_waitcnt lgkmcnt(0)
    v_mfma_f32_16x16x32_bf16 v[16:19], v[132:135], v[64:67], v[16:19]
    ds_read_b64_tr_b16 v[48:49], v8 offset:8192
    ds_read_b64_tr_b16 v[50:51], v8 offset:8704
    v_mfma_f32_16x16x32_bf16 v[20:23], v[196:199], v[64:67], v[20:23]
    ds_read_b64_tr_b16 v[52:53], v9 offset:8192
    ds_read_b64_tr_b16 v[54:55], v9 offset:8704
    v_mfma_f32_16x16x32_bf16 v[24:27], v[132:135], v[68:71], v[24:27]
    ds_read_b64_tr_b16 v[56:57], v10 offset:8192
    ds_read_b64_tr_b16 v[58:59], v10 offset:8704
    v_mfma_f32_16x16x32_bf16 v[28:31], v[196:199], v[68:71], v[28:31]
    ds_read_b64_tr_b16 v[60:61], v11 offset:8192
    ds_read_b64_tr_b16 v[62:63], v11 offset:8704
    v_mfma_f32_16x16x32_bf16 v[32:35], v[132:135], v[72:75], v[32:35]
    v_mfma_f32_16x16x32_bf16 v[36:39], v[196:199], v[72:75], v[36:39]
    v_mfma_f32_16x16x32_bf16 v[40:43], v[132:135], v[76:79], v[40:43]
    v_mfma_f32_16x16x32_bf16 v[44:47], v[196:199], v[76:79], v[44:47]
    s_waitcnt lgkmcnt(0)
    v_mfma_f32_16x16x32_bf16 v[16:19], v[136:139], v[48:51], v[16:19]
    ds_read_b64_tr_b16 v[64:65], v8 offset:12288
    ds_read_b64_tr_b16 v[66:67], v8 offset:12800
    v_mfma_f32_16x16x32_bf16 v[20:23], v[200:203], v[48:51], v[20:23]
    ds_read_b64_tr_b16 v[68:69], v9 offset:12288
    ds_read_b64_tr_b16 v[70:71], v9 offset:12800
    v_mfma_f32_16x16x32_bf16 v[24:27], v[136:139], v[52:55], v[24:27]
    ds_read_b64_tr_b16 v[72:73], v10 offset:12288
    ds_read_b64_tr_b16 v[74:75], v10 offset:12800
    v_mfma_f32_16x16x32_bf16 v[28:31], v[200:203], v[52:55], v[28:31]
    ds_read_b64_tr_b16 v[76:77], v11 offset:12288
    ds_read_b64_tr_b16 v[78:79], v11 offset:12800
    v_mfma_f32_16x16x32_bf16 v[32:35], v[136:139], v[56:59], v[32:35]
    v_mfma_f32_16x16x32_bf16 v[36:39], v[200:203], v[56:59], v[36:39]
    v_mfma_f32_16x16x32_bf16 v[40:43], v[136:139], v[60:63], v[40:43]
    v_mfma_f32_16x16x32_bf16 v[44:47], v[200:203], v[60:63], v[44:47]
    s_waitcnt lgkmcnt(0)
    v_mfma_f32_16x16x32_bf16 v[16:19], v[140:143], v[64:67], v[16:19]
    ds_read_b64_tr_b16 v[48:49], v8 offset:16384
    ds_read_b64_tr_b16 v[50:51], v8 offset:16896
    v_mfma_f32_16x16x32_bf16 v[20:23], v[204:207], v[64:67], v[20:23]
    ds_read_b64_tr_b16 v[52:53], v9 offset:16384
    ds_read_b64_tr_b16 v[54:55], v9 offset:16896
    v_mfma_f32_16x16x32_bf16 v[24:27], v[140:143], v[68:71], v[24:27]
    ds_read_b64_tr_b16 v[56:57], v10 offset:16384
    ds_read_b64_tr_b16 v[58:59], v10 offset:16896
    v_mfma_f32_16x16x32_bf16 v[28:31], v[204:207], v[68:71], v[28:31]
    ds_read_b64_tr_b16 v[60:61], v11 offset:16384
    ds_read_b64_tr_b16 v[62:63], v11 offset:16896
    v_mfma_f32_16x16x32_bf16 v[32:35], v[140:143], v[72:75], v[32:35]
    v_mfma_f32_16x16x32_bf16 v[36:39], v[204:207], v[72:75], v[36:39]
    v_mfma_f32_16x16x32_bf16 v[40:43], v[140:143], v[76:79], v[40:43]
    v_mfma_f32_16x16x32_bf16 v[44:47], v[204:207], v[76:79], v[44:47]
    s_waitcnt lgkmcnt(0)
    v_mfma_f32_16x16x32_bf16 v[16:19], v[144:147], v[48:51], v[16:19]
    ds_read_b64_tr_b16 v[64:65], v8 offset:20480
    ds_read_b64_tr_b16 v[66:67], v8 offset:20992
    v_mfma_f32_16x16x32_bf16 v[20:23], v[208:211], v[48:51], v[20:23]
    ds_read_b64_tr_b16 v[68:69], v9 offset:20480
    ds_read_b64_tr_b16 v[70:71], v9 offset:20992
    v_mfma_f32_16x16x32_bf16 v[24:27], v[144:147], v[52:55], v[24:27]
    ds_read_b64_tr_b16 v[72:73], v10 offset:20480
    ds_read_b64_tr_b16 v[74:75], v10 offset:20992
    v_mfma_f32_16x16x32_bf16 v[28:31], v[208:211], v[52:55], v[28:31]
    ds_read_b64_tr_b16 v[76:77], v11 offset:20480
    ds_read_b64_tr_b16 v[78:79], v11 offset:20992
    v_mfma_f32_16x16x32_bf16 v[32:35], v[144:147], v[56:59], v[32:35]
    v_mfma_f32_16x16x32_bf16 v[36:39], v[208:211], v[56:59], v[36:39]
    v_mfma_f32_16x16x32_bf16 v[40:43], v[144:147], v[60:63], v[40:43]
    v_mfma_f32_16x16x32_bf16 v[44:47], v[208:211], v[60:63], v[44:47]
    s_waitcnt lgkmcnt(0)
    v_mfma_f32_16x16x32_bf16 v[16:19], v[148:151], v[64:67], v[16:19]
    ds_read_b64_tr_b16 v[48:49], v8 offset:24576
    ds_read_b64_tr_b16 v[50:51], v8 offset:25088
    v_mfma_f32_16x16x32_bf16 v[20:23], v[212:215], v[64:67], v[20:23]
    ds_read_b64_tr_b16 v[52:53], v9 offset:24576
    ds_read_b64_tr_b16 v[54:55], v9 offset:25088
    v_mfma_f32_16x16x32_bf16 v[24:27], v[148:151], v[68:71], v[24:27]
    ds_read_b64_tr_b16 v[56:57], v10 offset:24576
    ds_read_b64_tr_b16 v[58:59], v10 offset:25088
    v_mfma_f32_16x16x32_bf16 v[28:31], v[212:215], v[68:71], v[28:31]
    ds_read_b64_tr_b16 v[60:61], v11 offset:24576
    ds_read_b64_tr_b16 v[62:63], v11 offset:25088
    v_mfma_f32_16x16x32_bf16 v[32:35], v[148:151], v[72:75], v[32:35]
    v_mfma_f32_16x16x32_bf16 v[36:39], v[212:215], v[72:75], v[36:39]
    v_mfma_f32_16x16x32_bf16 v[40:43], v[148:151], v[76:79], v[40:43]
    v_mfma_f32_16x16x32_bf16 v[44:47], v[212:215], v[76:79], v[44:47]
    s_waitcnt lgkmcnt(0)
    v_mfma_f32_16x16x32_bf16 v[16:19], v[152:155], v[48:51], v[16:19]
    ds_read_b64_tr_b16 v[64:65], v8 offset:28672
    ds_read_b64_tr_b16 v[66:67], v8 offset:29184
    v_mfma_f32_16x16x32_bf16 v[20:23], v[216:219], v[48:51], v[20:23]
    ds_read_b64_tr_b16 v[68:69], v9 offset:28672
    ds_read_b64_tr_b16 v[70:71], v9 offset:29184
    v_mfma_f32_16x16x32_bf16 v[24:27], v[152:155], v[52:55], v[24:27]
    ds_read_b64_tr_b16 v[72:73], v10 offset:28672
    ds_read_b64_tr_b16 v[74:75], v10 offset:29184
    v_mfma_f32_16x16x32_bf16 v[28:31], v[216:219], v[52:55], v[28:31]
    ds_read_b64_tr_b16 v[76:77], v11 offset:28672
    ds_read_b64_tr_b16 v[78:79], v11 offset:29184
    v_mfma_f32_16x16x32_bf16 v[32:35], v[152:155], v[56:59], v[32:35]
    v_mfma_f32_16x16x32_bf16 v[36:39], v[216:219], v[56:59], v[36:39]
    v_mfma_f32_16x16x32_bf16 v[40:43], v[152:155], v[60:63], v[40:43]
    v_mfma_f32_16x16x32_bf16 v[44:47], v[216:219], v[60:63], v[44:47]
    s_waitcnt lgkmcnt(0)
    v_mfma_f32_16x16x32_bf16 v[16:19], v[156:159], v[64:67], v[16:19]
    ds_read_b64_tr_b16 v[48:49], v8 offset:32768
    ds_read_b64_tr_b16 v[50:51], v8 offset:33280
    v_mfma_f32_16x16x32_bf16 v[20:23], v[220:223], v[64:67], v[20:23]
    ds_read_b64_tr_b16 v[52:53], v9 offset:32768
    ds_read_b64_tr_b16 v[54:55], v9 offset:33280
    v_mfma_f32_16x16x32_bf16 v[24:27], v[156:159], v[68:71], v[24:27]
    ds_read_b64_tr_b16 v[56:57], v10 offset:32768
    ds_read_b64_tr_b16 v[58:59], v10 offset:33280
    v_mfma_f32_16x16x32_bf16 v[28:31], v[220:223], v[68:71], v[28:31]
    ds_read_b64_tr_b16 v[60:61], v11 offset:32768
    ds_read_b64_tr_b16 v[62:63], v11 offset:33280
    v_mfma_f32_16x16x32_bf16 v[32:35], v[156:159], v[72:75], v[32:35]
    v_mfma_f32_16x16x32_bf16 v[36:39], v[220:223], v[72:75], v[36:39]
    v_mfma_f32_16x16x32_bf16 v[40:43], v[156:159], v[76:79], v[40:43]
    v_mfma_f32_16x16x32_bf16 v[44:47], v[220:223], v[76:79], v[44:47]
    s_waitcnt lgkmcnt(0)
    v_mfma_f32_16x16x32_bf16 v[16:19], v[160:163], v[48:51], v[16:19]
    ds_read_b64_tr_b16 v[64:65], v8 offset:36864
    ds_read_b64_tr_b16 v[66:67], v8 offset:37376
    v_mfma_f32_16x16x32_bf16 v[20:23], v[224:227], v[48:51], v[20:23]
    ds_read_b64_tr_b16 v[68:69], v9 offset:36864
    ds_read_b64_tr_b16 v[70:71], v9 offset:37376
    v_mfma_f32_16x16x32_bf16 v[24:27], v[160:163], v[52:55], v[24:27]
    ds_read_b64_tr_b16 v[72:73], v10 offset:36864
    ds_read_b64_tr_b16 v[74:75], v10 offset:37376
    v_mfma_f32_16x16x32_bf16 v[28:31], v[224:227], v[52:55], v[28:31]
    ds_read_b64_tr_b16 v[76:77], v11 offset:36864
    ds_read_b64_tr_b16 v[78:79], v11 offset:37376
    v_mfma_f32_16x16x32_bf16 v[32:35], v[160:163], v[56:59], v[32:35]
    v_mfma_f32_16x16x32_bf16 v[36:39], v[224:227], v[56:59], v[36:39]
    v_mfma_f32_16x16x32_bf16 v[40:43], v[160:163], v[60:63], v[40:43]
    v_mfma_f32_16x16x32_bf16 v[44:47], v[224:227], v[60:63], v[44:47]
    s_waitcnt lgkmcnt(0)
    v_mfma_f32_16x16x32_bf16 v[16:19], v[164:167], v[64:67], v[16:19]
    ds_read_b64_tr_b16 v[48:49], v8 offset:40960
    ds_read_b64_tr_b16 v[50:51], v8 offset:41472
    v_mfma_f32_16x16x32_bf16 v[20:23], v[228:231], v[64:67], v[20:23]
    ds_read_b64_tr_b16 v[52:53], v9 offset:40960
    ds_read_b64_tr_b16 v[54:55], v9 offset:41472
    v_mfma_f32_16x16x32_bf16 v[24:27], v[164:167], v[68:71], v[24:27]
    ds_read_b64_tr_b16 v[56:57], v10 offset:40960
    ds_read_b64_tr_b16 v[58:59], v10 offset:41472
    v_mfma_f32_16x16x32_bf16 v[28:31], v[228:231], v[68:71], v[28:31]
    ds_read_b64_tr_b16 v[60:61], v11 offset:40960
    ds_read_b64_tr_b16 v[62:63], v11 offset:41472
    v_mfma_f32_16x16x32_bf16 v[32:35], v[164:167], v[72:75], v[32:35]
    v_mfma_f32_16x16x32_bf16 v[36:39], v[228:231], v[72:75], v[36:39]
    v_mfma_f32_16x16x32_bf16 v[40:43], v[164:167], v[76:79], v[40:43]
    v_mfma_f32_16x16x32_bf16 v[44:47], v[228:231], v[76:79], v[44:47]
    s_waitcnt lgkmcnt(0)
    v_mfma_f32_16x16x32_bf16 v[16:19], v[168:171], v[48:51], v[16:19]
    ds_read_b64_tr_b16 v[64:65], v8 offset:45056
    ds_read_b64_tr_b16 v[66:67], v8 offset:45568
    v_mfma_f32_16x16x32_bf16 v[20:23], v[232:235], v[48:51], v[20:23]
    ds_read_b64_tr_b16 v[68:69], v9 offset:45056
    ds_read_b64_tr_b16 v[70:71], v9 offset:45568
    v_mfma_f32_16x16x32_bf16 v[24:27], v[168:171], v[52:55], v[24:27]
    ds_read_b64_tr_b16 v[72:73], v10 offset:45056
    ds_read_b64_tr_b16 v[74:75], v10 offset:45568
    v_mfma_f32_16x16x32_bf16 v[28:31], v[232:235], v[52:55], v[28:31]
    ds_read_b64_tr_b16 v[76:77], v11 offset:45056
    ds_read_b64_tr_b16 v[78:79], v11 offset:45568
    v_mfma_f32_16x16x32_bf16 v[32:35], v[168:171], v[56:59], v[32:35]
    v_mfma_f32_16x16x32_bf16 v[36:39], v[232:235], v[56:59], v[36:39]
    v_mfma_f32_16x16x32_bf16 v[40:43], v[168:171], v[60:63], v[40:43]
    v_mfma_f32_16x16x32_bf16 v[44:47], v[232:235], v[60:63], v[44:47]
    s_waitcnt lgkmcnt(0)
    v_mfma_f32_16x16x32_bf16 v[16:19], v[172:175], v[64:67], v[16:19]
    ds_read_b64_tr_b16 v[48:49], v8 offset:49152
    ds_read_b64_tr_b16 v[50:51], v8 offset:49664
    v_mfma_f32_16x16x32_bf16 v[20:23], v[236:239], v[64:67], v[20:23]
    ds_read_b64_tr_b16 v[52:53], v9 offset:49152
    ds_read_b64_tr_b16 v[54:55], v9 offset:49664
    v_mfma_f32_16x16x32_bf16 v[24:27], v[172:175], v[68:71], v[24:27]
    ds_read_b64_tr_b16 v[56:57], v10 offset:49152
    ds_read_b64_tr_b16 v[58:59], v10 offset:49664
    v_mfma_f32_16x16x32_bf16 v[28:31], v[236:239], v[68:71], v[28:31]
    ds_read_b64_tr_b16 v[60:61], v11 offset:49152
    ds_read_b64_tr_b16 v[62:63], v11 offset:49664
    v_mfma_f32_16x16x32_bf16 v[32:35], v[172:175], v[72:75], v[32:35]
    v_mfma_f32_16x16x32_bf16 v[36:39], v[236:239], v[72:75], v[36:39]
    v_mfma_f32_16x16x32_bf16 v[40:43], v[172:175], v[76:79], v[40:43]
    v_mfma_f32_16x16x32_bf16 v[44:47], v[236:239], v[76:79], v[44:47]
    s_waitcnt lgkmcnt(0)
    v_mfma_f32_16x16x32_bf16 v[16:19], v[176:179], v[48:51], v[16:19]
    ds_read_b64_tr_b16 v[64:65], v8 offset:53248
    ds_read_b64_tr_b16 v[66:67], v8 offset:53760
    v_mfma_f32_16x16x32_bf16 v[20:23], v[240:243], v[48:51], v[20:23]
    ds_read_b64_tr_b16 v[68:69], v9 offset:53248
    ds_read_b64_tr_b16 v[70:71], v9 offset:53760
    v_mfma_f32_16x16x32_bf16 v[24:27], v[176:179], v[52:55], v[24:27]
    ds_read_b64_tr_b16 v[72:73], v10 offset:53248
    ds_read_b64_tr_b16 v[74:75], v10 offset:53760
    v_mfma_f32_16x16x32_bf16 v[28:31], v[240:243], v[52:55], v[28:31]
    ds_read_b64_tr_b16 v[76:77], v11 offset:53248
    ds_read_b64_tr_b16 v[78:79], v11 offset:53760
    v_mfma_f32_16x16x32_bf16 v[32:35], v[176:179], v[56:59], v[32:35]
    v_mfma_f32_16x16x32_bf16 v[36:39], v[240:243], v[56:59], v[36:39]
    v_mfma_f32_16x16x32_bf16 v[40:43], v[176:179], v[60:63], v[40:43]
    v_mfma_f32_16x16x32_bf16 v[44:47], v[240:243], v[60:63], v[44:47]
    s_waitcnt lgkmcnt(0)
    v_mfma_f32_16x16x32_bf16 v[16:19], v[180:183], v[64:67], v[16:19]
    ds_read_b64_tr_b16 v[48:49], v8 offset:57344
    ds_read_b64_tr_b16 v[50:51], v8 offset:57856
    v_mfma_f32_16x16x32_bf16 v[20:23], v[244:247], v[64:67], v[20:23]
    ds_read_b64_tr_b16 v[52:53], v9 offset:57344
    ds_read_b64_tr_b16 v[54:55], v9 offset:57856
    v_mfma_f32_16x16x32_bf16 v[24:27], v[180:183], v[68:71], v[24:27]
    ds_read_b64_tr_b16 v[56:57], v10 offset:57344
    ds_read_b64_tr_b16 v[58:59], v10 offset:57856
    v_mfma_f32_16x16x32_bf16 v[28:31], v[244:247], v[68:71], v[28:31]
    ds_read_b64_tr_b16 v[60:61], v11 offset:57344
    ds_read_b64_tr_b16 v[62:63], v11 offset:57856
    v_mfma_f32_16x16x32_bf16 v[32:35], v[180:183], v[72:75], v[32:35]
    v_mfma_f32_16x16x32_bf16 v[36:39], v[244:247], v[72:75], v[36:39]
    v_mfma_f32_16x16x32_bf16 v[40:43], v[180:183], v[76:79], v[40:43]
    v_mfma_f32_16x16x32_bf16 v[44:47], v[244:247], v[76:79], v[44:47]
    s_waitcnt lgkmcnt(0)
    v_mfma_f32_16x16x32_bf16 v[16:19], v[184:187], v[48:51], v[16:19]
    ds_read_b64_tr_b16 v[64:65], v8 offset:61440
    ds_read_b64_tr_b16 v[66:67], v8 offset:61952
    v_mfma_f32_16x16x32_bf16 v[20:23], v[248:251], v[48:51], v[20:23]
    ds_read_b64_tr_b16 v[68:69], v9 offset:61440
    ds_read_b64_tr_b16 v[70:71], v9 offset:61952
    v_mfma_f32_16x16x32_bf16 v[24:27], v[184:187], v[52:55], v[24:27]
    ds_read_b64_tr_b16 v[72:73], v10 offset:61440
    ds_read_b64_tr_b16 v[74:75], v10 offset:61952
    v_mfma_f32_16x16x32_bf16 v[28:31], v[248:251], v[52:55], v[28:31]
    ds_read_b64_tr_b16 v[76:77], v11 offset:61440
    ds_read_b64_tr_b16 v[78:79], v11 offset:61952
    v_mfma_f32_16x16x32_bf16 v[32:35], v[184:187], v[56:59], v[32:35]
    v_mfma_f32_16x16x32_bf16 v[36:39], v[248:251], v[56:59], v[36:39]
    v_mfma_f32_16x16x32_bf16 v[40:43], v[184:187], v[60:63], v[40:43]
    v_mfma_f32_16x16x32_bf16 v[44:47], v[248:251], v[60:63], v[44:47]
    s_waitcnt lgkmcnt(0)
    v_mfma_f32_16x16x32_bf16 v[16:19], v[188:191], v[64:67], v[16:19]
    v_mfma_f32_16x16x32_bf16 v[20:23], v[252:255], v[64:67], v[20:23]
    v_mfma_f32_16x16x32_bf16 v[24:27], v[188:191], v[68:71], v[24:27]
    v_mfma_f32_16x16x32_bf16 v[28:31], v[252:255], v[68:71], v[28:31]
    v_mfma_f32_16x16x32_bf16 v[32:35], v[188:191], v[72:75], v[32:35]
    v_mfma_f32_16x16x32_bf16 v[36:39], v[252:255], v[72:75], v[36:39]
    v_mfma_f32_16x16x32_bf16 v[40:43], v[188:191], v[76:79], v[40:43]
    v_mfma_f32_16x16x32_bf16 v[44:47], v[252:255], v[76:79], v[44:47]
    s_nop 7
    s_waitcnt vmcnt(0)
    s_barrier
    s_lshl_b32 s19, s16, 14
    s_add_u32 m0, s19, 0
    s_lshl_b32 s20, s30, 7
    s_mul_i32 s34, s16, 393216
    s_add_u32 s34, s34, 0
    s_add_u32 s34, s34, s20
    buffer_load_dwordx4 v4, s[88:91], s34 offen lds
    s_add_u32 s34, s34, 24576
    s_add_u32 m0, m0, 1024
    s_nop 0
    buffer_load_dwordx4 v5, s[88:91], s34 offen lds
    s_add_u32 s34, s34, 24576
    s_add_u32 m0, m0, 1024
    s_nop 0
    buffer_load_dwordx4 v4, s[88:91], s34 offen lds
    s_add_u32 s34, s34, 24576
    s_add_u32 m0, m0, 1024
    s_nop 0
    buffer_load_dwordx4 v5, s[88:91], s34 offen lds
    s_add_u32 s34, s34, 24576
    s_add_u32 m0, m0, 1024
    s_nop 0
    buffer_load_dwordx4 v4, s[88:91], s34 offen lds
    s_add_u32 s34, s34, 24576
    s_add_u32 m0, m0, 1024
    s_nop 0
    buffer_load_dwordx4 v5, s[88:91], s34 offen lds
    s_add_u32 s34, s34, 24576
    s_add_u32 m0, m0, 1024
    s_nop 0
    buffer_load_dwordx4 v4, s[88:91], s34 offen lds
    s_add_u32 s34, s34, 24576
    s_add_u32 m0, m0, 1024
    s_nop 0
    buffer_load_dwordx4 v5, s[88:91], s34 offen lds
    s_add_u32 s34, s34, 24576
    s_add_u32 m0, m0, 1024
    s_nop 0
    buffer_load_dwordx4 v4, s[88:91], s34 offen lds
    s_add_u32 s34, s34, 24576
    s_add_u32 m0, m0, 1024
    s_nop 0
    buffer_load_dwordx4 v5, s[88:91], s34 offen lds
    s_add_u32 s34, s34, 24576
    s_add_u32 m0, m0, 1024
    s_nop 0
    buffer_load_dwordx4 v4, s[88:91], s34 offen lds
    s_add_u32 s34, s34, 24576
    s_add_u32 m0, m0, 1024
    s_nop 0
    buffer_load_dwordx4 v5, s[88:91], s34 offen lds
    s_add_u32 s34, s34, 24576
    s_add_u32 m0, m0, 1024
    s_nop 0
    buffer_load_dwordx4 v4, s[88:91], s34 offen lds
    s_add_u32 s34, s34, 24576
    s_add_u32 m0, m0, 1024
    s_nop 0
    buffer_load_dwordx4 v5, s[88:91], s34 offen lds
    s_add_u32 s34, s34, 24576
    s_add_u32 m0, m0, 1024
    s_nop 0
    buffer_load_dwordx4 v4, s[88:91], s34 offen lds
    s_add_u32 s34, s34, 24576
    s_add_u32 m0, m0, 1024
    s_nop 0
    buffer_load_dwordx4 v5, s[88:91], s34 offen lds
    s_add_u32 s34, s34, 24576
    s_add_u32 m0, m0, 1024
    s_nop 0
    s_mov_b32 s19, 0x3fb8aa3b
    s_mov_b32 s20, 0x358637bd
    v_mul_f32 v48, s19, v16
    v_mul_f32 v49, s19, v17
    v_mul_f32 v50, s19, v18
    v_mul_f32 v51, s19, v19
    v_mul_f32 v52, s19, v20
    v_mul_f32 v53, s19, v21
    v_mul_f32 v54, s19, v22
    v_mul_f32 v55, s19, v23
    v_min_f32 v48, 0, v48
    v_min_f32 v49, 0, v49
    v_min_f32 v50, 0, v50
    v_min_f32 v51, 0, v51
    v_min_f32 v52, 0, v52
    v_min_f32 v53, 0, v53
    v_min_f32 v54, 0, v54
    v_min_f32 v55, 0, v55
    v_exp_f32 v48, v48
    v_exp_f32 v49, v49
    v_exp_f32 v50, v50
    v_exp_f32 v51, v51
    v_exp_f32 v52, v52
    v_exp_f32 v53, v53
    v_exp_f32 v54, v54
    v_exp_f32 v55, v55
    v_max_f32 v16, 0, v16
    v_max_f32 v17, 0, v17
    v_max_f32 v18, 0, v18
    v_max_f32 v19, 0, v19
    v_max_f32 v20, 0, v20
    v_max_f32 v21, 0, v21
    v_max_f32 v22, 0, v22
    v_max_f32 v23, 0, v23
    v_add_f32 v16, v16, v48
    v_add_f32 v17, v17, v49
    v_add_f32 v18, v18, v50
    v_add_f32 v19, v19, v51
    v_add_f32 v20, v20, v52
    v_add_f32 v21, v21, v53
    v_add_f32 v22, v22, v54
    v_add_f32 v23, v23, v55
    v_add_f32 v16, s20, v16
    v_add_f32 v17, s20, v17
    v_add_f32 v18, s20, v18
    v_add_f32 v19, s20, v19
    v_add_f32 v20, s20, v20
    v_add_f32 v21, s20, v21
    v_add_f32 v22, s20, v22
    v_add_f32 v23, s20, v23
    v_mul_f32 v48, s19, v24
    v_mul_f32 v49, s19, v25
    v_mul_f32 v50, s19, v26
    v_mul_f32 v51, s19, v27
    v_mul_f32 v52, s19, v28
    v_mul_f32 v53, s19, v29
    v_mul_f32 v54, s19, v30
    v_mul_f32 v55, s19, v31
    v_min_f32 v48, 0, v48
    v_min_f32 v49, 0, v49
    v_min_f32 v50, 0, v50
    v_min_f32 v51, 0, v51
    v_min_f32 v52, 0, v52
    v_min_f32 v53, 0, v53
    v_min_f32 v54, 0, v54
    v_min_f32 v55, 0, v55
    v_exp_f32 v48, v48
    v_exp_f32 v49, v49
    v_exp_f32 v50, v50
    v_exp_f32 v51, v51
    v_exp_f32 v52, v52
    v_exp_f32 v53, v53
    v_exp_f32 v54, v54
    v_exp_f32 v55, v55
    v_max_f32 v24, 0, v24
    v_max_f32 v25, 0, v25
    v_max_f32 v26, 0, v26
    v_max_f32 v27, 0, v27
    v_max_f32 v28, 0, v28
    v_max_f32 v29, 0, v29
    v_max_f32 v30, 0, v30
    v_max_f32 v31, 0, v31
    v_add_f32 v24, v24, v48
    v_add_f32 v25, v25, v49
    v_add_f32 v26, v26, v50
    v_add_f32 v27, v27, v51
    v_add_f32 v28, v28, v52
    v_add_f32 v29, v29, v53
    v_add_f32 v30, v30, v54
    v_add_f32 v31, v31, v55
    v_add_f32 v24, s20, v24
    v_add_f32 v25, s20, v25
    v_add_f32 v26, s20, v26
    v_add_f32 v27, s20, v27
    v_add_f32 v28, s20, v28
    v_add_f32 v29, s20, v29
    v_add_f32 v30, s20, v30
    v_add_f32 v31, s20, v31
    v_mul_f32 v48, s19, v32
    v_mul_f32 v49, s19, v33
    v_mul_f32 v50, s19, v34
    v_mul_f32 v51, s19, v35
    v_mul_f32 v52, s19, v36
    v_mul_f32 v53, s19, v37
    v_mul_f32 v54, s19, v38
    v_mul_f32 v55, s19, v39
    v_min_f32 v48, 0, v48
    v_min_f32 v49, 0, v49
    v_min_f32 v50, 0, v50
    v_min_f32 v51, 0, v51
    v_min_f32 v52, 0, v52
    v_min_f32 v53, 0, v53
    v_min_f32 v54, 0, v54
    v_min_f32 v55, 0, v55
    v_exp_f32 v48, v48
    v_exp_f32 v49, v49
    v_exp_f32 v50, v50
    v_exp_f32 v51, v51
    v_exp_f32 v52, v52
    v_exp_f32 v53, v53
    v_exp_f32 v54, v54
    v_exp_f32 v55, v55
    v_max_f32 v32, 0, v32
    v_max_f32 v33, 0, v33
    v_max_f32 v34, 0, v34
    v_max_f32 v35, 0, v35
    v_max_f32 v36, 0, v36
    v_max_f32 v37, 0, v37
    v_max_f32 v38, 0, v38
    v_max_f32 v39, 0, v39
    v_add_f32 v32, v32, v48
    v_add_f32 v33, v33, v49
    v_add_f32 v34, v34, v50
    v_add_f32 v35, v35, v51
    v_add_f32 v36, v36, v52
    v_add_f32 v37, v37, v53
    v_add_f32 v38, v38, v54
    v_add_f32 v39, v39, v55
    v_add_f32 v32, s20, v32
    v_add_f32 v33, s20, v33
    v_add_f32 v34, s20, v34
    v_add_f32 v35, s20, v35
    v_add_f32 v36, s20, v36
    v_add_f32 v37, s20, v37
    v_add_f32 v38, s20, v38
    v_add_f32 v39, s20, v39
    v_mul_f32 v48, s19, v40
    v_mul_f32 v49, s19, v41
    v_mul_f32 v50, s19, v42
    v_mul_f32 v51, s19, v43
    v_mul_f32 v52, s19, v44
    v_mul_f32 v53, s19, v45
    v_mul_f32 v54, s19, v46
    v_mul_f32 v55, s19, v47
    v_min_f32 v48, 0, v48
    v_min_f32 v49, 0, v49
    v_min_f32 v50, 0, v50
    v_min_f32 v51, 0, v51
    v_min_f32 v52, 0, v52
    v_min_f32 v53, 0, v53
    v_min_f32 v54, 0, v54
    v_min_f32 v55, 0, v55
    v_exp_f32 v48, v48
    v_exp_f32 v49, v49
    v_exp_f32 v50, v50
    v_exp_f32 v51, v51
    v_exp_f32 v52, v52
    v_exp_f32 v53, v53
    v_exp_f32 v54, v54
    v_exp_f32 v55, v55
    v_max_f32 v40, 0, v40
    v_max_f32 v41, 0, v41
    v_max_f32 v42, 0, v42
    v_max_f32 v43, 0, v43
    v_max_f32 v44, 0, v44
    v_max_f32 v45, 0, v45
    v_max_f32 v46, 0, v46
    v_max_f32 v47, 0, v47
    v_add_f32 v40, v40, v48
    v_add_f32 v41, v41, v49
    v_add_f32 v42, v42, v50
    v_add_f32 v43, v43, v51
    v_add_f32 v44, v44, v52
    v_add_f32 v45, v45, v53
    v_add_f32 v46, v46, v54
    v_add_f32 v47, v47, v55
    v_add_f32 v40, s20, v40
    v_add_f32 v41, s20, v41
    v_add_f32 v42, s20, v42
    v_add_f32 v43, s20, v43
    v_add_f32 v44, s20, v44
    v_add_f32 v45, s20, v45
    v_add_f32 v46, s20, v46
    v_add_f32 v47, s20, v47
    v_cvt_pk_bf16_f32 v80, v16, v17
    v_cvt_pk_bf16_f32 v81, v18, v19
    v_cvt_pk_bf16_f32 v82, v20, v21
    v_cvt_pk_bf16_f32 v83, v22, v23
    v_cvt_pk_bf16_f32 v84, v24, v25
    v_cvt_pk_bf16_f32 v85, v26, v27
    v_cvt_pk_bf16_f32 v86, v28, v29
    v_cvt_pk_bf16_f32 v87, v30, v31
    v_cvt_pk_bf16_f32 v88, v32, v33
    v_cvt_pk_bf16_f32 v89, v34, v35
    v_cvt_pk_bf16_f32 v90, v36, v37
    v_cvt_pk_bf16_f32 v91, v38, v39
    v_cvt_pk_bf16_f32 v92, v40, v41
    v_cvt_pk_bf16_f32 v93, v42, v43
    v_cvt_pk_bf16_f32 v94, v44, v45
    v_cvt_pk_bf16_f32 v95, v46, v47
    v_add_u32 v8, 65536, v8
    v_add_u32 v9, 65536, v9
    v_add_u32 v10, 65536, v10
    v_add_u32 v11, 65536, v11
    ds_read_b64_tr_b16 v[48:49], v8 offset:0
    ds_read_b64_tr_b16 v[50:51], v8 offset:512
    ds_read_b64_tr_b16 v[52:53], v9 offset:0
    ds_read_b64_tr_b16 v[54:55], v9 offset:512
    ds_read_b64_tr_b16 v[56:57], v10 offset:0
    ds_read_b64_tr_b16 v[58:59], v10 offset:512
    ds_read_b64_tr_b16 v[60:61], v11 offset:0
    ds_read_b64_tr_b16 v[62:63], v11 offset:512
    s_waitcnt lgkmcnt(0)
    v_mfma_f32_16x16x32_bf16 v[16:19], v[128:131], v[48:51], 0
    ds_read_b64_tr_b16 v[64:65], v8 offset:4096
    ds_read_b64_tr_b16 v[66:67], v8 offset:4608
    v_mfma_f32_16x16x32_bf16 v[20:23], v[192:195], v[48:51], 0
    ds_read_b64_tr_b16 v[68:69], v9 offset:4096
    ds_read_b64_tr_b16 v[70:71], v9 offset:4608
    v_mfma_f32_16x16x32_bf16 v[24:27], v[128:131], v[52:55], 0
    ds_read_b64_tr_b16 v[72:73], v10 offset:4096
    ds_read_b64_tr_b16 v[74:75], v10 offset:4608
    v_mfma_f32_16x16x32_bf16 v[28:31], v[192:195], v[52:55], 0
    ds_read_b64_tr_b16 v[76:77], v11 offset:4096
    ds_read_b64_tr_b16 v[78:79], v11 offset:4608
    v_mfma_f32_16x16x32_bf16 v[32:35], v[128:131], v[56:59], 0
    v_mfma_f32_16x16x32_bf16 v[36:39], v[192:195], v[56:59], 0
    v_mfma_f32_16x16x32_bf16 v[40:43], v[128:131], v[60:63], 0
    v_mfma_f32_16x16x32_bf16 v[44:47], v[192:195], v[60:63], 0
    s_waitcnt lgkmcnt(0)
    v_mfma_f32_16x16x32_bf16 v[16:19], v[132:135], v[64:67], v[16:19]
    ds_read_b64_tr_b16 v[48:49], v8 offset:8192
    ds_read_b64_tr_b16 v[50:51], v8 offset:8704
    v_mfma_f32_16x16x32_bf16 v[20:23], v[196:199], v[64:67], v[20:23]
    ds_read_b64_tr_b16 v[52:53], v9 offset:8192
    ds_read_b64_tr_b16 v[54:55], v9 offset:8704
    v_mfma_f32_16x16x32_bf16 v[24:27], v[132:135], v[68:71], v[24:27]
    ds_read_b64_tr_b16 v[56:57], v10 offset:8192
    ds_read_b64_tr_b16 v[58:59], v10 offset:8704
    v_mfma_f32_16x16x32_bf16 v[28:31], v[196:199], v[68:71], v[28:31]
    ds_read_b64_tr_b16 v[60:61], v11 offset:8192
    ds_read_b64_tr_b16 v[62:63], v11 offset:8704
    v_mfma_f32_16x16x32_bf16 v[32:35], v[132:135], v[72:75], v[32:35]
    v_mfma_f32_16x16x32_bf16 v[36:39], v[196:199], v[72:75], v[36:39]
    v_mfma_f32_16x16x32_bf16 v[40:43], v[132:135], v[76:79], v[40:43]
    v_mfma_f32_16x16x32_bf16 v[44:47], v[196:199], v[76:79], v[44:47]
    s_waitcnt lgkmcnt(0)
    v_mfma_f32_16x16x32_bf16 v[16:19], v[136:139], v[48:51], v[16:19]
    ds_read_b64_tr_b16 v[64:65], v8 offset:12288
    ds_read_b64_tr_b16 v[66:67], v8 offset:12800
    v_mfma_f32_16x16x32_bf16 v[20:23], v[200:203], v[48:51], v[20:23]
    ds_read_b64_tr_b16 v[68:69], v9 offset:12288
    ds_read_b64_tr_b16 v[70:71], v9 offset:12800
    v_mfma_f32_16x16x32_bf16 v[24:27], v[136:139], v[52:55], v[24:27]
    ds_read_b64_tr_b16 v[72:73], v10 offset:12288
    ds_read_b64_tr_b16 v[74:75], v10 offset:12800
    v_mfma_f32_16x16x32_bf16 v[28:31], v[200:203], v[52:55], v[28:31]
    ds_read_b64_tr_b16 v[76:77], v11 offset:12288
    ds_read_b64_tr_b16 v[78:79], v11 offset:12800
    v_mfma_f32_16x16x32_bf16 v[32:35], v[136:139], v[56:59], v[32:35]
    v_mfma_f32_16x16x32_bf16 v[36:39], v[200:203], v[56:59], v[36:39]
    v_mfma_f32_16x16x32_bf16 v[40:43], v[136:139], v[60:63], v[40:43]
    v_mfma_f32_16x16x32_bf16 v[44:47], v[200:203], v[60:63], v[44:47]
    s_waitcnt lgkmcnt(0)
    v_mfma_f32_16x16x32_bf16 v[16:19], v[140:143], v[64:67], v[16:19]
    ds_read_b64_tr_b16 v[48:49], v8 offset:16384
    ds_read_b64_tr_b16 v[50:51], v8 offset:16896
    v_mfma_f32_16x16x32_bf16 v[20:23], v[204:207], v[64:67], v[20:23]
    ds_read_b64_tr_b16 v[52:53], v9 offset:16384
    ds_read_b64_tr_b16 v[54:55], v9 offset:16896
    v_mfma_f32_16x16x32_bf16 v[24:27], v[140:143], v[68:71], v[24:27]
    ds_read_b64_tr_b16 v[56:57], v10 offset:16384
    ds_read_b64_tr_b16 v[58:59], v10 offset:16896
    v_mfma_f32_16x16x32_bf16 v[28:31], v[204:207], v[68:71], v[28:31]
    ds_read_b64_tr_b16 v[60:61], v11 offset:16384
    ds_read_b64_tr_b16 v[62:63], v11 offset:16896
    v_mfma_f32_16x16x32_bf16 v[32:35], v[140:143], v[72:75], v[32:35]
    v_mfma_f32_16x16x32_bf16 v[36:39], v[204:207], v[72:75], v[36:39]
    v_mfma_f32_16x16x32_bf16 v[40:43], v[140:143], v[76:79], v[40:43]
    v_mfma_f32_16x16x32_bf16 v[44:47], v[204:207], v[76:79], v[44:47]
    s_waitcnt lgkmcnt(0)
    v_mfma_f32_16x16x32_bf16 v[16:19], v[144:147], v[48:51], v[16:19]
    ds_read_b64_tr_b16 v[64:65], v8 offset:20480
    ds_read_b64_tr_b16 v[66:67], v8 offset:20992
    v_mfma_f32_16x16x32_bf16 v[20:23], v[208:211], v[48:51], v[20:23]
    ds_read_b64_tr_b16 v[68:69], v9 offset:20480
    ds_read_b64_tr_b16 v[70:71], v9 offset:20992
    v_mfma_f32_16x16x32_bf16 v[24:27], v[144:147], v[52:55], v[24:27]
    ds_read_b64_tr_b16 v[72:73], v10 offset:20480
    ds_read_b64_tr_b16 v[74:75], v10 offset:20992
    v_mfma_f32_16x16x32_bf16 v[28:31], v[208:211], v[52:55], v[28:31]
    ds_read_b64_tr_b16 v[76:77], v11 offset:20480
    ds_read_b64_tr_b16 v[78:79], v11 offset:20992
    v_mfma_f32_16x16x32_bf16 v[32:35], v[144:147], v[56:59], v[32:35]
    v_mfma_f32_16x16x32_bf16 v[36:39], v[208:211], v[56:59], v[36:39]
    v_mfma_f32_16x16x32_bf16 v[40:43], v[144:147], v[60:63], v[40:43]
    v_mfma_f32_16x16x32_bf16 v[44:47], v[208:211], v[60:63], v[44:47]
    s_waitcnt lgkmcnt(0)
    v_mfma_f32_16x16x32_bf16 v[16:19], v[148:151], v[64:67], v[16:19]
    ds_read_b64_tr_b16 v[48:49], v8 offset:24576
    ds_read_b64_tr_b16 v[50:51], v8 offset:25088
    v_mfma_f32_16x16x32_bf16 v[20:23], v[212:215], v[64:67], v[20:23]
    ds_read_b64_tr_b16 v[52:53], v9 offset:24576
    ds_read_b64_tr_b16 v[54:55], v9 offset:25088
    v_mfma_f32_16x16x32_bf16 v[24:27], v[148:151], v[68:71], v[24:27]
    ds_read_b64_tr_b16 v[56:57], v10 offset:24576
    ds_read_b64_tr_b16 v[58:59], v10 offset:25088
    v_mfma_f32_16x16x32_bf16 v[28:31], v[212:215], v[68:71], v[28:31]
    ds_read_b64_tr_b16 v[60:61], v11 offset:24576
    ds_read_b64_tr_b16 v[62:63], v11 offset:25088
    v_mfma_f32_16x16x32_bf16 v[32:35], v[148:151], v[72:75], v[32:35]
    v_mfma_f32_16x16x32_bf16 v[36:39], v[212:215], v[72:75], v[36:39]
    v_mfma_f32_16x16x32_bf16 v[40:43], v[148:151], v[76:79], v[40:43]
    v_mfma_f32_16x16x32_bf16 v[44:47], v[212:215], v[76:79], v[44:47]
    s_waitcnt lgkmcnt(0)
    v_mfma_f32_16x16x32_bf16 v[16:19], v[152:155], v[48:51], v[16:19]
    ds_read_b64_tr_b16 v[64:65], v8 offset:28672
    ds_read_b64_tr_b16 v[66:67], v8 offset:29184
    v_mfma_f32_16x16x32_bf16 v[20:23], v[216:219], v[48:51], v[20:23]
    ds_read_b64_tr_b16 v[68:69], v9 offset:28672
    ds_read_b64_tr_b16 v[70:71], v9 offset:29184
    v_mfma_f32_16x16x32_bf16 v[24:27], v[152:155], v[52:55], v[24:27]
    ds_read_b64_tr_b16 v[72:73], v10 offset:28672
    ds_read_b64_tr_b16 v[74:75], v10 offset:29184
    v_mfma_f32_16x16x32_bf16 v[28:31], v[216:219], v[52:55], v[28:31]
    ds_read_b64_tr_b16 v[76:77], v11 offset:28672
    ds_read_b64_tr_b16 v[78:79], v11 offset:29184
    v_mfma_f32_16x16x32_bf16 v[32:35], v[152:155], v[56:59], v[32:35]
    v_mfma_f32_16x16x32_bf16 v[36:39], v[216:219], v[56:59], v[36:39]
    v_mfma_f32_16x16x32_bf16 v[40:43], v[152:155], v[60:63], v[40:43]
    v_mfma_f32_16x16x32_bf16 v[44:47], v[216:219], v[60:63], v[44:47]
    s_waitcnt lgkmcnt(0)
    v_mfma_f32_16x16x32_bf16 v[16:19], v[156:159], v[64:67], v[16:19]
    ds_read_b64_tr_b16 v[48:49], v8 offset:32768
    ds_read_b64_tr_b16 v[50:51], v8 offset:33280
    v_mfma_f32_16x16x32_bf16 v[20:23], v[220:223], v[64:67], v[20:23]
    ds_read_b64_tr_b16 v[52:53], v9 offset:32768
    ds_read_b64_tr_b16 v[54:55], v9 offset:33280
    v_mfma_f32_16x16x32_bf16 v[24:27], v[156:159], v[68:71], v[24:27]
    ds_read_b64_tr_b16 v[56:57], v10 offset:32768
    ds_read_b64_tr_b16 v[58:59], v10 offset:33280
    v_mfma_f32_16x16x32_bf16 v[28:31], v[220:223], v[68:71], v[28:31]
    ds_read_b64_tr_b16 v[60:61], v11 offset:32768
    ds_read_b64_tr_b16 v[62:63], v11 offset:33280
    v_mfma_f32_16x16x32_bf16 v[32:35], v[156:159], v[72:75], v[32:35]
    v_mfma_f32_16x16x32_bf16 v[36:39], v[220:223], v[72:75], v[36:39]
    v_mfma_f32_16x16x32_bf16 v[40:43], v[156:159], v[76:79], v[40:43]
    v_mfma_f32_16x16x32_bf16 v[44:47], v[220:223], v[76:79], v[44:47]
    s_waitcnt lgkmcnt(0)
    v_mfma_f32_16x16x32_bf16 v[16:19], v[160:163], v[48:51], v[16:19]
    ds_read_b64_tr_b16 v[64:65], v8 offset:36864
    ds_read_b64_tr_b16 v[66:67], v8 offset:37376
    v_mfma_f32_16x16x32_bf16 v[20:23], v[224:227], v[48:51], v[20:23]
    ds_read_b64_tr_b16 v[68:69], v9 offset:36864
    ds_read_b64_tr_b16 v[70:71], v9 offset:37376
    v_mfma_f32_16x16x32_bf16 v[24:27], v[160:163], v[52:55], v[24:27]
    ds_read_b64_tr_b16 v[72:73], v10 offset:36864
    ds_read_b64_tr_b16 v[74:75], v10 offset:37376
    v_mfma_f32_16x16x32_bf16 v[28:31], v[224:227], v[52:55], v[28:31]
    ds_read_b64_tr_b16 v[76:77], v11 offset:36864
    ds_read_b64_tr_b16 v[78:79], v11 offset:37376
    v_mfma_f32_16x16x32_bf16 v[32:35], v[160:163], v[56:59], v[32:35]
    v_mfma_f32_16x16x32_bf16 v[36:39], v[224:227], v[56:59], v[36:39]
    v_mfma_f32_16x16x32_bf16 v[40:43], v[160:163], v[60:63], v[40:43]
    v_mfma_f32_16x16x32_bf16 v[44:47], v[224:227], v[60:63], v[44:47]
    s_waitcnt lgkmcnt(0)
    v_mfma_f32_16x16x32_bf16 v[16:19], v[164:167], v[64:67], v[16:19]
    ds_read_b64_tr_b16 v[48:49], v8 offset:40960
    ds_read_b64_tr_b16 v[50:51], v8 offset:41472
    v_mfma_f32_16x16x32_bf16 v[20:23], v[228:231], v[64:67], v[20:23]
    ds_read_b64_tr_b16 v[52:53], v9 offset:40960
    ds_read_b64_tr_b16 v[54:55], v9 offset:41472
    v_mfma_f32_16x16x32_bf16 v[24:27], v[164:167], v[68:71], v[24:27]
    ds_read_b64_tr_b16 v[56:57], v10 offset:40960
    ds_read_b64_tr_b16 v[58:59], v10 offset:41472
    v_mfma_f32_16x16x32_bf16 v[28:31], v[228:231], v[68:71], v[28:31]
    ds_read_b64_tr_b16 v[60:61], v11 offset:40960
    ds_read_b64_tr_b16 v[62:63], v11 offset:41472
    v_mfma_f32_16x16x32_bf16 v[32:35], v[164:167], v[72:75], v[32:35]
    v_mfma_f32_16x16x32_bf16 v[36:39], v[228:231], v[72:75], v[36:39]
    v_mfma_f32_16x16x32_bf16 v[40:43], v[164:167], v[76:79], v[40:43]
    v_mfma_f32_16x16x32_bf16 v[44:47], v[228:231], v[76:79], v[44:47]
    s_waitcnt lgkmcnt(0)
    v_mfma_f32_16x16x32_bf16 v[16:19], v[168:171], v[48:51], v[16:19]
    ds_read_b64_tr_b16 v[64:65], v8 offset:45056
    ds_read_b64_tr_b16 v[66:67], v8 offset:45568
    v_mfma_f32_16x16x32_bf16 v[20:23], v[232:235], v[48:51], v[20:23]
    ds_read_b64_tr_b16 v[68:69], v9 offset:45056
    ds_read_b64_tr_b16 v[70:71], v9 offset:45568
    v_mfma_f32_16x16x32_bf16 v[24:27], v[168:171], v[52:55], v[24:27]
    ds_read_b64_tr_b16 v[72:73], v10 offset:45056
    ds_read_b64_tr_b16 v[74:75], v10 offset:45568
    v_mfma_f32_16x16x32_bf16 v[28:31], v[232:235], v[52:55], v[28:31]
    ds_read_b64_tr_b16 v[76:77], v11 offset:45056
    ds_read_b64_tr_b16 v[78:79], v11 offset:45568
    v_mfma_f32_16x16x32_bf16 v[32:35], v[168:171], v[56:59], v[32:35]
    v_mfma_f32_16x16x32_bf16 v[36:39], v[232:235], v[56:59], v[36:39]
    v_mfma_f32_16x16x32_bf16 v[40:43], v[168:171], v[60:63], v[40:43]
    v_mfma_f32_16x16x32_bf16 v[44:47], v[232:235], v[60:63], v[44:47]
    s_waitcnt lgkmcnt(0)
    v_mfma_f32_16x16x32_bf16 v[16:19], v[172:175], v[64:67], v[16:19]
    ds_read_b64_tr_b16 v[48:49], v8 offset:49152
    ds_read_b64_tr_b16 v[50:51], v8 offset:49664
    v_mfma_f32_16x16x32_bf16 v[20:23], v[236:239], v[64:67], v[20:23]
    ds_read_b64_tr_b16 v[52:53], v9 offset:49152
    ds_read_b64_tr_b16 v[54:55], v9 offset:49664
    v_mfma_f32_16x16x32_bf16 v[24:27], v[172:175], v[68:71], v[24:27]
    ds_read_b64_tr_b16 v[56:57], v10 offset:49152
    ds_read_b64_tr_b16 v[58:59], v10 offset:49664
    v_mfma_f32_16x16x32_bf16 v[28:31], v[236:239], v[68:71], v[28:31]
    ds_read_b64_tr_b16 v[60:61], v11 offset:49152
    ds_read_b64_tr_b16 v[62:63], v11 offset:49664
    v_mfma_f32_16x16x32_bf16 v[32:35], v[172:175], v[72:75], v[32:35]
    v_mfma_f32_16x16x32_bf16 v[36:39], v[236:239], v[72:75], v[36:39]
    v_mfma_f32_16x16x32_bf16 v[40:43], v[172:175], v[76:79], v[40:43]
    v_mfma_f32_16x16x32_bf16 v[44:47], v[236:239], v[76:79], v[44:47]
    s_waitcnt lgkmcnt(0)
    v_mfma_f32_16x16x32_bf16 v[16:19], v[176:179], v[48:51], v[16:19]
    ds_read_b64_tr_b16 v[64:65], v8 offset:53248
    ds_read_b64_tr_b16 v[66:67], v8 offset:53760
    v_mfma_f32_16x16x32_bf16 v[20:23], v[240:243], v[48:51], v[20:23]
    ds_read_b64_tr_b16 v[68:69], v9 offset:53248
    ds_read_b64_tr_b16 v[70:71], v9 offset:53760
    v_mfma_f32_16x16x32_bf16 v[24:27], v[176:179], v[52:55], v[24:27]
    ds_read_b64_tr_b16 v[72:73], v10 offset:53248
    ds_read_b64_tr_b16 v[74:75], v10 offset:53760
    v_mfma_f32_16x16x32_bf16 v[28:31], v[240:243], v[52:55], v[28:31]
    ds_read_b64_tr_b16 v[76:77], v11 offset:53248
    ds_read_b64_tr_b16 v[78:79], v11 offset:53760
    v_mfma_f32_16x16x32_bf16 v[32:35], v[176:179], v[56:59], v[32:35]
    v_mfma_f32_16x16x32_bf16 v[36:39], v[240:243], v[56:59], v[36:39]
    v_mfma_f32_16x16x32_bf16 v[40:43], v[176:179], v[60:63], v[40:43]
    v_mfma_f32_16x16x32_bf16 v[44:47], v[240:243], v[60:63], v[44:47]
    s_waitcnt lgkmcnt(0)
    v_mfma_f32_16x16x32_bf16 v[16:19], v[180:183], v[64:67], v[16:19]
    ds_read_b64_tr_b16 v[48:49], v8 offset:57344
    ds_read_b64_tr_b16 v[50:51], v8 offset:57856
    v_mfma_f32_16x16x32_bf16 v[20:23], v[244:247], v[64:67], v[20:23]
    ds_read_b64_tr_b16 v[52:53], v9 offset:57344
    ds_read_b64_tr_b16 v[54:55], v9 offset:57856
    v_mfma_f32_16x16x32_bf16 v[24:27], v[180:183], v[68:71], v[24:27]
    ds_read_b64_tr_b16 v[56:57], v10 offset:57344
    ds_read_b64_tr_b16 v[58:59], v10 offset:57856
    v_mfma_f32_16x16x32_bf16 v[28:31], v[244:247], v[68:71], v[28:31]
    ds_read_b64_tr_b16 v[60:61], v11 offset:57344
    ds_read_b64_tr_b16 v[62:63], v11 offset:57856
    v_mfma_f32_16x16x32_bf16 v[32:35], v[180:183], v[72:75], v[32:35]
    v_mfma_f32_16x16x32_bf16 v[36:39], v[244:247], v[72:75], v[36:39]
    v_mfma_f32_16x16x32_bf16 v[40:43], v[180:183], v[76:79], v[40:43]
    v_mfma_f32_16x16x32_bf16 v[44:47], v[244:247], v[76:79], v[44:47]
    s_waitcnt lgkmcnt(0)
    v_mfma_f32_16x16x32_bf16 v[16:19], v[184:187], v[48:51], v[16:19]
    ds_read_b64_tr_b16 v[64:65], v8 offset:61440
    ds_read_b64_tr_b16 v[66:67], v8 offset:61952
    v_mfma_f32_16x16x32_bf16 v[20:23], v[248:251], v[48:51], v[20:23]
    ds_read_b64_tr_b16 v[68:69], v9 offset:61440
    ds_read_b64_tr_b16 v[70:71], v9 offset:61952
    v_mfma_f32_16x16x32_bf16 v[24:27], v[184:187], v[52:55], v[24:27]
    ds_read_b64_tr_b16 v[72:73], v10 offset:61440
    ds_read_b64_tr_b16 v[74:75], v10 offset:61952
    v_mfma_f32_16x16x32_bf16 v[28:31], v[248:251], v[52:55], v[28:31]
    ds_read_b64_tr_b16 v[76:77], v11 offset:61440
    ds_read_b64_tr_b16 v[78:79], v11 offset:61952
    v_mfma_f32_16x16x32_bf16 v[32:35], v[184:187], v[56:59], v[32:35]
    v_mfma_f32_16x16x32_bf16 v[36:39], v[248:251], v[56:59], v[36:39]
    v_mfma_f32_16x16x32_bf16 v[40:43], v[184:187], v[60:63], v[40:43]
    v_mfma_f32_16x16x32_bf16 v[44:47], v[248:251], v[60:63], v[44:47]
    s_waitcnt lgkmcnt(0)
    v_mfma_f32_16x16x32_bf16 v[16:19], v[188:191], v[64:67], v[16:19]
    v_mfma_f32_16x16x32_bf16 v[20:23], v[252:255], v[64:67], v[20:23]
    v_mfma_f32_16x16x32_bf16 v[24:27], v[188:191], v[68:71], v[24:27]
    v_mfma_f32_16x16x32_bf16 v[28:31], v[252:255], v[68:71], v[28:31]
    v_mfma_f32_16x16x32_bf16 v[32:35], v[188:191], v[72:75], v[32:35]
    v_mfma_f32_16x16x32_bf16 v[36:39], v[252:255], v[72:75], v[36:39]
    v_mfma_f32_16x16x32_bf16 v[40:43], v[188:191], v[76:79], v[40:43]
    v_mfma_f32_16x16x32_bf16 v[44:47], v[252:255], v[76:79], v[44:47]
    v_subrev_u32 v8, 65536, v8
    v_subrev_u32 v9, 65536, v9
    v_subrev_u32 v10, 65536, v10
    v_subrev_u32 v11, 65536, v11
    s_nop 7
    v_cvt_pk_bf16_f32 v96, v16, v17
    v_cvt_pk_bf16_f32 v97, v18, v19
    v_cvt_pk_bf16_f32 v98, v20, v21
    v_cvt_pk_bf16_f32 v99, v22, v23
    v_cvt_pk_bf16_f32 v100, v24, v25
    v_cvt_pk_bf16_f32 v101, v26, v27
    v_cvt_pk_bf16_f32 v102, v28, v29
    v_cvt_pk_bf16_f32 v103, v30, v31
    v_cvt_pk_bf16_f32 v104, v32, v33
    v_cvt_pk_bf16_f32 v105, v34, v35
    v_cvt_pk_bf16_f32 v106, v36, v37
    v_cvt_pk_bf16_f32 v107, v38, v39
    v_cvt_pk_bf16_f32 v108, v40, v41
    v_cvt_pk_bf16_f32 v109, v42, v43
    v_cvt_pk_bf16_f32 v110, v44, v45
    v_cvt_pk_bf16_f32 v111, v46, v47
    v_mov_b32 v48, 0x3f803f80
    v_mov_b32 v49, 0x3f803f80
    v_mov_b32 v50, 0x3f803f80
    v_mov_b32 v51, 0x3f803f80
    s_nop 1
    v_mfma_f32_16x16x32_bf16 v[16:19], v[80:83], v[96:99], 0
    v_mfma_f32_16x16x32_bf16 v[20:23], v[80:83], v[48:51], 0
    v_mfma_f32_16x16x32_bf16 v[24:27], v[84:87], v[100:103], 0
    v_mfma_f32_16x16x32_bf16 v[28:31], v[84:87], v[48:51], 0
    v_mfma_f32_16x16x32_bf16 v[32:35], v[88:91], v[104:107], 0
    v_mfma_f32_16x16x32_bf16 v[36:39], v[88:91], v[48:51], 0
    v_mfma_f32_16x16x32_bf16 v[40:43], v[92:95], v[108:111], 0
    v_mfma_f32_16x16x32_bf16 v[44:47], v[92:95], v[48:51], 0
    s_lshl_b32 s19, s16, 11
    s_add_u32 s19, s19, 131072
    v_add_u32 v52, s19, v0
    s_lshl_b32 s19, s16, 13
    s_add_u32 s19, s19, 131072
    v_add_u32 v53, s19, v0
    s_nop 7
    ds_write_b128 v52, v[16:19] offset:0
    ds_write_b128 v52, v[20:23] offset:1024
    ds_write_b128 v52, v[24:27] offset:8192
    ds_write_b128 v52, v[28:31] offset:9216
    ds_write_b128 v52, v[32:35] offset:16384
    ds_write_b128 v52, v[36:39] offset:17408
    ds_write_b128 v52, v[40:43] offset:24576
    ds_write_b128 v52, v[44:47] offset:25600
    s_waitcnt vmcnt(0) lgkmcnt(0)
    s_barrier
    s_lshl_b32 s19, s16, 14
    s_add_u32 m0, s19, 65536
    s_lshl_b32 s20, s30, 7
    s_lshl_b32 s34, s16, 17
    s_add_u32 s34, s34, s20
    buffer_load_dwordx4 v6, s[4:7], s34 offen lds
    s_add_u32 s34, s34, 4096
    s_add_u32 m0, m0, 1024
    s_nop 0
    buffer_load_dwordx4 v7, s[4:7], s34 offen lds
    s_add_u32 s34, s34, 4096
    s_add_u32 m0, m0, 1024
    s_nop 0
    buffer_load_dwordx4 v6, s[4:7], s34 offen lds
    s_add_u32 s34, s34, 4096
    s_add_u32 m0, m0, 1024
    s_nop 0
    buffer_load_dwordx4 v7, s[4:7], s34 offen lds
    s_add_u32 s34, s34, 20480
    s_add_u32 m0, m0, 1024
    s_nop 0
    buffer_load_dwordx4 v6, s[4:7], s34 offen lds
    s_add_u32 s34, s34, 4096
    s_add_u32 m0, m0, 1024
    s_nop 0
    buffer_load_dwordx4 v7, s[4:7], s34 offen lds
    s_add_u32 s34, s34, 4096
    s_add_u32 m0, m0, 1024
    s_nop 0
    buffer_load_dwordx4 v6, s[4:7], s34 offen lds
    s_add_u32 s34, s34, 4096
    s_add_u32 m0, m0, 1024
    s_nop 0
    buffer_load_dwordx4 v7, s[4:7], s34 offen lds
    s_add_u32 s34, s34, 20480
    s_add_u32 m0, m0, 1024
    s_nop 0
    buffer_load_dwordx4 v6, s[4:7], s34 offen lds
    s_add_u32 s34, s34, 4096
    s_add_u32 m0, m0, 1024
    s_nop 0
    buffer_load_dwordx4 v7, s[4:7], s34 offen lds
    s_add_u32 s34, s34, 4096
    s_add_u32 m0, m0, 1024
    s_nop 0
    buffer_load_dwordx4 v6, s[4:7], s34 offen lds
    s_add_u32 s34, s34, 4096
    s_add_u32 m0, m0, 1024
    s_nop 0
    buffer_load_dwordx4 v7, s[4:7], s34 offen lds
    s_add_u32 s34, s34, 20480
    s_add_u32 m0, m0, 1024
    s_nop 0
    buffer_load_dwordx4 v6, s[4:7], s34 offen lds
    s_add_u32 s34, s34, 4096
    s_add_u32 m0, m0, 1024
    s_nop 0
    buffer_load_dwordx4 v7, s[4:7], s34 offen lds
    s_add_u32 s34, s34, 4096
    s_add_u32 m0, m0, 1024
    s_nop 0
    buffer_load_dwordx4 v6, s[4:7], s34 offen lds
    s_add_u32 s34, s34, 4096
    s_add_u32 m0, m0, 1024
    s_nop 0
    buffer_load_dwordx4 v7, s[4:7], s34 offen lds
    s_add_u32 s34, s34, 20480
    s_add_u32 m0, m0, 1024
    s_nop 0
    ds_read_b128 v[16:19], v53 offset:0
    ds_read_b128 v[20:23], v53 offset:1024
    ds_read_b128 v[24:27], v53 offset:2048
    ds_read_b128 v[28:31], v53 offset:3072
    ds_read_b128 v[32:35], v53 offset:4096
    ds_read_b128 v[36:39], v53 offset:5120
    ds_read_b128 v[40:43], v53 offset:6144
    ds_read_b128 v[44:47], v53 offset:7168
    s_waitcnt lgkmcnt(0)
    v_add_f32 v16, v16, v24
    v_add_f32 v17, v17, v25
    v_add_f32 v18, v18, v26
    v_add_f32 v19, v19, v27
    v_add_f32 v20, v20, v28
    v_add_f32 v21, v21, v29
    v_add_f32 v22, v22, v30
    v_add_f32 v23, v23, v31
    v_add_f32 v16, v16, v32
    v_add_f32 v17, v17, v33
    v_add_f32 v18, v18, v34
    v_add_f32 v19, v19, v35
    v_add_f32 v20, v20, v36
    v_add_f32 v21, v21, v37
    v_add_f32 v22, v22, v38
    v_add_f32 v23, v23, v39
    v_add_f32 v16, v16, v40
    v_add_f32 v17, v17, v41
    v_add_f32 v18, v18, v42
    v_add_f32 v19, v19, v43
    v_add_f32 v20, v20, v44
    v_add_f32 v21, v21, v45
    v_add_f32 v22, v22, v46
    v_add_f32 v23, v23, v47
    s_lshl_b32 s35, s30, 17
    s_lshl_b32 s19, s16, 11
    s_add_u32 s35, s35, s19
    s_add_u32 s35, s35, 83886080
    s_lshl_b32 s19, s31, 13
    s_add_u32 s19, s19, s35
    buffer_store_dwordx4 v[16:19], v0, s[8:11], s19 offen sc1
    buffer_store_dwordx4 v[20:23], v0, s[8:11], s19 offen offset:1024 sc1
    s_lshl_b32 s36, s30, 12
    s_add_u32 s36, s36, 63963648
    s_waitcnt vmcnt(0)
    s_barrier
    buffer_atomic_add v3, v2, s[8:11], s36 offen
    ds_read_b64_tr_b16 v[48:49], v8 offset:0
    ds_read_b64_tr_b16 v[50:51], v8 offset:512
    ds_read_b64_tr_b16 v[52:53], v9 offset:0
    ds_read_b64_tr_b16 v[54:55], v9 offset:512
    ds_read_b64_tr_b16 v[56:57], v10 offset:0
    ds_read_b64_tr_b16 v[58:59], v10 offset:512
    ds_read_b64_tr_b16 v[60:61], v11 offset:0
    ds_read_b64_tr_b16 v[62:63], v11 offset:512
    s_waitcnt lgkmcnt(0)
    v_mfma_f32_16x16x32_bf16 v[16:19], v[48:51], v[128:131], 0
    ds_read_b64_tr_b16 v[64:65], v8 offset:4096
    ds_read_b64_tr_b16 v[66:67], v8 offset:4608
    v_mfma_f32_16x16x32_bf16 v[20:23], v[48:51], v[192:195], 0
    ds_read_b64_tr_b16 v[68:69], v9 offset:4096
    ds_read_b64_tr_b16 v[70:71], v9 offset:4608
    v_mfma_f32_16x16x32_bf16 v[24:27], v[52:55], v[128:131], 0
    ds_read_b64_tr_b16 v[72:73], v10 offset:4096
    ds_read_b64_tr_b16 v[74:75], v10 offset:4608
    v_mfma_f32_16x16x32_bf16 v[28:31], v[52:55], v[192:195], 0
    ds_read_b64_tr_b16 v[76:77], v11 offset:4096
    ds_read_b64_tr_b16 v[78:79], v11 offset:4608
    v_mfma_f32_16x16x32_bf16 v[32:35], v[56:59], v[128:131], 0
    v_mfma_f32_16x16x32_bf16 v[36:39], v[56:59], v[192:195], 0
    v_mfma_f32_16x16x32_bf16 v[40:43], v[60:63], v[128:131], 0
    v_mfma_f32_16x16x32_bf16 v[44:47], v[60:63], v[192:195], 0
    s_waitcnt lgkmcnt(0)
    v_mfma_f32_16x16x32_bf16 v[16:19], v[64:67], v[132:135], v[16:19]
    ds_read_b64_tr_b16 v[48:49], v8 offset:8192
    ds_read_b64_tr_b16 v[50:51], v8 offset:8704
    v_mfma_f32_16x16x32_bf16 v[20:23], v[64:67], v[196:199], v[20:23]
    ds_read_b64_tr_b16 v[52:53], v9 offset:8192
    ds_read_b64_tr_b16 v[54:55], v9 offset:8704
    v_mfma_f32_16x16x32_bf16 v[24:27], v[68:71], v[132:135], v[24:27]
    ds_read_b64_tr_b16 v[56:57], v10 offset:8192
    ds_read_b64_tr_b16 v[58:59], v10 offset:8704
    v_mfma_f32_16x16x32_bf16 v[28:31], v[68:71], v[196:199], v[28:31]
    ds_read_b64_tr_b16 v[60:61], v11 offset:8192
    ds_read_b64_tr_b16 v[62:63], v11 offset:8704
    v_mfma_f32_16x16x32_bf16 v[32:35], v[72:75], v[132:135], v[32:35]
    v_mfma_f32_16x16x32_bf16 v[36:39], v[72:75], v[196:199], v[36:39]
    v_mfma_f32_16x16x32_bf16 v[40:43], v[76:79], v[132:135], v[40:43]
    v_mfma_f32_16x16x32_bf16 v[44:47], v[76:79], v[196:199], v[44:47]
    s_waitcnt lgkmcnt(0)
    v_mfma_f32_16x16x32_bf16 v[16:19], v[48:51], v[136:139], v[16:19]
    ds_read_b64_tr_b16 v[64:65], v8 offset:12288
    ds_read_b64_tr_b16 v[66:67], v8 offset:12800
    v_mfma_f32_16x16x32_bf16 v[20:23], v[48:51], v[200:203], v[20:23]
    ds_read_b64_tr_b16 v[68:69], v9 offset:12288
    ds_read_b64_tr_b16 v[70:71], v9 offset:12800
    v_mfma_f32_16x16x32_bf16 v[24:27], v[52:55], v[136:139], v[24:27]
    ds_read_b64_tr_b16 v[72:73], v10 offset:12288
    ds_read_b64_tr_b16 v[74:75], v10 offset:12800
    v_mfma_f32_16x16x32_bf16 v[28:31], v[52:55], v[200:203], v[28:31]
    ds_read_b64_tr_b16 v[76:77], v11 offset:12288
    ds_read_b64_tr_b16 v[78:79], v11 offset:12800
    v_mfma_f32_16x16x32_bf16 v[32:35], v[56:59], v[136:139], v[32:35]
    v_mfma_f32_16x16x32_bf16 v[36:39], v[56:59], v[200:203], v[36:39]
    v_mfma_f32_16x16x32_bf16 v[40:43], v[60:63], v[136:139], v[40:43]
    v_mfma_f32_16x16x32_bf16 v[44:47], v[60:63], v[200:203], v[44:47]
    s_waitcnt lgkmcnt(0)
    v_mfma_f32_16x16x32_bf16 v[16:19], v[64:67], v[140:143], v[16:19]
    ds_read_b64_tr_b16 v[48:49], v8 offset:16384
    ds_read_b64_tr_b16 v[50:51], v8 offset:16896
    v_mfma_f32_16x16x32_bf16 v[20:23], v[64:67], v[204:207], v[20:23]
    ds_read_b64_tr_b16 v[52:53], v9 offset:16384
    ds_read_b64_tr_b16 v[54:55], v9 offset:16896
    v_mfma_f32_16x16x32_bf16 v[24:27], v[68:71], v[140:143], v[24:27]
    ds_read_b64_tr_b16 v[56:57], v10 offset:16384
    ds_read_b64_tr_b16 v[58:59], v10 offset:16896
    v_mfma_f32_16x16x32_bf16 v[28:31], v[68:71], v[204:207], v[28:31]
    ds_read_b64_tr_b16 v[60:61], v11 offset:16384
    ds_read_b64_tr_b16 v[62:63], v11 offset:16896
    v_mfma_f32_16x16x32_bf16 v[32:35], v[72:75], v[140:143], v[32:35]
    v_mfma_f32_16x16x32_bf16 v[36:39], v[72:75], v[204:207], v[36:39]
    v_mfma_f32_16x16x32_bf16 v[40:43], v[76:79], v[140:143], v[40:43]
    v_mfma_f32_16x16x32_bf16 v[44:47], v[76:79], v[204:207], v[44:47]
    s_waitcnt lgkmcnt(0)
    v_mfma_f32_16x16x32_bf16 v[16:19], v[48:51], v[144:147], v[16:19]
    ds_read_b64_tr_b16 v[64:65], v8 offset:20480
    ds_read_b64_tr_b16 v[66:67], v8 offset:20992
    v_mfma_f32_16x16x32_bf16 v[20:23], v[48:51], v[208:211], v[20:23]
    ds_read_b64_tr_b16 v[68:69], v9 offset:20480
    ds_read_b64_tr_b16 v[70:71], v9 offset:20992
    v_mfma_f32_16x16x32_bf16 v[24:27], v[52:55], v[144:147], v[24:27]
    ds_read_b64_tr_b16 v[72:73], v10 offset:20480
    ds_read_b64_tr_b16 v[74:75], v10 offset:20992
    v_mfma_f32_16x16x32_bf16 v[28:31], v[52:55], v[208:211], v[28:31]
    ds_read_b64_tr_b16 v[76:77], v11 offset:20480
    ds_read_b64_tr_b16 v[78:79], v11 offset:20992
    v_mfma_f32_16x16x32_bf16 v[32:35], v[56:59], v[144:147], v[32:35]
    v_mfma_f32_16x16x32_bf16 v[36:39], v[56:59], v[208:211], v[36:39]
    v_mfma_f32_16x16x32_bf16 v[40:43], v[60:63], v[144:147], v[40:43]
    v_mfma_f32_16x16x32_bf16 v[44:47], v[60:63], v[208:211], v[44:47]
    s_waitcnt lgkmcnt(0)
    v_mfma_f32_16x16x32_bf16 v[16:19], v[64:67], v[148:151], v[16:19]
    ds_read_b64_tr_b16 v[48:49], v8 offset:24576
    ds_read_b64_tr_b16 v[50:51], v8 offset:25088
    v_mfma_f32_16x16x32_bf16 v[20:23], v[64:67], v[212:215], v[20:23]
    ds_read_b64_tr_b16 v[52:53], v9 offset:24576
    ds_read_b64_tr_b16 v[54:55], v9 offset:25088
    v_mfma_f32_16x16x32_bf16 v[24:27], v[68:71], v[148:151], v[24:27]
    ds_read_b64_tr_b16 v[56:57], v10 offset:24576
    ds_read_b64_tr_b16 v[58:59], v10 offset:25088
    v_mfma_f32_16x16x32_bf16 v[28:31], v[68:71], v[212:215], v[28:31]
    ds_read_b64_tr_b16 v[60:61], v11 offset:24576
    ds_read_b64_tr_b16 v[62:63], v11 offset:25088
    v_mfma_f32_16x16x32_bf16 v[32:35], v[72:75], v[148:151], v[32:35]
    v_mfma_f32_16x16x32_bf16 v[36:39], v[72:75], v[212:215], v[36:39]
    v_mfma_f32_16x16x32_bf16 v[40:43], v[76:79], v[148:151], v[40:43]
    v_mfma_f32_16x16x32_bf16 v[44:47], v[76:79], v[212:215], v[44:47]
    s_waitcnt lgkmcnt(0)
    v_mfma_f32_16x16x32_bf16 v[16:19], v[48:51], v[152:155], v[16:19]
    ds_read_b64_tr_b16 v[64:65], v8 offset:28672
    ds_read_b64_tr_b16 v[66:67], v8 offset:29184
    v_mfma_f32_16x16x32_bf16 v[20:23], v[48:51], v[216:219], v[20:23]
    ds_read_b64_tr_b16 v[68:69], v9 offset:28672
    ds_read_b64_tr_b16 v[70:71], v9 offset:29184
    v_mfma_f32_16x16x32_bf16 v[24:27], v[52:55], v[152:155], v[24:27]
    ds_read_b64_tr_b16 v[72:73], v10 offset:28672
    ds_read_b64_tr_b16 v[74:75], v10 offset:29184
    v_mfma_f32_16x16x32_bf16 v[28:31], v[52:55], v[216:219], v[28:31]
    ds_read_b64_tr_b16 v[76:77], v11 offset:28672
    ds_read_b64_tr_b16 v[78:79], v11 offset:29184
    v_mfma_f32_16x16x32_bf16 v[32:35], v[56:59], v[152:155], v[32:35]
    v_mfma_f32_16x16x32_bf16 v[36:39], v[56:59], v[216:219], v[36:39]
    v_mfma_f32_16x16x32_bf16 v[40:43], v[60:63], v[152:155], v[40:43]
    v_mfma_f32_16x16x32_bf16 v[44:47], v[60:63], v[216:219], v[44:47]
    s_waitcnt lgkmcnt(0)
    v_mfma_f32_16x16x32_bf16 v[16:19], v[64:67], v[156:159], v[16:19]
    ds_read_b64_tr_b16 v[48:49], v8 offset:32768
    ds_read_b64_tr_b16 v[50:51], v8 offset:33280
    v_mfma_f32_16x16x32_bf16 v[20:23], v[64:67], v[220:223], v[20:23]
    ds_read_b64_tr_b16 v[52:53], v9 offset:32768
    ds_read_b64_tr_b16 v[54:55], v9 offset:33280
    v_mfma_f32_16x16x32_bf16 v[24:27], v[68:71], v[156:159], v[24:27]
    ds_read_b64_tr_b16 v[56:57], v10 offset:32768
    ds_read_b64_tr_b16 v[58:59], v10 offset:33280
    v_mfma_f32_16x16x32_bf16 v[28:31], v[68:71], v[220:223], v[28:31]
    ds_read_b64_tr_b16 v[60:61], v11 offset:32768
    ds_read_b64_tr_b16 v[62:63], v11 offset:33280
    v_mfma_f32_16x16x32_bf16 v[32:35], v[72:75], v[156:159], v[32:35]
    v_mfma_f32_16x16x32_bf16 v[36:39], v[72:75], v[220:223], v[36:39]
    v_mfma_f32_16x16x32_bf16 v[40:43], v[76:79], v[156:159], v[40:43]
    v_mfma_f32_16x16x32_bf16 v[44:47], v[76:79], v[220:223], v[44:47]
    s_waitcnt lgkmcnt(0)
    v_mfma_f32_16x16x32_bf16 v[16:19], v[48:51], v[160:163], v[16:19]
    ds_read_b64_tr_b16 v[64:65], v8 offset:36864
    ds_read_b64_tr_b16 v[66:67], v8 offset:37376
    v_mfma_f32_16x16x32_bf16 v[20:23], v[48:51], v[224:227], v[20:23]
    ds_read_b64_tr_b16 v[68:69], v9 offset:36864
    ds_read_b64_tr_b16 v[70:71], v9 offset:37376
    v_mfma_f32_16x16x32_bf16 v[24:27], v[52:55], v[160:163], v[24:27]
    ds_read_b64_tr_b16 v[72:73], v10 offset:36864
    ds_read_b64_tr_b16 v[74:75], v10 offset:37376
    v_mfma_f32_16x16x32_bf16 v[28:31], v[52:55], v[224:227], v[28:31]
    ds_read_b64_tr_b16 v[76:77], v11 offset:36864
    ds_read_b64_tr_b16 v[78:79], v11 offset:37376
    v_mfma_f32_16x16x32_bf16 v[32:35], v[56:59], v[160:163], v[32:35]
    v_mfma_f32_16x16x32_bf16 v[36:39], v[56:59], v[224:227], v[36:39]
    v_mfma_f32_16x16x32_bf16 v[40:43], v[60:63], v[160:163], v[40:43]
    v_mfma_f32_16x16x32_bf16 v[44:47], v[60:63], v[224:227], v[44:47]
    s_waitcnt lgkmcnt(0)
    v_mfma_f32_16x16x32_bf16 v[16:19], v[64:67], v[164:167], v[16:19]
    ds_read_b64_tr_b16 v[48:49], v8 offset:40960
    ds_read_b64_tr_b16 v[50:51], v8 offset:41472
    v_mfma_f32_16x16x32_bf16 v[20:23], v[64:67], v[228:231], v[20:23]
    ds_read_b64_tr_b16 v[52:53], v9 offset:40960
    ds_read_b64_tr_b16 v[54:55], v9 offset:41472
    v_mfma_f32_16x16x32_bf16 v[24:27], v[68:71], v[164:167], v[24:27]
    ds_read_b64_tr_b16 v[56:57], v10 offset:40960
    ds_read_b64_tr_b16 v[58:59], v10 offset:41472
    v_mfma_f32_16x16x32_bf16 v[28:31], v[68:71], v[228:231], v[28:31]
    ds_read_b64_tr_b16 v[60:61], v11 offset:40960
    ds_read_b64_tr_b16 v[62:63], v11 offset:41472
    v_mfma_f32_16x16x32_bf16 v[32:35], v[72:75], v[164:167], v[32:35]
    v_mfma_f32_16x16x32_bf16 v[36:39], v[72:75], v[228:231], v[36:39]
    v_mfma_f32_16x16x32_bf16 v[40:43], v[76:79], v[164:167], v[40:43]
    v_mfma_f32_16x16x32_bf16 v[44:47], v[76:79], v[228:231], v[44:47]
    s_waitcnt lgkmcnt(0)
    v_mfma_f32_16x16x32_bf16 v[16:19], v[48:51], v[168:171], v[16:19]
    ds_read_b64_tr_b16 v[64:65], v8 offset:45056
    ds_read_b64_tr_b16 v[66:67], v8 offset:45568
    v_mfma_f32_16x16x32_bf16 v[20:23], v[48:51], v[232:235], v[20:23]
    ds_read_b64_tr_b16 v[68:69], v9 offset:45056
    ds_read_b64_tr_b16 v[70:71], v9 offset:45568
    v_mfma_f32_16x16x32_bf16 v[24:27], v[52:55], v[168:171], v[24:27]
    ds_read_b64_tr_b16 v[72:73], v10 offset:45056
    ds_read_b64_tr_b16 v[74:75], v10 offset:45568
    v_mfma_f32_16x16x32_bf16 v[28:31], v[52:55], v[232:235], v[28:31]
    ds_read_b64_tr_b16 v[76:77], v11 offset:45056
    ds_read_b64_tr_b16 v[78:79], v11 offset:45568
    v_mfma_f32_16x16x32_bf16 v[32:35], v[56:59], v[168:171], v[32:35]
    v_mfma_f32_16x16x32_bf16 v[36:39], v[56:59], v[232:235], v[36:39]
    v_mfma_f32_16x16x32_bf16 v[40:43], v[60:63], v[168:171], v[40:43]
    v_mfma_f32_16x16x32_bf16 v[44:47], v[60:63], v[232:235], v[44:47]
    s_waitcnt lgkmcnt(0)
    v_mfma_f32_16x16x32_bf16 v[16:19], v[64:67], v[172:175], v[16:19]
    ds_read_b64_tr_b16 v[48:49], v8 offset:49152
    ds_read_b64_tr_b16 v[50:51], v8 offset:49664
    v_mfma_f32_16x16x32_bf16 v[20:23], v[64:67], v[236:239], v[20:23]
    ds_read_b64_tr_b16 v[52:53], v9 offset:49152
    ds_read_b64_tr_b16 v[54:55], v9 offset:49664
    v_mfma_f32_16x16x32_bf16 v[24:27], v[68:71], v[172:175], v[24:27]
    ds_read_b64_tr_b16 v[56:57], v10 offset:49152
    ds_read_b64_tr_b16 v[58:59], v10 offset:49664
    v_mfma_f32_16x16x32_bf16 v[28:31], v[68:71], v[236:239], v[28:31]
    ds_read_b64_tr_b16 v[60:61], v11 offset:49152
    ds_read_b64_tr_b16 v[62:63], v11 offset:49664
    v_mfma_f32_16x16x32_bf16 v[32:35], v[72:75], v[172:175], v[32:35]
    v_mfma_f32_16x16x32_bf16 v[36:39], v[72:75], v[236:239], v[36:39]
    v_mfma_f32_16x16x32_bf16 v[40:43], v[76:79], v[172:175], v[40:43]
    v_mfma_f32_16x16x32_bf16 v[44:47], v[76:79], v[236:239], v[44:47]
    s_waitcnt lgkmcnt(0)
    v_mfma_f32_16x16x32_bf16 v[16:19], v[48:51], v[176:179], v[16:19]
    ds_read_b64_tr_b16 v[64:65], v8 offset:53248
    ds_read_b64_tr_b16 v[66:67], v8 offset:53760
    v_mfma_f32_16x16x32_bf16 v[20:23], v[48:51], v[240:243], v[20:23]
    ds_read_b64_tr_b16 v[68:69], v9 offset:53248
    ds_read_b64_tr_b16 v[70:71], v9 offset:53760
    v_mfma_f32_16x16x32_bf16 v[24:27], v[52:55], v[176:179], v[24:27]
    ds_read_b64_tr_b16 v[72:73], v10 offset:53248
    ds_read_b64_tr_b16 v[74:75], v10 offset:53760
    v_mfma_f32_16x16x32_bf16 v[28:31], v[52:55], v[240:243], v[28:31]
    ds_read_b64_tr_b16 v[76:77], v11 offset:53248
    ds_read_b64_tr_b16 v[78:79], v11 offset:53760
    v_mfma_f32_16x16x32_bf16 v[32:35], v[56:59], v[176:179], v[32:35]
    v_mfma_f32_16x16x32_bf16 v[36:39], v[56:59], v[240:243], v[36:39]
    v_mfma_f32_16x16x32_bf16 v[40:43], v[60:63], v[176:179], v[40:43]
    v_mfma_f32_16x16x32_bf16 v[44:47], v[60:63], v[240:243], v[44:47]
    s_waitcnt lgkmcnt(0)
    v_mfma_f32_16x16x32_bf16 v[16:19], v[64:67], v[180:183], v[16:19]
    ds_read_b64_tr_b16 v[48:49], v8 offset:57344
    ds_read_b64_tr_b16 v[50:51], v8 offset:57856
    v_mfma_f32_16x16x32_bf16 v[20:23], v[64:67], v[244:247], v[20:23]
    ds_read_b64_tr_b16 v[52:53], v9 offset:57344
    ds_read_b64_tr_b16 v[54:55], v9 offset:57856
    v_mfma_f32_16x16x32_bf16 v[24:27], v[68:71], v[180:183], v[24:27]
    ds_read_b64_tr_b16 v[56:57], v10 offset:57344
    ds_read_b64_tr_b16 v[58:59], v10 offset:57856
    v_mfma_f32_16x16x32_bf16 v[28:31], v[68:71], v[244:247], v[28:31]
    ds_read_b64_tr_b16 v[60:61], v11 offset:57344
    ds_read_b64_tr_b16 v[62:63], v11 offset:57856
    v_mfma_f32_16x16x32_bf16 v[32:35], v[72:75], v[180:183], v[32:35]
    v_mfma_f32_16x16x32_bf16 v[36:39], v[72:75], v[244:247], v[36:39]
    v_mfma_f32_16x16x32_bf16 v[40:43], v[76:79], v[180:183], v[40:43]
    v_mfma_f32_16x16x32_bf16 v[44:47], v[76:79], v[244:247], v[44:47]
    s_waitcnt lgkmcnt(0)
    v_mfma_f32_16x16x32_bf16 v[16:19], v[48:51], v[184:187], v[16:19]
    ds_read_b64_tr_b16 v[64:65], v8 offset:61440
    ds_read_b64_tr_b16 v[66:67], v8 offset:61952
    v_mfma_f32_16x16x32_bf16 v[20:23], v[48:51], v[248:251], v[20:23]
    ds_read_b64_tr_b16 v[68:69], v9 offset:61440
    ds_read_b64_tr_b16 v[70:71], v9 offset:61952
    v_mfma_f32_16x16x32_bf16 v[24:27], v[52:55], v[184:187], v[24:27]
    ds_read_b64_tr_b16 v[72:73], v10 offset:61440
    ds_read_b64_tr_b16 v[74:75], v10 offset:61952
    v_mfma_f32_16x16x32_bf16 v[28:31], v[52:55], v[248:251], v[28:31]
    ds_read_b64_tr_b16 v[76:77], v11 offset:61440
    ds_read_b64_tr_b16 v[78:79], v11 offset:61952
    v_mfma_f32_16x16x32_bf16 v[32:35], v[56:59], v[184:187], v[32:35]
    v_mfma_f32_16x16x32_bf16 v[36:39], v[56:59], v[248:251], v[36:39]
    v_mfma_f32_16x16x32_bf16 v[40:43], v[60:63], v[184:187], v[40:43]
    v_mfma_f32_16x16x32_bf16 v[44:47], v[60:63], v[248:251], v[44:47]
    s_waitcnt lgkmcnt(0)
    v_mfma_f32_16x16x32_bf16 v[16:19], v[64:67], v[188:191], v[16:19]
    v_mfma_f32_16x16x32_bf16 v[20:23], v[64:67], v[252:255], v[20:23]
    v_mfma_f32_16x16x32_bf16 v[24:27], v[68:71], v[188:191], v[24:27]
    v_mfma_f32_16x16x32_bf16 v[28:31], v[68:71], v[252:255], v[28:31]
    v_mfma_f32_16x16x32_bf16 v[32:35], v[72:75], v[188:191], v[32:35]
    v_mfma_f32_16x16x32_bf16 v[36:39], v[72:75], v[252:255], v[36:39]
    v_mfma_f32_16x16x32_bf16 v[40:43], v[76:79], v[188:191], v[40:43]
    v_mfma_f32_16x16x32_bf16 v[44:47], v[76:79], v[252:255], v[44:47]
    s_nop 7
    s_mov_b32 s19, 0x3fb8aa3b
    s_mov_b32 s20, 0x358637bd
    v_mul_f32 v48, s19, v16
    v_mul_f32 v49, s19, v17
    v_mul_f32 v50, s19, v18
    v_mul_f32 v51, s19, v19
    v_mul_f32 v52, s19, v20
    v_mul_f32 v53, s19, v21
    v_mul_f32 v54, s19, v22
    v_mul_f32 v55, s19, v23
    v_min_f32 v48, 0, v48
    v_min_f32 v49, 0, v49
    v_min_f32 v50, 0, v50
    v_min_f32 v51, 0, v51
    v_min_f32 v52, 0, v52
    v_min_f32 v53, 0, v53
    v_min_f32 v54, 0, v54
    v_min_f32 v55, 0, v55
    v_exp_f32 v48, v48
    v_exp_f32 v49, v49
    v_exp_f32 v50, v50
    v_exp_f32 v51, v51
    v_exp_f32 v52, v52
    v_exp_f32 v53, v53
    v_exp_f32 v54, v54
    v_exp_f32 v55, v55
    v_max_f32 v16, 0, v16
    v_max_f32 v17, 0, v17
    v_max_f32 v18, 0, v18
    v_max_f32 v19, 0, v19
    v_max_f32 v20, 0, v20
    v_max_f32 v21, 0, v21
    v_max_f32 v22, 0, v22
    v_max_f32 v23, 0, v23
    v_add_f32 v16, v16, v48
    v_add_f32 v17, v17, v49
    v_add_f32 v18, v18, v50
    v_add_f32 v19, v19, v51
    v_add_f32 v20, v20, v52
    v_add_f32 v21, v21, v53
    v_add_f32 v22, v22, v54
    v_add_f32 v23, v23, v55
    v_add_f32 v16, s20, v16
    v_add_f32 v17, s20, v17
    v_add_f32 v18, s20, v18
    v_add_f32 v19, s20, v19
    v_add_f32 v20, s20, v20
    v_add_f32 v21, s20, v21
    v_add_f32 v22, s20, v22
    v_add_f32 v23, s20, v23
    v_mul_f32 v48, s19, v24
    v_mul_f32 v49, s19, v25
    v_mul_f32 v50, s19, v26
    v_mul_f32 v51, s19, v27
    v_mul_f32 v52, s19, v28
    v_mul_f32 v53, s19, v29
    v_mul_f32 v54, s19, v30
    v_mul_f32 v55, s19, v31
    v_min_f32 v48, 0, v48
    v_min_f32 v49, 0, v49
    v_min_f32 v50, 0, v50
    v_min_f32 v51, 0, v51
    v_min_f32 v52, 0, v52
    v_min_f32 v53, 0, v53
    v_min_f32 v54, 0, v54
    v_min_f32 v55, 0, v55
    v_exp_f32 v48, v48
    v_exp_f32 v49, v49
    v_exp_f32 v50, v50
    v_exp_f32 v51, v51
    v_exp_f32 v52, v52
    v_exp_f32 v53, v53
    v_exp_f32 v54, v54
    v_exp_f32 v55, v55
    v_max_f32 v24, 0, v24
    v_max_f32 v25, 0, v25
    v_max_f32 v26, 0, v26
    v_max_f32 v27, 0, v27
    v_max_f32 v28, 0, v28
    v_max_f32 v29, 0, v29
    v_max_f32 v30, 0, v30
    v_max_f32 v31, 0, v31
    v_add_f32 v24, v24, v48
    v_add_f32 v25, v25, v49
    v_add_f32 v26, v26, v50
    v_add_f32 v27, v27, v51
    v_add_f32 v28, v28, v52
    v_add_f32 v29, v29, v53
    v_add_f32 v30, v30, v54
    v_add_f32 v31, v31, v55
    v_add_f32 v24, s20, v24
    v_add_f32 v25, s20, v25
    v_add_f32 v26, s20, v26
    v_add_f32 v27, s20, v27
    v_add_f32 v28, s20, v28
    v_add_f32 v29, s20, v29
    v_add_f32 v30, s20, v30
    v_add_f32 v31, s20, v31
    v_mul_f32 v48, s19, v32
    v_mul_f32 v49, s19, v33
    v_mul_f32 v50, s19, v34
    v_mul_f32 v51, s19, v35
    v_mul_f32 v52, s19, v36
    v_mul_f32 v53, s19, v37
    v_mul_f32 v54, s19, v38
    v_mul_f32 v55, s19, v39
    v_min_f32 v48, 0, v48
    v_min_f32 v49, 0, v49
    v_min_f32 v50, 0, v50
    v_min_f32 v51, 0, v51
    v_min_f32 v52, 0, v52
    v_min_f32 v53, 0, v53
    v_min_f32 v54, 0, v54
    v_min_f32 v55, 0, v55
    v_exp_f32 v48, v48
    v_exp_f32 v49, v49
    v_exp_f32 v50, v50
    v_exp_f32 v51, v51
    v_exp_f32 v52, v52
    v_exp_f32 v53, v53
    v_exp_f32 v54, v54
    v_exp_f32 v55, v55
    v_max_f32 v32, 0, v32
    v_max_f32 v33, 0, v33
    v_max_f32 v34, 0, v34
    v_max_f32 v35, 0, v35
    v_max_f32 v36, 0, v36
    v_max_f32 v37, 0, v37
    v_max_f32 v38, 0, v38
    v_max_f32 v39, 0, v39
    v_add_f32 v32, v32, v48
    v_add_f32 v33, v33, v49
    v_add_f32 v34, v34, v50
    v_add_f32 v35, v35, v51
    v_add_f32 v36, v36, v52
    v_add_f32 v37, v37, v53
    v_add_f32 v38, v38, v54
    v_add_f32 v39, v39, v55
    v_add_f32 v32, s20, v32
    v_add_f32 v33, s20, v33
    v_add_f32 v34, s20, v34
    v_add_f32 v35, s20, v35
    v_add_f32 v36, s20, v36
    v_add_f32 v37, s20, v37
    v_add_f32 v38, s20, v38
    v_add_f32 v39, s20, v39
    v_mul_f32 v48, s19, v40
    v_mul_f32 v49, s19, v41
    v_mul_f32 v50, s19, v42
    v_mul_f32 v51, s19, v43
    v_mul_f32 v52, s19, v44
    v_mul_f32 v53, s19, v45
    v_mul_f32 v54, s19, v46
    v_mul_f32 v55, s19, v47
    v_min_f32 v48, 0, v48
    v_min_f32 v49, 0, v49
    v_min_f32 v50, 0, v50
    v_min_f32 v51, 0, v51
    v_min_f32 v52, 0, v52
    v_min_f32 v53, 0, v53
    v_min_f32 v54, 0, v54
    v_min_f32 v55, 0, v55
    v_exp_f32 v48, v48
    v_exp_f32 v49, v49
    v_exp_f32 v50, v50
    v_exp_f32 v51, v51
    v_exp_f32 v52, v52
    v_exp_f32 v53, v53
    v_exp_f32 v54, v54
    v_exp_f32 v55, v55
    v_max_f32 v40, 0, v40
    v_max_f32 v41, 0, v41
    v_max_f32 v42, 0, v42
    v_max_f32 v43, 0, v43
    v_max_f32 v44, 0, v44
    v_max_f32 v45, 0, v45
    v_max_f32 v46, 0, v46
    v_max_f32 v47, 0, v47
    v_add_f32 v40, v40, v48
    v_add_f32 v41, v41, v49
    v_add_f32 v42, v42, v50
    v_add_f32 v43, v43, v51
    v_add_f32 v44, v44, v52
    v_add_f32 v45, v45, v53
    v_add_f32 v46, v46, v54
    v_add_f32 v47, v47, v55
    v_add_f32 v40, s20, v40
    v_add_f32 v41, s20, v41
    v_add_f32 v42, s20, v42
    v_add_f32 v43, s20, v43
    v_add_f32 v44, s20, v44
    v_add_f32 v45, s20, v45
    v_add_f32 v46, s20, v46
    v_add_f32 v47, s20, v47
    v_cvt_pk_bf16_f32 v112, v16, v17
    v_cvt_pk_bf16_f32 v113, v18, v19
    v_cvt_pk_bf16_f32 v114, v20, v21
    v_cvt_pk_bf16_f32 v115, v22, v23
    v_cvt_pk_bf16_f32 v116, v24, v25
    v_cvt_pk_bf16_f32 v117, v26, v27
    v_cvt_pk_bf16_f32 v118, v28, v29
    v_cvt_pk_bf16_f32 v119, v30, v31
    v_cvt_pk_bf16_f32 v120, v32, v33
    v_cvt_pk_bf16_f32 v121, v34, v35
    v_cvt_pk_bf16_f32 v122, v36, v37
    v_cvt_pk_bf16_f32 v123, v38, v39
    v_cvt_pk_bf16_f32 v124, v40, v41
    v_cvt_pk_bf16_f32 v125, v42, v43
    v_cvt_pk_bf16_f32 v126, v44, v45
    v_cvt_pk_bf16_f32 v127, v46, v47
    v_mov_b32 v20, 0
L_ww_12:
    buffer_load_dword v21, v20, s[8:11], s36 offen sc1
    s_waitcnt vmcnt(0)
    v_readfirstlane_b32 s19, v21
    s_nop 0
    s_cmp_ge_u32 s19, 16
    s_cbranch_scc1 L_wd_13
    s_add_u32 s71, s71, 1
    s_cmp_gt_u32 s71, 0x200000
    s_cbranch_scc1 L_work_fail
    s_sleep 2
    s_branch L_ww_12
L_wd_13:
    buffer_load_dwordx4 v[128:131], v0, s[8:11], s35 offen sc1
    buffer_load_dwordx4 v[132:135], v0, s[8:11], s35 offen offset:1024 sc1
    s_add_u32 s35, s35, 8192
    buffer_load_dwordx4 v[136:139], v0, s[8:11], s35 offen sc1
    buffer_load_dwordx4 v[140:143], v0, s[8:11], s35 offen offset:1024 sc1
    s_add_u32 s35, s35, 8192
    buffer_load_dwordx4 v[144:147], v0, s[8:11], s35 offen sc1
    buffer_load_dwordx4 v[148:151], v0, s[8:11], s35 offen offset:1024 sc1
    s_add_u32 s35, s35, 8192
    buffer_load_dwordx4 v[152:155], v0, s[8:11], s35 offen sc1
    buffer_load_dwordx4 v[156:159], v0, s[8:11], s35 offen offset:1024 sc1
    s_add_u32 s35, s35, 8192
    buffer_load_dwordx4 v[160:163], v0, s[8:11], s35 offen sc1
    buffer_load_dwordx4 v[164:167], v0, s[8:11], s35 offen offset:1024 sc1
    s_add_u32 s35, s35, 8192
    buffer_load_dwordx4 v[168:171], v0, s[8:11], s35 offen sc1
    buffer_load_dwordx4 v[172:175], v0, s[8:11], s35 offen offset:1024 sc1
    s_add_u32 s35, s35, 8192
    buffer_load_dwordx4 v[176:179], v0, s[8:11], s35 offen sc1
    buffer_load_dwordx4 v[180:183], v0, s[8:11], s35 offen offset:1024 sc1
    s_add_u32 s35, s35, 8192
    buffer_load_dwordx4 v[184:187], v0, s[8:11], s35 offen sc1
    buffer_load_dwordx4 v[188:191], v0, s[8:11], s35 offen offset:1024 sc1
    s_add_u32 s35, s35, 8192
    buffer_load_dwordx4 v[192:195], v0, s[8:11], s35 offen sc1
    buffer_load_dwordx4 v[196:199], v0, s[8:11], s35 offen offset:1024 sc1
    s_add_u32 s35, s35, 8192
    buffer_load_dwordx4 v[200:203], v0, s[8:11], s35 offen sc1
    buffer_load_dwordx4 v[204:207], v0, s[8:11], s35 offen offset:1024 sc1
    s_add_u32 s35, s35, 8192
    buffer_load_dwordx4 v[208:211], v0, s[8:11], s35 offen sc1
    buffer_load_dwordx4 v[212:215], v0, s[8:11], s35 offen offset:1024 sc1
    s_add_u32 s35, s35, 8192
    buffer_load_dwordx4 v[216:219], v0, s[8:11], s35 offen sc1
    buffer_load_dwordx4 v[220:223], v0, s[8:11], s35 offen offset:1024 sc1
    s_add_u32 s35, s35, 8192
    buffer_load_dwordx4 v[224:227], v0, s[8:11], s35 offen sc1
    buffer_load_dwordx4 v[228:231], v0, s[8:11], s35 offen offset:1024 sc1
    s_add_u32 s35, s35, 8192
    buffer_load_dwordx4 v[232:235], v0, s[8:11], s35 offen sc1
    buffer_load_dwordx4 v[236:239], v0, s[8:11], s35 offen offset:1024 sc1
    s_add_u32 s35, s35, 8192
    buffer_load_dwordx4 v[240:243], v0, s[8:11], s35 offen sc1
    buffer_load_dwordx4 v[244:247], v0, s[8:11], s35 offen offset:1024 sc1
    s_add_u32 s35, s35, 8192
    buffer_load_dwordx4 v[248:251], v0, s[8:11], s35 offen sc1
    buffer_load_dwordx4 v[252:255], v0, s[8:11], s35 offen offset:1024 sc1
    s_add_u32 s35, s35, 8192
    s_waitcnt vmcnt(0)
    v_add_f32 v128, v128, v192
    v_add_f32 v129, v129, v193
    v_add_f32 v130, v130, v194
    v_add_f32 v131, v131, v195
    v_add_f32 v132, v132, v196
    v_add_f32 v133, v133, v197
    v_add_f32 v134, v134, v198
    v_add_f32 v135, v135, v199
    v_add_f32 v136, v136, v200
    v_add_f32 v137, v137, v201
    v_add_f32 v138, v138, v202
    v_add_f32 v139, v139, v203
    v_add_f32 v140, v140, v204
    v_add_f32 v141, v141, v205
    v_add_f32 v142, v142, v206
    v_add_f32 v143, v143, v207
    v_add_f32 v144, v144, v208
    v_add_f32 v145, v145, v209
    v_add_f32 v146, v146, v210
    v_add_f32 v147, v147, v211
    v_add_f32 v148, v148, v212
    v_add_f32 v149, v149, v213
    v_add_f32 v150, v150, v214
    v_add_f32 v151, v151, v215
    v_add_f32 v152, v152, v216
    v_add_f32 v153, v153, v217
    v_add_f32 v154, v154, v218
    v_add_f32 v155, v155, v219
    v_add_f32 v156, v156, v220
    v_add_f32 v157, v157, v221
    v_add_f32 v158, v158, v222
    v_add_f32 v159, v159, v223
    v_add_f32 v160, v160, v224
    v_add_f32 v161, v161, v225
    v_add_f32 v162, v162, v226
    v_add_f32 v163, v163, v227
    v_add_f32 v164, v164, v228
    v_add_f32 v165, v165, v229
    v_add_f32 v166, v166, v230
    v_add_f32 v167, v167, v231
    v_add_f32 v168, v168, v232
    v_add_f32 v169, v169, v233
    v_add_f32 v170, v170, v234
    v_add_f32 v171, v171, v235
    v_add_f32 v172, v172, v236
    v_add_f32 v173, v173, v237
    v_add_f32 v174, v174, v238
    v_add_f32 v175, v175, v239
    v_add_f32 v176, v176, v240
    v_add_f32 v177, v177, v241
    v_add_f32 v178, v178, v242
    v_add_f32 v179, v179, v243
    v_add_f32 v180, v180, v244
    v_add_f32 v181, v181, v245
    v_add_f32 v182, v182, v246
    v_add_f32 v183, v183, v247
    v_add_f32 v184, v184, v248
    v_add_f32 v185, v185, v249
    v_add_f32 v186, v186, v250
    v_add_f32 v187, v187, v251
    v_add_f32 v188, v188, v252
    v_add_f32 v189, v189, v253
    v_add_f32 v190, v190, v254
    v_add_f32 v191, v191, v255
    v_add_f32 v128, v128, v160
    v_add_f32 v129, v129, v161
    v_add_f32 v130, v130, v162
    v_add_f32 v131, v131, v163
    v_add_f32 v132, v132, v164
    v_add_f32 v133, v133, v165
    v_add_f32 v134, v134, v166
    v_add_f32 v135, v135, v167
    v_add_f32 v136, v136, v168
    v_add_f32 v137, v137, v169
    v_add_f32 v138, v138, v170
    v_add_f32 v139, v139, v171
    v_add_f32 v140, v140, v172
    v_add_f32 v141, v141, v173
    v_add_f32 v142, v142, v174
    v_add_f32 v143, v143, v175
    v_add_f32 v144, v144, v176
    v_add_f32 v145, v145, v177
    v_add_f32 v146, v146, v178
    v_add_f32 v147, v147, v179
    v_add_f32 v148, v148, v180
    v_add_f32 v149, v149, v181
    v_add_f32 v150, v150, v182
    v_add_f32 v151, v151, v183
    v_add_f32 v152, v152, v184
    v_add_f32 v153, v153, v185
    v_add_f32 v154, v154, v186
    v_add_f32 v155, v155, v187
    v_add_f32 v156, v156, v188
    v_add_f32 v157, v157, v189
    v_add_f32 v158, v158, v190
    v_add_f32 v159, v159, v191
    v_add_f32 v128, v128, v144
    v_add_f32 v129, v129, v145
    v_add_f32 v130, v130, v146
    v_add_f32 v131, v131, v147
    v_add_f32 v132, v132, v148
    v_add_f32 v133, v133, v149
    v_add_f32 v134, v134, v150
    v_add_f32 v135, v135, v151
    v_add_f32 v136, v136, v152
    v_add_f32 v137, v137, v153
    v_add_f32 v138, v138, v154
    v_add_f32 v139, v139, v155
    v_add_f32 v140, v140, v156
    v_add_f32 v141, v141, v157
    v_add_f32 v142, v142, v158
    v_add_f32 v143, v143, v159
    v_add_f32 v128, v128, v136
    v_add_f32 v129, v129, v137
    v_add_f32 v130, v130, v138
    v_add_f32 v131, v131, v139
    v_add_f32 v132, v132, v140
    v_add_f32 v133, v133, v141
    v_add_f32 v134, v134, v142
    v_add_f32 v135, v135, v143
    v_cvt_pk_bf16_f32 v16, v128, v129
    v_cvt_pk_bf16_f32 v17, v130, v131
    v_cvt_pk_bf16_f32 v18, v132, v133
    v_cvt_pk_bf16_f32 v19, v134, v135
    v_add_u32 v52, 131072, v13
    v_add_u32 v53, 131072, v0
    ds_write_b128 v52, v[16:19]
    s_waitcnt lgkmcnt(0)
    s_barrier
    ds_read_b128 v[80:83], v53 offset:0
    ds_read_b128 v[84:87], v53 offset:1024
    ds_read_b128 v[88:91], v53 offset:2048
    ds_read_b128 v[92:95], v53 offset:3072
    s_waitcnt lgkmcnt(0)
    v_mfma_f32_16x16x16_bf16 v[16:19], v[80:81], v[112:113], 0
    v_mfma_f32_16x16x16_bf16 v[48:51], v[82:83], v[112:113], 0
    v_mfma_f32_16x16x16_bf16 v[20:23], v[80:81], v[114:115], 0
    v_mfma_f32_16x16x16_bf16 v[52:55], v[82:83], v[114:115], 0
    v_mfma_f32_16x16x16_bf16 v[24:27], v[84:85], v[116:117], 0
    v_mfma_f32_16x16x16_bf16 v[56:59], v[86:87], v[116:117], 0
    v_mfma_f32_16x16x16_bf16 v[28:31], v[84:85], v[118:119], 0
    v_mfma_f32_16x16x16_bf16 v[60:63], v[86:87], v[118:119], 0
    v_mfma_f32_16x16x16_bf16 v[32:35], v[88:89], v[120:121], 0
    v_mfma_f32_16x16x16_bf16 v[64:67], v[90:91], v[120:121], 0
    v_mfma_f32_16x16x16_bf16 v[36:39], v[88:89], v[122:123], 0
    v_mfma_f32_16x16x16_bf16 v[68:71], v[90:91], v[122:123], 0
    v_mfma_f32_16x16x16_bf16 v[40:43], v[92:93], v[124:125], 0
    v_mfma_f32_16x16x16_bf16 v[72:75], v[94:95], v[124:125], 0
    v_mfma_f32_16x16x16_bf16 v[44:47], v[92:93], v[126:127], 0
    v_mfma_f32_16x16x16_bf16 v[76:79], v[94:95], v[126:127], 0
    s_mov_b32 s20, 0x358637bd
    s_nop 7
    v_add_f32 v48, s20, v48
    v_add_f32 v52, s20, v52
    v_add_f32 v56, s20, v56
    v_add_f32 v60, s20, v60
    v_add_f32 v64, s20, v64
    v_add_f32 v68, s20, v68
    v_add_f32 v72, s20, v72
    v_add_f32 v76, s20, v76
    v_rcp_f32 v48, v48
    v_rcp_f32 v52, v52
    v_rcp_f32 v56, v56
    v_rcp_f32 v60, v60
    v_rcp_f32 v64, v64
    v_rcp_f32 v68, v68
    v_rcp_f32 v72, v72
    v_rcp_f32 v76, v76
    s_nop 0
    v_mul_f32 v16, v16, v48
    v_mul_f32 v17, v17, v48
    v_mul_f32 v18, v18, v48
    v_mul_f32 v19, v19, v48
    v_mul_f32 v20, v20, v52
    v_mul_f32 v21, v21, v52
    v_mul_f32 v22, v22, v52
    v_mul_f32 v23, v23, v52
    v_mul_f32 v24, v24, v56
    v_mul_f32 v25, v25, v56
    v_mul_f32 v26, v26, v56
    v_mul_f32 v27, v27, v56
    v_mul_f32 v28, v28, v60
    v_mul_f32 v29, v29, v60
    v_mul_f32 v30, v30, v60
    v_mul_f32 v31, v31, v60
    v_mul_f32 v32, v32, v64
    v_mul_f32 v33, v33, v64
    v_mul_f32 v34, v34, v64
    v_mul_f32 v35, v35, v64
    v_mul_f32 v36, v36, v68
    v_mul_f32 v37, v37, v68
    v_mul_f32 v38, v38, v68
    v_mul_f32 v39, v39, v68
    v_mul_f32 v40, v40, v72
    v_mul_f32 v41, v41, v72
    v_mul_f32 v42, v42, v72
    v_mul_f32 v43, v43, v72
    v_mul_f32 v44, v44, v76
    v_mul_f32 v45, v45, v76
    v_mul_f32 v46, v46, v76
    v_mul_f32 v47, v47, v76
    s_lshl_b32 s35, s31, 17
    s_lshl_b32 s19, s16, 15
    s_add_u32 s35, s35, s19
    s_add_u32 s35, s35, 85983232
    s_lshl_b32 s19, s30, 11
    s_add_u32 s19, s19, s35
    s_add_u32 s20, s19, 16384
    v_cvt_pk_bf16_f32 v96, v16, v17
    v_cvt_pk_bf16_f32 v97, v18, v19
    v_cvt_pk_bf16_f32 v98, v24, v25
    v_cvt_pk_bf16_f32 v99, v26, v27
    buffer_store_dwordx4 v[96:99], v0, s[8:11], s19 offen offset:0 sc1
    v_cvt_pk_bf16_f32 v100, v32, v33
    v_cvt_pk_bf16_f32 v101, v34, v35
    v_cvt_pk_bf16_f32 v102, v40, v41
    v_cvt_pk_bf16_f32 v103, v42, v43
    buffer_store_dwordx4 v[100:103], v0, s[8:11], s19 offen offset:1024 sc1
    v_cvt_pk_bf16_f32 v104, v20, v21
    v_cvt_pk_bf16_f32 v105, v22, v23
    v_cvt_pk_bf16_f32 v106, v28, v29
    v_cvt_pk_bf16_f32 v107, v30, v31
    buffer_store_dwordx4 v[104:107], v0, s[8:11], s20 offen offset:0 sc1
    v_cvt_pk_bf16_f32 v108, v36, v37
    v_cvt_pk_bf16_f32 v109, v38, v39
    v_cvt_pk_bf16_f32 v110, v44, v45
    v_cvt_pk_bf16_f32 v111, v46, v47
    buffer_store_dwordx4 v[108:111], v0, s[8:11], s20 offen offset:1024 sc1
    s_lshl_b32 s36, s31, 12
    s_add_u32 s36, s36, 63963776
    s_waitcnt vmcnt(0)
    s_barrier
    buffer_atomic_add v3, v2, s[8:11], s36 offen
    v_mov_b32 v20, 0
L_ww_14:
    buffer_load_dword v21, v20, s[8:11], s36 offen sc1
    s_waitcnt vmcnt(0)
    v_readfirstlane_b32 s19, v21
    s_nop 0
    s_cmp_ge_u32 s19, 8
    s_cbranch_scc1 L_wd_15
    s_add_u32 s71, s71, 1
    s_cmp_gt_u32 s71, 0x200000
    s_cbranch_scc1 L_work_fail
    s_sleep 2
    s_branch L_ww_14
L_wd_15:
    buffer_load_dwordx4 v[128:131], v0, s[8:11], s35 offen offset:0 sc1
    buffer_load_dwordx4 v[132:135], v0, s[8:11], s35 offen offset:1024 sc1
    buffer_load_dwordx4 v[136:139], v0, s[8:11], s35 offen offset:2048 sc1
    buffer_load_dwordx4 v[140:143], v0, s[8:11], s35 offen offset:3072 sc1
    s_add_u32 s35, s35, 4096
    buffer_load_dwordx4 v[144:147], v0, s[8:11], s35 offen offset:0 sc1
    buffer_load_dwordx4 v[148:151], v0, s[8:11], s35 offen offset:1024 sc1
    buffer_load_dwordx4 v[152:155], v0, s[8:11], s35 offen offset:2048 sc1
    buffer_load_dwordx4 v[156:159], v0, s[8:11], s35 offen offset:3072 sc1
    s_add_u32 s35, s35, 4096
    buffer_load_dwordx4 v[160:163], v0, s[8:11], s35 offen offset:0 sc1
    buffer_load_dwordx4 v[164:167], v0, s[8:11], s35 offen offset:1024 sc1
    buffer_load_dwordx4 v[168:171], v0, s[8:11], s35 offen offset:2048 sc1
    buffer_load_dwordx4 v[172:175], v0, s[8:11], s35 offen offset:3072 sc1
    s_add_u32 s35, s35, 4096
    buffer_load_dwordx4 v[176:179], v0, s[8:11], s35 offen offset:0 sc1
    buffer_load_dwordx4 v[180:183], v0, s[8:11], s35 offen offset:1024 sc1
    buffer_load_dwordx4 v[184:187], v0, s[8:11], s35 offen offset:2048 sc1
    buffer_load_dwordx4 v[188:191], v0, s[8:11], s35 offen offset:3072 sc1
    s_add_u32 s35, s35, 4096
    buffer_load_dwordx4 v[192:195], v0, s[8:11], s35 offen offset:0 sc1
    buffer_load_dwordx4 v[196:199], v0, s[8:11], s35 offen offset:1024 sc1
    buffer_load_dwordx4 v[200:203], v0, s[8:11], s35 offen offset:2048 sc1
    buffer_load_dwordx4 v[204:207], v0, s[8:11], s35 offen offset:3072 sc1
    s_add_u32 s35, s35, 4096
    buffer_load_dwordx4 v[208:211], v0, s[8:11], s35 offen offset:0 sc1
    buffer_load_dwordx4 v[212:215], v0, s[8:11], s35 offen offset:1024 sc1
    buffer_load_dwordx4 v[216:219], v0, s[8:11], s35 offen offset:2048 sc1
    buffer_load_dwordx4 v[220:223], v0, s[8:11], s35 offen offset:3072 sc1
    s_add_u32 s35, s35, 4096
    buffer_load_dwordx4 v[224:227], v0, s[8:11], s35 offen offset:0 sc1
    buffer_load_dwordx4 v[228:231], v0, s[8:11], s35 offen offset:1024 sc1
    buffer_load_dwordx4 v[232:235], v0, s[8:11], s35 offen offset:2048 sc1
    buffer_load_dwordx4 v[236:239], v0, s[8:11], s35 offen offset:3072 sc1
    s_add_u32 s35, s35, 4096
    buffer_load_dwordx4 v[240:243], v0, s[8:11], s35 offen offset:0 sc1
    buffer_load_dwordx4 v[244:247], v0, s[8:11], s35 offen offset:1024 sc1
    buffer_load_dwordx4 v[248:251], v0, s[8:11], s35 offen offset:2048 sc1
    buffer_load_dwordx4 v[252:255], v0, s[8:11], s35 offen offset:3072 sc1
    s_add_u32 s35, s35, 4096
    s_waitcnt vmcnt(0)
    v_add_u32 v8, 65536, v8
    v_add_u32 v9, 65536, v9
    v_add_u32 v10, 65536, v10
    v_add_u32 v11, 65536, v11
    ds_read_b64_tr_b16 v[48:49], v8 offset:0
    ds_read_b64_tr_b16 v[50:51], v8 offset:512
    ds_read_b64_tr_b16 v[52:53], v9 offset:0
    ds_read_b64_tr_b16 v[54:55], v9 offset:512
    ds_read_b64_tr_b16 v[56:57], v10 offset:0
    ds_read_b64_tr_b16 v[58:59], v10 offset:512
    ds_read_b64_tr_b16 v[60:61], v11 offset:0
    ds_read_b64_tr_b16 v[62:63], v11 offset:512
    s_waitcnt lgkmcnt(0)
    v_mfma_f32_16x16x32_bf16 v[16:19], v[48:51], v[128:131], 0
    ds_read_b64_tr_b16 v[64:65], v8 offset:4096
    ds_read_b64_tr_b16 v[66:67], v8 offset:4608
    v_mfma_f32_16x16x32_bf16 v[20:23], v[48:51], v[192:195], 0
    ds_read_b64_tr_b16 v[68:69], v9 offset:4096
    ds_read_b64_tr_b16 v[70:71], v9 offset:4608
    v_mfma_f32_16x16x32_bf16 v[24:27], v[52:55], v[128:131], 0
    ds_read_b64_tr_b16 v[72:73], v10 offset:4096
    ds_read_b64_tr_b16 v[74:75], v10 offset:4608
    v_mfma_f32_16x16x32_bf16 v[28:31], v[52:55], v[192:195], 0
    ds_read_b64_tr_b16 v[76:77], v11 offset:4096
    ds_read_b64_tr_b16 v[78:79], v11 offset:4608
    v_mfma_f32_16x16x32_bf16 v[32:35], v[56:59], v[128:131], 0
    v_mfma_f32_16x16x32_bf16 v[36:39], v[56:59], v[192:195], 0
    v_mfma_f32_16x16x32_bf16 v[40:43], v[60:63], v[128:131], 0
    v_mfma_f32_16x16x32_bf16 v[44:47], v[60:63], v[192:195], 0
    s_waitcnt lgkmcnt(0)
    v_mfma_f32_16x16x32_bf16 v[16:19], v[64:67], v[132:135], v[16:19]
    ds_read_b64_tr_b16 v[48:49], v8 offset:8192
    ds_read_b64_tr_b16 v[50:51], v8 offset:8704
    v_mfma_f32_16x16x32_bf16 v[20:23], v[64:67], v[196:199], v[20:23]
    ds_read_b64_tr_b16 v[52:53], v9 offset:8192
    ds_read_b64_tr_b16 v[54:55], v9 offset:8704
    v_mfma_f32_16x16x32_bf16 v[24:27], v[68:71], v[132:135], v[24:27]
    ds_read_b64_tr_b16 v[56:57], v10 offset:8192
    ds_read_b64_tr_b16 v[58:59], v10 offset:8704
    v_mfma_f32_16x16x32_bf16 v[28:31], v[68:71], v[196:199], v[28:31]
    ds_read_b64_tr_b16 v[60:61], v11 offset:8192
    ds_read_b64_tr_b16 v[62:63], v11 offset:8704
    v_mfma_f32_16x16x32_bf16 v[32:35], v[72:75], v[132:135], v[32:35]
    v_mfma_f32_16x16x32_bf16 v[36:39], v[72:75], v[196:199], v[36:39]
    v_mfma_f32_16x16x32_bf16 v[40:43], v[76:79], v[132:135], v[40:43]
    v_mfma_f32_16x16x32_bf16 v[44:47], v[76:79], v[196:199], v[44:47]
    s_waitcnt lgkmcnt(0)
    v_mfma_f32_16x16x32_bf16 v[16:19], v[48:51], v[136:139], v[16:19]
    ds_read_b64_tr_b16 v[64:65], v8 offset:12288
    ds_read_b64_tr_b16 v[66:67], v8 offset:12800
    v_mfma_f32_16x16x32_bf16 v[20:23], v[48:51], v[200:203], v[20:23]
    ds_read_b64_tr_b16 v[68:69], v9 offset:12288
    ds_read_b64_tr_b16 v[70:71], v9 offset:12800
    v_mfma_f32_16x16x32_bf16 v[24:27], v[52:55], v[136:139], v[24:27]
    ds_read_b64_tr_b16 v[72:73], v10 offset:12288
    ds_read_b64_tr_b16 v[74:75], v10 offset:12800
    v_mfma_f32_16x16x32_bf16 v[28:31], v[52:55], v[200:203], v[28:31]
    ds_read_b64_tr_b16 v[76:77], v11 offset:12288
    ds_read_b64_tr_b16 v[78:79], v11 offset:12800
    v_mfma_f32_16x16x32_bf16 v[32:35], v[56:59], v[136:139], v[32:35]
    v_mfma_f32_16x16x32_bf16 v[36:39], v[56:59], v[200:203], v[36:39]
    v_mfma_f32_16x16x32_bf16 v[40:43], v[60:63], v[136:139], v[40:43]
    v_mfma_f32_16x16x32_bf16 v[44:47], v[60:63], v[200:203], v[44:47]
    s_waitcnt lgkmcnt(0)
    v_mfma_f32_16x16x32_bf16 v[16:19], v[64:67], v[140:143], v[16:19]
    ds_read_b64_tr_b16 v[48:49], v8 offset:16384
    ds_read_b64_tr_b16 v[50:51], v8 offset:16896
    v_mfma_f32_16x16x32_bf16 v[20:23], v[64:67], v[204:207], v[20:23]
    ds_read_b64_tr_b16 v[52:53], v9 offset:16384
    ds_read_b64_tr_b16 v[54:55], v9 offset:16896
    v_mfma_f32_16x16x32_bf16 v[24:27], v[68:71], v[140:143], v[24:27]
    ds_read_b64_tr_b16 v[56:57], v10 offset:16384
    ds_read_b64_tr_b16 v[58:59], v10 offset:16896
    v_mfma_f32_16x16x32_bf16 v[28:31], v[68:71], v[204:207], v[28:31]
    ds_read_b64_tr_b16 v[60:61], v11 offset:16384
    ds_read_b64_tr_b16 v[62:63], v11 offset:16896
    v_mfma_f32_16x16x32_bf16 v[32:35], v[72:75], v[140:143], v[32:35]
    v_mfma_f32_16x16x32_bf16 v[36:39], v[72:75], v[204:207], v[36:39]
    v_mfma_f32_16x16x32_bf16 v[40:43], v[76:79], v[140:143], v[40:43]
    v_mfma_f32_16x16x32_bf16 v[44:47], v[76:79], v[204:207], v[44:47]
    s_waitcnt lgkmcnt(0)
    v_mfma_f32_16x16x32_bf16 v[16:19], v[48:51], v[144:147], v[16:19]
    ds_read_b64_tr_b16 v[64:65], v8 offset:20480
    ds_read_b64_tr_b16 v[66:67], v8 offset:20992
    v_mfma_f32_16x16x32_bf16 v[20:23], v[48:51], v[208:211], v[20:23]
    ds_read_b64_tr_b16 v[68:69], v9 offset:20480
    ds_read_b64_tr_b16 v[70:71], v9 offset:20992
    v_mfma_f32_16x16x32_bf16 v[24:27], v[52:55], v[144:147], v[24:27]
    ds_read_b64_tr_b16 v[72:73], v10 offset:20480
    ds_read_b64_tr_b16 v[74:75], v10 offset:20992
    v_mfma_f32_16x16x32_bf16 v[28:31], v[52:55], v[208:211], v[28:31]
    ds_read_b64_tr_b16 v[76:77], v11 offset:20480
    ds_read_b64_tr_b16 v[78:79], v11 offset:20992
    v_mfma_f32_16x16x32_bf16 v[32:35], v[56:59], v[144:147], v[32:35]
    v_mfma_f32_16x16x32_bf16 v[36:39], v[56:59], v[208:211], v[36:39]
    v_mfma_f32_16x16x32_bf16 v[40:43], v[60:63], v[144:147], v[40:43]
    v_mfma_f32_16x16x32_bf16 v[44:47], v[60:63], v[208:211], v[44:47]
    s_waitcnt lgkmcnt(0)
    v_mfma_f32_16x16x32_bf16 v[16:19], v[64:67], v[148:151], v[16:19]
    ds_read_b64_tr_b16 v[48:49], v8 offset:24576
    ds_read_b64_tr_b16 v[50:51], v8 offset:25088
    v_mfma_f32_16x16x32_bf16 v[20:23], v[64:67], v[212:215], v[20:23]
    ds_read_b64_tr_b16 v[52:53], v9 offset:24576
    ds_read_b64_tr_b16 v[54:55], v9 offset:25088
    v_mfma_f32_16x16x32_bf16 v[24:27], v[68:71], v[148:151], v[24:27]
    ds_read_b64_tr_b16 v[56:57], v10 offset:24576
    ds_read_b64_tr_b16 v[58:59], v10 offset:25088
    v_mfma_f32_16x16x32_bf16 v[28:31], v[68:71], v[212:215], v[28:31]
    ds_read_b64_tr_b16 v[60:61], v11 offset:24576
    ds_read_b64_tr_b16 v[62:63], v11 offset:25088
    v_mfma_f32_16x16x32_bf16 v[32:35], v[72:75], v[148:151], v[32:35]
    v_mfma_f32_16x16x32_bf16 v[36:39], v[72:75], v[212:215], v[36:39]
    v_mfma_f32_16x16x32_bf16 v[40:43], v[76:79], v[148:151], v[40:43]
    v_mfma_f32_16x16x32_bf16 v[44:47], v[76:79], v[212:215], v[44:47]
    s_waitcnt lgkmcnt(0)
    v_mfma_f32_16x16x32_bf16 v[16:19], v[48:51], v[152:155], v[16:19]
    ds_read_b64_tr_b16 v[64:65], v8 offset:28672
    ds_read_b64_tr_b16 v[66:67], v8 offset:29184
    v_mfma_f32_16x16x32_bf16 v[20:23], v[48:51], v[216:219], v[20:23]
    ds_read_b64_tr_b16 v[68:69], v9 offset:28672
    ds_read_b64_tr_b16 v[70:71], v9 offset:29184
    v_mfma_f32_16x16x32_bf16 v[24:27], v[52:55], v[152:155], v[24:27]
    ds_read_b64_tr_b16 v[72:73], v10 offset:28672
    ds_read_b64_tr_b16 v[74:75], v10 offset:29184
    v_mfma_f32_16x16x32_bf16 v[28:31], v[52:55], v[216:219], v[28:31]
    ds_read_b64_tr_b16 v[76:77], v11 offset:28672
    ds_read_b64_tr_b16 v[78:79], v11 offset:29184
    v_mfma_f32_16x16x32_bf16 v[32:35], v[56:59], v[152:155], v[32:35]
    v_mfma_f32_16x16x32_bf16 v[36:39], v[56:59], v[216:219], v[36:39]
    v_mfma_f32_16x16x32_bf16 v[40:43], v[60:63], v[152:155], v[40:43]
    v_mfma_f32_16x16x32_bf16 v[44:47], v[60:63], v[216:219], v[44:47]
    s_waitcnt lgkmcnt(0)
    v_mfma_f32_16x16x32_bf16 v[16:19], v[64:67], v[156:159], v[16:19]
    ds_read_b64_tr_b16 v[48:49], v8 offset:32768
    ds_read_b64_tr_b16 v[50:51], v8 offset:33280
    v_mfma_f32_16x16x32_bf16 v[20:23], v[64:67], v[220:223], v[20:23]
    ds_read_b64_tr_b16 v[52:53], v9 offset:32768
    ds_read_b64_tr_b16 v[54:55], v9 offset:33280
    v_mfma_f32_16x16x32_bf16 v[24:27], v[68:71], v[156:159], v[24:27]
    ds_read_b64_tr_b16 v[56:57], v10 offset:32768
    ds_read_b64_tr_b16 v[58:59], v10 offset:33280
    v_mfma_f32_16x16x32_bf16 v[28:31], v[68:71], v[220:223], v[28:31]
    ds_read_b64_tr_b16 v[60:61], v11 offset:32768
    ds_read_b64_tr_b16 v[62:63], v11 offset:33280
    v_mfma_f32_16x16x32_bf16 v[32:35], v[72:75], v[156:159], v[32:35]
    v_mfma_f32_16x16x32_bf16 v[36:39], v[72:75], v[220:223], v[36:39]
    v_mfma_f32_16x16x32_bf16 v[40:43], v[76:79], v[156:159], v[40:43]
    v_mfma_f32_16x16x32_bf16 v[44:47], v[76:79], v[220:223], v[44:47]
    s_waitcnt lgkmcnt(0)
    v_mfma_f32_16x16x32_bf16 v[16:19], v[48:51], v[160:163], v[16:19]
    ds_read_b64_tr_b16 v[64:65], v8 offset:36864
    ds_read_b64_tr_b16 v[66:67], v8 offset:37376
    v_mfma_f32_16x16x32_bf16 v[20:23], v[48:51], v[224:227], v[20:23]
    ds_read_b64_tr_b16 v[68:69], v9 offset:36864
    ds_read_b64_tr_b16 v[70:71], v9 offset:37376
    v_mfma_f32_16x16x32_bf16 v[24:27], v[52:55], v[160:163], v[24:27]
    ds_read_b64_tr_b16 v[72:73], v10 offset:36864
    ds_read_b64_tr_b16 v[74:75], v10 offset:37376
    v_mfma_f32_16x16x32_bf16 v[28:31], v[52:55], v[224:227], v[28:31]
    ds_read_b64_tr_b16 v[76:77], v11 offset:36864
    ds_read_b64_tr_b16 v[78:79], v11 offset:37376
    v_mfma_f32_16x16x32_bf16 v[32:35], v[56:59], v[160:163], v[32:35]
    v_mfma_f32_16x16x32_bf16 v[36:39], v[56:59], v[224:227], v[36:39]
    v_mfma_f32_16x16x32_bf16 v[40:43], v[60:63], v[160:163], v[40:43]
    v_mfma_f32_16x16x32_bf16 v[44:47], v[60:63], v[224:227], v[44:47]
    s_waitcnt lgkmcnt(0)
    v_mfma_f32_16x16x32_bf16 v[16:19], v[64:67], v[164:167], v[16:19]
    ds_read_b64_tr_b16 v[48:49], v8 offset:40960
    ds_read_b64_tr_b16 v[50:51], v8 offset:41472
    v_mfma_f32_16x16x32_bf16 v[20:23], v[64:67], v[228:231], v[20:23]
    ds_read_b64_tr_b16 v[52:53], v9 offset:40960
    ds_read_b64_tr_b16 v[54:55], v9 offset:41472
    v_mfma_f32_16x16x32_bf16 v[24:27], v[68:71], v[164:167], v[24:27]
    ds_read_b64_tr_b16 v[56:57], v10 offset:40960
    ds_read_b64_tr_b16 v[58:59], v10 offset:41472
    v_mfma_f32_16x16x32_bf16 v[28:31], v[68:71], v[228:231], v[28:31]
    ds_read_b64_tr_b16 v[60:61], v11 offset:40960
    ds_read_b64_tr_b16 v[62:63], v11 offset:41472
    v_mfma_f32_16x16x32_bf16 v[32:35], v[72:75], v[164:167], v[32:35]
    v_mfma_f32_16x16x32_bf16 v[36:39], v[72:75], v[228:231], v[36:39]
    v_mfma_f32_16x16x32_bf16 v[40:43], v[76:79], v[164:167], v[40:43]
    v_mfma_f32_16x16x32_bf16 v[44:47], v[76:79], v[228:231], v[44:47]
    s_waitcnt lgkmcnt(0)
    v_mfma_f32_16x16x32_bf16 v[16:19], v[48:51], v[168:171], v[16:19]
    ds_read_b64_tr_b16 v[64:65], v8 offset:45056
    ds_read_b64_tr_b16 v[66:67], v8 offset:45568
    v_mfma_f32_16x16x32_bf16 v[20:23], v[48:51], v[232:235], v[20:23]
    ds_read_b64_tr_b16 v[68:69], v9 offset:45056
    ds_read_b64_tr_b16 v[70:71], v9 offset:45568
    v_mfma_f32_16x16x32_bf16 v[24:27], v[52:55], v[168:171], v[24:27]
    ds_read_b64_tr_b16 v[72:73], v10 offset:45056
    ds_read_b64_tr_b16 v[74:75], v10 offset:45568
    v_mfma_f32_16x16x32_bf16 v[28:31], v[52:55], v[232:235], v[28:31]
    ds_read_b64_tr_b16 v[76:77], v11 offset:45056
    ds_read_b64_tr_b16 v[78:79], v11 offset:45568
    v_mfma_f32_16x16x32_bf16 v[32:35], v[56:59], v[168:171], v[32:35]
    v_mfma_f32_16x16x32_bf16 v[36:39], v[56:59], v[232:235], v[36:39]
    v_mfma_f32_16x16x32_bf16 v[40:43], v[60:63], v[168:171], v[40:43]
    v_mfma_f32_16x16x32_bf16 v[44:47], v[60:63], v[232:235], v[44:47]
    s_waitcnt lgkmcnt(0)
    v_mfma_f32_16x16x32_bf16 v[16:19], v[64:67], v[172:175], v[16:19]
    ds_read_b64_tr_b16 v[48:49], v8 offset:49152
    ds_read_b64_tr_b16 v[50:51], v8 offset:49664
    v_mfma_f32_16x16x32_bf16 v[20:23], v[64:67], v[236:239], v[20:23]
    ds_read_b64_tr_b16 v[52:53], v9 offset:49152
    ds_read_b64_tr_b16 v[54:55], v9 offset:49664
    v_mfma_f32_16x16x32_bf16 v[24:27], v[68:71], v[172:175], v[24:27]
    ds_read_b64_tr_b16 v[56:57], v10 offset:49152
    ds_read_b64_tr_b16 v[58:59], v10 offset:49664
    v_mfma_f32_16x16x32_bf16 v[28:31], v[68:71], v[236:239], v[28:31]
    ds_read_b64_tr_b16 v[60:61], v11 offset:49152
    ds_read_b64_tr_b16 v[62:63], v11 offset:49664
    v_mfma_f32_16x16x32_bf16 v[32:35], v[72:75], v[172:175], v[32:35]
    v_mfma_f32_16x16x32_bf16 v[36:39], v[72:75], v[236:239], v[36:39]
    v_mfma_f32_16x16x32_bf16 v[40:43], v[76:79], v[172:175], v[40:43]
    v_mfma_f32_16x16x32_bf16 v[44:47], v[76:79], v[236:239], v[44:47]
    s_waitcnt lgkmcnt(0)
    v_mfma_f32_16x16x32_bf16 v[16:19], v[48:51], v[176:179], v[16:19]
    ds_read_b64_tr_b16 v[64:65], v8 offset:53248
    ds_read_b64_tr_b16 v[66:67], v8 offset:53760
    v_mfma_f32_16x16x32_bf16 v[20:23], v[48:51], v[240:243], v[20:23]
    ds_read_b64_tr_b16 v[68:69], v9 offset:53248
    ds_read_b64_tr_b16 v[70:71], v9 offset:53760
    v_mfma_f32_16x16x32_bf16 v[24:27], v[52:55], v[176:179], v[24:27]
    ds_read_b64_tr_b16 v[72:73], v10 offset:53248
    ds_read_b64_tr_b16 v[74:75], v10 offset:53760
    v_mfma_f32_16x16x32_bf16 v[28:31], v[52:55], v[240:243], v[28:31]
    ds_read_b64_tr_b16 v[76:77], v11 offset:53248
    ds_read_b64_tr_b16 v[78:79], v11 offset:53760
    v_mfma_f32_16x16x32_bf16 v[32:35], v[56:59], v[176:179], v[32:35]
    v_mfma_f32_16x16x32_bf16 v[36:39], v[56:59], v[240:243], v[36:39]
    v_mfma_f32_16x16x32_bf16 v[40:43], v[60:63], v[176:179], v[40:43]
    v_mfma_f32_16x16x32_bf16 v[44:47], v[60:63], v[240:243], v[44:47]
    s_waitcnt lgkmcnt(0)
    v_mfma_f32_16x16x32_bf16 v[16:19], v[64:67], v[180:183], v[16:19]
    ds_read_b64_tr_b16 v[48:49], v8 offset:57344
    ds_read_b64_tr_b16 v[50:51], v8 offset:57856
    v_mfma_f32_16x16x32_bf16 v[20:23], v[64:67], v[244:247], v[20:23]
    ds_read_b64_tr_b16 v[52:53], v9 offset:57344
    ds_read_b64_tr_b16 v[54:55], v9 offset:57856
    v_mfma_f32_16x16x32_bf16 v[24:27], v[68:71], v[180:183], v[24:27]
    ds_read_b64_tr_b16 v[56:57], v10 offset:57344
    ds_read_b64_tr_b16 v[58:59], v10 offset:57856
    v_mfma_f32_16x16x32_bf16 v[28:31], v[68:71], v[244:247], v[28:31]
    ds_read_b64_tr_b16 v[60:61], v11 offset:57344
    ds_read_b64_tr_b16 v[62:63], v11 offset:57856
    v_mfma_f32_16x16x32_bf16 v[32:35], v[72:75], v[180:183], v[32:35]
    v_mfma_f32_16x16x32_bf16 v[36:39], v[72:75], v[244:247], v[36:39]
    v_mfma_f32_16x16x32_bf16 v[40:43], v[76:79], v[180:183], v[40:43]
    v_mfma_f32_16x16x32_bf16 v[44:47], v[76:79], v[244:247], v[44:47]
    s_waitcnt lgkmcnt(0)
    v_mfma_f32_16x16x32_bf16 v[16:19], v[48:51], v[184:187], v[16:19]
    ds_read_b64_tr_b16 v[64:65], v8 offset:61440
    ds_read_b64_tr_b16 v[66:67], v8 offset:61952
    v_mfma_f32_16x16x32_bf16 v[20:23], v[48:51], v[248:251], v[20:23]
    ds_read_b64_tr_b16 v[68:69], v9 offset:61440
    ds_read_b64_tr_b16 v[70:71], v9 offset:61952
    v_mfma_f32_16x16x32_bf16 v[24:27], v[52:55], v[184:187], v[24:27]
    ds_read_b64_tr_b16 v[72:73], v10 offset:61440
    ds_read_b64_tr_b16 v[74:75], v10 offset:61952
    v_mfma_f32_16x16x32_bf16 v[28:31], v[52:55], v[248:251], v[28:31]
    ds_read_b64_tr_b16 v[76:77], v11 offset:61440
    ds_read_b64_tr_b16 v[78:79], v11 offset:61952
    v_mfma_f32_16x16x32_bf16 v[32:35], v[56:59], v[184:187], v[32:35]
    v_mfma_f32_16x16x32_bf16 v[36:39], v[56:59], v[248:251], v[36:39]
    v_mfma_f32_16x16x32_bf16 v[40:43], v[60:63], v[184:187], v[40:43]
    v_mfma_f32_16x16x32_bf16 v[44:47], v[60:63], v[248:251], v[44:47]
    s_waitcnt lgkmcnt(0)
    v_mfma_f32_16x16x32_bf16 v[16:19], v[64:67], v[188:191], v[16:19]
    v_mfma_f32_16x16x32_bf16 v[20:23], v[64:67], v[252:255], v[20:23]
    v_mfma_f32_16x16x32_bf16 v[24:27], v[68:71], v[188:191], v[24:27]
    v_mfma_f32_16x16x32_bf16 v[28:31], v[68:71], v[252:255], v[28:31]
    v_mfma_f32_16x16x32_bf16 v[32:35], v[72:75], v[188:191], v[32:35]
    v_mfma_f32_16x16x32_bf16 v[36:39], v[72:75], v[252:255], v[36:39]
    v_mfma_f32_16x16x32_bf16 v[40:43], v[76:79], v[188:191], v[40:43]
    v_mfma_f32_16x16x32_bf16 v[44:47], v[76:79], v[252:255], v[44:47]
    v_subrev_u32 v8, 65536, v8
    v_subrev_u32 v9, 65536, v9
    v_subrev_u32 v10, 65536, v10
    v_subrev_u32 v11, 65536, v11
    s_nop 7
    s_lshl_b32 s35, s31, 18
    s_lshl_b32 s19, s16, 16
    s_add_u32 s35, s35, s19
    s_lshl_b32 s19, s30, 7
    s_add_u32 s35, s35, s19
    s_add_u32 s36, s35, 32768
    v_cvt_pk_bf16_f32 v96, v16, v17
    v_cvt_pk_bf16_f32 v97, v18, v19
    buffer_store_dwordx2 v[96:97], v14, s[92:95], s35 offen offset:0
    v_cvt_pk_bf16_f32 v98, v20, v21
    v_cvt_pk_bf16_f32 v99, v22, v23
    buffer_store_dwordx2 v[98:99], v14, s[92:95], s36 offen offset:0
    v_cvt_pk_bf16_f32 v100, v24, v25
    v_cvt_pk_bf16_f32 v101, v26, v27
    buffer_store_dwordx2 v[100:101], v14, s[92:95], s35 offen offset:32
    v_cvt_pk_bf16_f32 v102, v28, v29
    v_cvt_pk_bf16_f32 v103, v30, v31
    buffer_store_dwordx2 v[102:103], v14, s[92:95], s36 offen offset:32
    v_cvt_pk_bf16_f32 v104, v32, v33
    v_cvt_pk_bf16_f32 v105, v34, v35
    buffer_store_dwordx2 v[104:105], v14, s[92:95], s35 offen offset:64
    v_cvt_pk_bf16_f32 v106, v36, v37
    v_cvt_pk_bf16_f32 v107, v38, v39
    buffer_store_dwordx2 v[106:107], v14, s[92:95], s36 offen offset:64
    v_cvt_pk_bf16_f32 v108, v40, v41
    v_cvt_pk_bf16_f32 v109, v42, v43
    buffer_store_dwordx2 v[108:109], v14, s[92:95], s35 offen offset:96
    v_cvt_pk_bf16_f32 v110, v44, v45
    v_cvt_pk_bf16_f32 v111, v46, v47
    buffer_store_dwordx2 v[110:111], v14, s[92:95], s36 offen offset:96
    s_barrier
    v_lshrrev_b32 v20, 4, v0
    v_lshrrev_b32 v21, 4, v20
    v_and_b32 v22, 15, v20
    v_lshrrev_b32 v23, 2, v20
    v_lshrrev_b32 v24, 3, v23
    v_and_b32 v25, 3, v20
    v_lshlrev_b32 v26, 1, v24
    v_xor_b32 v25, v25, v26
    v_lshlrev_b32 v24, 5, v24
    v_and_b32 v26, 3, v23
    v_lshl_add_u32 v24, v26, 3, v24
    v_bfe_u32 v26, v23, 2, 1
    v_add_u32 v24, v24, v26
    v_lshlrev_b32 v24, 10, v24
    v_lshl_add_u32 v4, v25, 4, v24
    s_lshl_b32 s19, s31, 6
    v_add_u32 v4, s19, v4
    v_lshrrev_b32 v23, 2, v22
    v_lshl_add_u32 v23, v21, 3, v23
    v_lshlrev_b32 v23, 6, v23
    v_and_b32 v24, 3, v22
    v_lshl_add_u32 v23, v24, 3, v23
    s_lshl_b32 s19, s16, 15
    v_add_u32 v23, s19, v23
    v_and_b32 v24, 1, v21
    v_lshl_add_u32 v5, v24, 5, v23
    v_xor_b32 v24, 1, v24
    v_lshl_add_u32 v6, v24, 5, v23
    s_mov_b32 s4, s56
    s_and_b32 s5, s57, 0xffff
    s_mov_b32 s6, 0x400000
    s_mov_b32 s7, 0x20000
    s_lshl_b32 m0, s16, 15
    s_lshl_b32 s34, s16, 20
    s_add_u32 s20, s31, 0
    s_and_b32 s20, s20, 7
    s_lshl_b32 s20, s20, 17
    s_add_u32 s20, s20, s34
    s_add_u32 s19, s20, 0
    buffer_load_dwordx4 v4, s[4:7], s19 offen lds
    s_add_u32 m0, m0, 1024
    s_add_u32 s19, s20, 65536
    buffer_load_dwordx4 v4, s[4:7], s19 offen lds
    s_add_u32 m0, m0, 1024
    s_add_u32 s19, s20, 2048
    buffer_load_dwordx4 v4, s[4:7], s19 offen lds
    s_add_u32 m0, m0, 1024
    s_add_u32 s19, s20, 67584
    buffer_load_dwordx4 v4, s[4:7], s19 offen lds
    s_add_u32 m0, m0, 1024
    s_add_u32 s19, s20, 4096
    buffer_load_dwordx4 v4, s[4:7], s19 offen lds
    s_add_u32 m0, m0, 1024
    s_add_u32 s19, s20, 69632
    buffer_load_dwordx4 v4, s[4:7], s19 offen lds
    s_add_u32 m0, m0, 1024
    s_add_u32 s19, s20, 6144
    buffer_load_dwordx4 v4, s[4:7], s19 offen lds
    s_add_u32 m0, m0, 1024
    s_add_u32 s19, s20, 71680
    buffer_load_dwordx4 v4, s[4:7], s19 offen lds
    s_add_u32 m0, m0, 1024
    s_add_u32 s20, s31, 1
    s_and_b32 s20, s20, 7
    s_lshl_b32 s20, s20, 17
    s_add_u32 s20, s20, s34
    s_add_u32 s19, s20, 0
    buffer_load_dwordx4 v4, s[4:7], s19 offen lds
    s_add_u32 m0, m0, 1024
    s_add_u32 s19, s20, 65536
    buffer_load_dwordx4 v4, s[4:7], s19 offen lds
    s_add_u32 m0, m0, 1024
    s_add_u32 s19, s20, 2048
    buffer_load_dwordx4 v4, s[4:7], s19 offen lds
    s_add_u32 m0, m0, 1024
    s_add_u32 s19, s20, 67584
    buffer_load_dwordx4 v4, s[4:7], s19 offen lds
    s_add_u32 m0, m0, 1024
    s_add_u32 s19, s20, 4096
    buffer_load_dwordx4 v4, s[4:7], s19 offen lds
    s_add_u32 m0, m0, 1024
    s_add_u32 s19, s20, 69632
    buffer_load_dwordx4 v4, s[4:7], s19 offen lds
    s_add_u32 m0, m0, 1024
    s_add_u32 s19, s20, 6144
    buffer_load_dwordx4 v4, s[4:7], s19 offen lds
    s_add_u32 m0, m0, 1024
    s_add_u32 s19, s20, 71680
    buffer_load_dwordx4 v4, s[4:7], s19 offen lds
    s_add_u32 m0, m0, 1024
    s_add_u32 s20, s31, 2
    s_and_b32 s20, s20, 7
    s_lshl_b32 s20, s20, 17
    s_add_u32 s20, s20, s34
    s_add_u32 s19, s20, 0
    buffer_load_dwordx4 v4, s[4:7], s19 offen lds
    s_add_u32 m0, m0, 1024
    s_add_u32 s19, s20, 65536
    buffer_load_dwordx4 v4, s[4:7], s19 offen lds
    s_add_u32 m0, m0, 1024
    s_add_u32 s19, s20, 2048
    buffer_load_dwordx4 v4, s[4:7], s19 offen lds
    s_add_u32 m0, m0, 1024
    s_add_u32 s19, s20, 67584
    buffer_load_dwordx4 v4, s[4:7], s19 offen lds
    s_add_u32 m0, m0, 1024
    s_add_u32 s19, s20, 4096
    buffer_load_dwordx4 v4, s[4:7], s19 offen lds
    s_add_u32 m0, m0, 1024
    s_add_u32 s19, s20, 69632
    buffer_load_dwordx4 v4, s[4:7], s19 offen lds
    s_add_u32 m0, m0, 1024
    s_add_u32 s19, s20, 6144
    buffer_load_dwordx4 v4, s[4:7], s19 offen lds
    s_add_u32 m0, m0, 1024
    s_add_u32 s19, s20, 71680
    buffer_load_dwordx4 v4, s[4:7], s19 offen lds
    s_add_u32 m0, m0, 1024
    s_add_u32 s20, s31, 3
    s_and_b32 s20, s20, 7
    s_lshl_b32 s20, s20, 17
    s_add_u32 s20, s20, s34
    s_add_u32 s19, s20, 0
    buffer_load_dwordx4 v4, s[4:7], s19 offen lds
    s_add_u32 m0, m0, 1024
    s_add_u32 s19, s20, 65536
    buffer_load_dwordx4 v4, s[4:7], s19 offen lds
    s_add_u32 m0, m0, 1024
    s_add_u32 s19, s20, 2048
    buffer_load_dwordx4 v4, s[4:7], s19 offen lds
    s_add_u32 m0, m0, 1024
    s_add_u32 s19, s20, 67584
    buffer_load_dwordx4 v4, s[4:7], s19 offen lds
    s_add_u32 m0, m0, 1024
    s_add_u32 s19, s20, 4096
    buffer_load_dwordx4 v4, s[4:7], s19 offen lds
    s_add_u32 m0, m0, 1024
    s_add_u32 s19, s20, 69632
    buffer_load_dwordx4 v4, s[4:7], s19 offen lds
    s_add_u32 m0, m0, 1024
    s_add_u32 s19, s20, 6144
    buffer_load_dwordx4 v4, s[4:7], s19 offen lds
    s_add_u32 m0, m0, 1024
    s_add_u32 s19, s20, 71680
    buffer_load_dwordx4 v4, s[4:7], s19 offen lds
    s_add_u32 m0, m0, 1024
    s_waitcnt vmcnt(0)
    ds_read_b64_tr_b16 a[0:1], v5 offset:0
    ds_read_b64_tr_b16 a[2:3], v5 offset:256
    ds_read_b64_tr_b16 a[4:5], v6 offset:0
    ds_read_b64_tr_b16 a[6:7], v6 offset:256
    ds_read_b64_tr_b16 a[8:9], v5 offset:2048
    ds_read_b64_tr_b16 a[10:11], v5 offset:2304
    ds_read_b64_tr_b16 a[12:13], v6 offset:2048
    ds_read_b64_tr_b16 a[14:15], v6 offset:2304
    s_waitcnt lgkmcnt(4)
    ds_read_b64_tr_b16 a[16:17], v5 offset:4096
    ds_read_b64_tr_b16 a[18:19], v5 offset:4352
    ds_read_b64_tr_b16 a[20:21], v6 offset:4096
    ds_read_b64_tr_b16 a[22:23], v6 offset:4352
    ds_read_b64_tr_b16 a[24:25], v5 offset:6144
    ds_read_b64_tr_b16 a[26:27], v5 offset:6400
    ds_read_b64_tr_b16 a[28:29], v6 offset:6144
    ds_read_b64_tr_b16 a[30:31], v6 offset:6400
    s_waitcnt lgkmcnt(4)
    ds_read_b64_tr_b16 a[32:33], v5 offset:8192
    ds_read_b64_tr_b16 a[34:35], v5 offset:8448
    ds_read_b64_tr_b16 a[36:37], v6 offset:8192
    ds_read_b64_tr_b16 a[38:39], v6 offset:8448
    ds_read_b64_tr_b16 a[40:41], v5 offset:10240
    ds_read_b64_tr_b16 a[42:43], v5 offset:10496
    ds_read_b64_tr_b16 a[44:45], v6 offset:10240
    ds_read_b64_tr_b16 a[46:47], v6 offset:10496
    s_waitcnt lgkmcnt(4)
    ds_read_b64_tr_b16 a[48:49], v5 offset:12288
    ds_read_b64_tr_b16 a[50:51], v5 offset:12544
    ds_read_b64_tr_b16 a[52:53], v6 offset:12288
    ds_read_b64_tr_b16 a[54:55], v6 offset:12544
    ds_read_b64_tr_b16 a[56:57], v5 offset:14336
    ds_read_b64_tr_b16 a[58:59], v5 offset:14592
    ds_read_b64_tr_b16 a[60:61], v6 offset:14336
    ds_read_b64_tr_b16 a[62:63], v6 offset:14592
    s_waitcnt lgkmcnt(4)
    ds_read_b64_tr_b16 a[64:65], v5 offset:16384
    ds_read_b64_tr_b16 a[66:67], v5 offset:16640
    ds_read_b64_tr_b16 a[68:69], v6 offset:16384
    ds_read_b64_tr_b16 a[70:71], v6 offset:16640
    ds_read_b64_tr_b16 a[72:73], v5 offset:18432
    ds_read_b64_tr_b16 a[74:75], v5 offset:18688
    ds_read_b64_tr_b16 a[76:77], v6 offset:18432
    ds_read_b64_tr_b16 a[78:79], v6 offset:18688
    s_waitcnt lgkmcnt(4)
    ds_read_b64_tr_b16 a[80:81], v5 offset:20480
    ds_read_b64_tr_b16 a[82:83], v5 offset:20736
    ds_read_b64_tr_b16 a[84:85], v6 offset:20480
    ds_read_b64_tr_b16 a[86:87], v6 offset:20736
    ds_read_b64_tr_b16 a[88:89], v5 offset:22528
    ds_read_b64_tr_b16 a[90:91], v5 offset:22784
    ds_read_b64_tr_b16 a[92:93], v6 offset:22528
    ds_read_b64_tr_b16 a[94:95], v6 offset:22784
    s_waitcnt lgkmcnt(4)
    ds_read_b64_tr_b16 a[96:97], v5 offset:24576
    ds_read_b64_tr_b16 a[98:99], v5 offset:24832
    ds_read_b64_tr_b16 a[100:101], v6 offset:24576
    ds_read_b64_tr_b16 a[102:103], v6 offset:24832
    ds_read_b64_tr_b16 a[104:105], v5 offset:26624
    ds_read_b64_tr_b16 a[106:107], v5 offset:26880
    ds_read_b64_tr_b16 a[108:109], v6 offset:26624
    ds_read_b64_tr_b16 a[110:111], v6 offset:26880
    s_waitcnt lgkmcnt(4)
    ds_read_b64_tr_b16 a[112:113], v5 offset:28672
    ds_read_b64_tr_b16 a[114:115], v5 offset:28928
    ds_read_b64_tr_b16 a[116:117], v6 offset:28672
    ds_read_b64_tr_b16 a[118:119], v6 offset:28928
    ds_read_b64_tr_b16 a[120:121], v5 offset:30720
    ds_read_b64_tr_b16 a[122:123], v5 offset:30976
    ds_read_b64_tr_b16 a[124:125], v6 offset:30720
    ds_read_b64_tr_b16 a[126:127], v6 offset:30976
    s_waitcnt lgkmcnt(4)
    s_waitcnt lgkmcnt(0)
    s_lshl_b32 m0, s16, 15
    s_lshl_b32 s34, s16, 20
    s_add_u32 s20, s31, 4
    s_and_b32 s20, s20, 7
    s_lshl_b32 s20, s20, 17
    s_add_u32 s20, s20, s34
    s_add_u32 s19, s20, 0
    buffer_load_dwordx4 v4, s[4:7], s19 offen lds
    s_add_u32 m0, m0, 1024
    s_add_u32 s19, s20, 65536
    buffer_load_dwordx4 v4, s[4:7], s19 offen lds
    s_add_u32 m0, m0, 1024
    s_add_u32 s19, s20, 2048
    buffer_load_dwordx4 v4, s[4:7], s19 offen lds
    s_add_u32 m0, m0, 1024
    s_add_u32 s19, s20, 67584
    buffer_load_dwordx4 v4, s[4:7], s19 offen lds
    s_add_u32 m0, m0, 1024
    s_add_u32 s19, s20, 4096
    buffer_load_dwordx4 v4, s[4:7], s19 offen lds
    s_add_u32 m0, m0, 1024
    s_add_u32 s19, s20, 69632
    buffer_load_dwordx4 v4, s[4:7], s19 offen lds
    s_add_u32 m0, m0, 1024
    s_add_u32 s19, s20, 6144
    buffer_load_dwordx4 v4, s[4:7], s19 offen lds
    s_add_u32 m0, m0, 1024
    s_add_u32 s19, s20, 71680
    buffer_load_dwordx4 v4, s[4:7], s19 offen lds
    s_add_u32 m0, m0, 1024
    s_add_u32 s20, s31, 5
    s_and_b32 s20, s20, 7
    s_lshl_b32 s20, s20, 17
    s_add_u32 s20, s20, s34
    s_add_u32 s19, s20, 0
    buffer_load_dwordx4 v4, s[4:7], s19 offen lds
    s_add_u32 m0, m0, 1024
    s_add_u32 s19, s20, 65536
    buffer_load_dwordx4 v4, s[4:7], s19 offen lds
    s_add_u32 m0, m0, 1024
    s_add_u32 s19, s20, 2048
    buffer_load_dwordx4 v4, s[4:7], s19 offen lds
    s_add_u32 m0, m0, 1024
    s_add_u32 s19, s20, 67584
    buffer_load_dwordx4 v4, s[4:7], s19 offen lds
    s_add_u32 m0, m0, 1024
    s_add_u32 s19, s20, 4096
    buffer_load_dwordx4 v4, s[4:7], s19 offen lds
    s_add_u32 m0, m0, 1024
    s_add_u32 s19, s20, 69632
    buffer_load_dwordx4 v4, s[4:7], s19 offen lds
    s_add_u32 m0, m0, 1024
    s_add_u32 s19, s20, 6144
    buffer_load_dwordx4 v4, s[4:7], s19 offen lds
    s_add_u32 m0, m0, 1024
    s_add_u32 s19, s20, 71680
    buffer_load_dwordx4 v4, s[4:7], s19 offen lds
    s_add_u32 m0, m0, 1024
    s_add_u32 s20, s31, 6
    s_and_b32 s20, s20, 7
    s_lshl_b32 s20, s20, 17
    s_add_u32 s20, s20, s34
    s_add_u32 s19, s20, 0
    buffer_load_dwordx4 v4, s[4:7], s19 offen lds
    s_add_u32 m0, m0, 1024
    s_add_u32 s19, s20, 65536
    buffer_load_dwordx4 v4, s[4:7], s19 offen lds
    s_add_u32 m0, m0, 1024
    s_add_u32 s19, s20, 2048
    buffer_load_dwordx4 v4, s[4:7], s19 offen lds
    s_add_u32 m0, m0, 1024
    s_add_u32 s19, s20, 67584
    buffer_load_dwordx4 v4, s[4:7], s19 offen lds
    s_add_u32 m0, m0, 1024
    s_add_u32 s19, s20, 4096
    buffer_load_dwordx4 v4, s[4:7], s19 offen lds
    s_add_u32 m0, m0, 1024
    s_add_u32 s19, s20, 69632
    buffer_load_dwordx4 v4, s[4:7], s19 offen lds
    s_add_u32 m0, m0, 1024
    s_add_u32 s19, s20, 6144
    buffer_load_dwordx4 v4, s[4:7], s19 offen lds
    s_add_u32 m0, m0, 1024
    s_add_u32 s19, s20, 71680
    buffer_load_dwordx4 v4, s[4:7], s19 offen lds
    s_add_u32 m0, m0, 1024
    s_add_u32 s20, s31, 7
    s_and_b32 s20, s20, 7
    s_lshl_b32 s20, s20, 17
    s_add_u32 s20, s20, s34
    s_add_u32 s19, s20, 0
    buffer_load_dwordx4 v4, s[4:7], s19 offen lds
    s_add_u32 m0, m0, 1024
    s_add_u32 s19, s20, 65536
    buffer_load_dwordx4 v4, s[4:7], s19 offen lds
    s_add_u32 m0, m0, 1024
    s_add_u32 s19, s20, 2048
    buffer_load_dwordx4 v4, s[4:7], s19 offen lds
    s_add_u32 m0, m0, 1024
    s_add_u32 s19, s20, 67584
    buffer_load_dwordx4 v4, s[4:7], s19 offen lds
    s_add_u32 m0, m0, 1024
    s_add_u32 s19, s20, 4096
    buffer_load_dwordx4 v4, s[4:7], s19 offen lds
    s_add_u32 m0, m0, 1024
    s_add_u32 s19, s20, 69632
    buffer_load_dwordx4 v4, s[4:7], s19 offen lds
    s_add_u32 m0, m0, 1024
    s_add_u32 s19, s20, 6144
    buffer_load_dwordx4 v4, s[4:7], s19 offen lds
    s_add_u32 m0, m0, 1024
    s_add_u32 s19, s20, 71680
    buffer_load_dwordx4 v4, s[4:7], s19 offen lds
    s_add_u32 m0, m0, 1024
    s_waitcnt vmcnt(0)
    ds_read_b64_tr_b16 a[128:129], v5 offset:0
    ds_read_b64_tr_b16 a[130:131], v5 offset:256
    ds_read_b64_tr_b16 a[132:133], v6 offset:0
    ds_read_b64_tr_b16 a[134:135], v6 offset:256
    ds_read_b64_tr_b16 a[136:137], v5 offset:2048
    ds_read_b64_tr_b16 a[138:139], v5 offset:2304
    ds_read_b64_tr_b16 a[140:141], v6 offset:2048
    ds_read_b64_tr_b16 a[142:143], v6 offset:2304
    s_waitcnt lgkmcnt(4)
    ds_read_b64_tr_b16 a[144:145], v5 offset:4096
    ds_read_b64_tr_b16 a[146:147], v5 offset:4352
    ds_read_b64_tr_b16 a[148:149], v6 offset:4096
    ds_read_b64_tr_b16 a[150:151], v6 offset:4352
    ds_read_b64_tr_b16 a[152:153], v5 offset:6144
    ds_read_b64_tr_b16 a[154:155], v5 offset:6400
    ds_read_b64_tr_b16 a[156:157], v6 offset:6144
    ds_read_b64_tr_b16 a[158:159], v6 offset:6400
    s_waitcnt lgkmcnt(4)
    ds_read_b64_tr_b16 a[160:161], v5 offset:8192
    ds_read_b64_tr_b16 a[162:163], v5 offset:8448
    ds_read_b64_tr_b16 a[164:165], v6 offset:8192
    ds_read_b64_tr_b16 a[166:167], v6 offset:8448
    ds_read_b64_tr_b16 a[168:169], v5 offset:10240
    ds_read_b64_tr_b16 a[170:171], v5 offset:10496
    ds_read_b64_tr_b16 a[172:173], v6 offset:10240
    ds_read_b64_tr_b16 a[174:175], v6 offset:10496
    s_waitcnt lgkmcnt(4)
    ds_read_b64_tr_b16 a[176:177], v5 offset:12288
    ds_read_b64_tr_b16 a[178:179], v5 offset:12544
    ds_read_b64_tr_b16 a[180:181], v6 offset:12288
    ds_read_b64_tr_b16 a[182:183], v6 offset:12544
    ds_read_b64_tr_b16 a[184:185], v5 offset:14336
    ds_read_b64_tr_b16 a[186:187], v5 offset:14592
    ds_read_b64_tr_b16 a[188:189], v6 offset:14336
    ds_read_b64_tr_b16 a[190:191], v6 offset:14592
    s_waitcnt lgkmcnt(4)
    ds_read_b64_tr_b16 a[192:193], v5 offset:16384
    ds_read_b64_tr_b16 a[194:195], v5 offset:16640
    ds_read_b64_tr_b16 a[196:197], v6 offset:16384
    ds_read_b64_tr_b16 a[198:199], v6 offset:16640
    ds_read_b64_tr_b16 a[200:201], v5 offset:18432
    ds_read_b64_tr_b16 a[202:203], v5 offset:18688
    ds_read_b64_tr_b16 a[204:205], v6 offset:18432
    ds_read_b64_tr_b16 a[206:207], v6 offset:18688
    s_waitcnt lgkmcnt(4)
    ds_read_b64_tr_b16 a[208:209], v5 offset:20480
    ds_read_b64_tr_b16 a[210:211], v5 offset:20736
    ds_read_b64_tr_b16 a[212:213], v6 offset:20480
    ds_read_b64_tr_b16 a[214:215], v6 offset:20736
    ds_read_b64_tr_b16 a[216:217], v5 offset:22528
    ds_read_b64_tr_b16 a[218:219], v5 offset:22784
    ds_read_b64_tr_b16 a[220:221], v6 offset:22528
    ds_read_b64_tr_b16 a[222:223], v6 offset:22784
    s_waitcnt lgkmcnt(4)
    ds_read_b64_tr_b16 a[224:225], v5 offset:24576
    ds_read_b64_tr_b16 a[226:227], v5 offset:24832
    ds_read_b64_tr_b16 a[228:229], v6 offset:24576
    ds_read_b64_tr_b16 a[230:231], v6 offset:24832
    ds_read_b64_tr_b16 a[232:233], v5 offset:26624
    ds_read_b64_tr_b16 a[234:235], v5 offset:26880
    ds_read_b64_tr_b16 a[236:237], v6 offset:26624
    ds_read_b64_tr_b16 a[238:239], v6 offset:26880
    s_waitcnt lgkmcnt(4)
    ds_read_b64_tr_b16 a[240:241], v5 offset:28672
    ds_read_b64_tr_b16 a[242:243], v5 offset:28928
    ds_read_b64_tr_b16 a[244:245], v6 offset:28672
    ds_read_b64_tr_b16 a[246:247], v6 offset:28928
    ds_read_b64_tr_b16 a[248:249], v5 offset:30720
    ds_read_b64_tr_b16 a[250:251], v5 offset:30976
    ds_read_b64_tr_b16 a[252:253], v6 offset:30720
    ds_read_b64_tr_b16 a[254:255], v6 offset:30976
    s_waitcnt lgkmcnt(4)
    s_waitcnt lgkmcnt(0)
    s_lshl_b32 s19, s16, 11
    s_add_u32 s19, s19, 131072
    v_add_u32 v7, s19, v0
    s_and_b32 s19, s16, 1
    s_lshl_b32 s19, s19, 10
    s_add_u32 s19, s19, 131072
    v_add_u32 v8, s19, v0
    s_mov_b32 s32, s30
L_og_top:
    s_lshr_b32 s21, s32, 1
    s_and_b32 s34, s21, 31
    s_lshl_b32 s34, s34, 12
    s_lshr_b32 s20, s21, 5
    s_lshl_b32 s20, s20, 9
    s_add_u32 s34, s34, s20
    s_lshl_b32 s20, s16, 7
    s_add_u32 s34, s34, s20
    s_add_u32 s34, s34, 63964160
    s_lshl_b32 s35, s32, 17
    s_lshl_b32 s20, s16, 15
    s_add_u32 s35, s35, s20
    s_add_u32 s35, s35, 67108864
    s_add_u32 s76, s31, 0
    s_and_b32 s76, s76, 7
    s_lshl_b32 s76, s76, 12
    s_add_u32 s76, s76, s35
    s_add_u32 s77, s31, 1
    s_and_b32 s77, s77, 7
    s_lshl_b32 s77, s77, 12
    s_add_u32 s77, s77, s35
    s_add_u32 s78, s31, 2
    s_and_b32 s78, s78, 7
    s_lshl_b32 s78, s78, 12
    s_add_u32 s78, s78, s35
    s_add_u32 s79, s31, 3
    s_and_b32 s79, s79, 7
    s_lshl_b32 s79, s79, 12
    s_add_u32 s79, s79, s35
    s_add_u32 s80, s31, 4
    s_and_b32 s80, s80, 7
    s_lshl_b32 s80, s80, 12
    s_add_u32 s80, s80, s35
    s_add_u32 s81, s31, 5
    s_and_b32 s81, s81, 7
    s_lshl_b32 s81, s81, 12
    s_add_u32 s81, s81, s35
    s_add_u32 s82, s31, 6
    s_and_b32 s82, s82, 7
    s_lshl_b32 s82, s82, 12
    s_add_u32 s82, s82, s35
    s_add_u32 s83, s31, 7
    s_and_b32 s83, s83, 7
    s_lshl_b32 s83, s83, 12
    s_add_u32 s83, s83, s35
    v_mov_b32 v20, 0
L_ww_16:
    buffer_load_dword v21, v20, s[8:11], s34 offen sc1
    s_waitcnt vmcnt(0)
    v_readfirstlane_b32 s19, v21
    s_nop 0
    s_cmp_ge_u32 s19, 8
    s_cbranch_scc1 L_wd_17
    s_add_u32 s71, s71, 1
    s_cmp_gt_u32 s71, 0x200000
    s_cbranch_scc1 L_work_fail
    s_sleep 2
    s_branch L_ww_16
L_wd_17:
    buffer_load_dwordx4 v[128:131], v0, s[8:11], s76 offen offset:0 sc1
    buffer_load_dwordx4 v[132:135], v0, s[8:11], s76 offen offset:1024 sc1
    buffer_load_dwordx4 v[136:139], v0, s[8:11], s76 offen offset:2048 sc1
    buffer_load_dwordx4 v[140:143], v0, s[8:11], s76 offen offset:3072 sc1
    buffer_load_dwordx4 v[144:147], v0, s[8:11], s77 offen offset:0 sc1
    buffer_load_dwordx4 v[148:151], v0, s[8:11], s77 offen offset:1024 sc1
    buffer_load_dwordx4 v[152:155], v0, s[8:11], s77 offen offset:2048 sc1
    buffer_load_dwordx4 v[156:159], v0, s[8:11], s77 offen offset:3072 sc1
    buffer_load_dwordx4 v[160:163], v0, s[8:11], s78 offen offset:0 sc1
    buffer_load_dwordx4 v[164:167], v0, s[8:11], s78 offen offset:1024 sc1
    buffer_load_dwordx4 v[168:171], v0, s[8:11], s78 offen offset:2048 sc1
    buffer_load_dwordx4 v[172:175], v0, s[8:11], s78 offen offset:3072 sc1
    s_waitcnt vmcnt(11)
    v_mfma_f32_16x16x32_bf16 v[16:19], a[0:3], v[128:131], 0
    v_mfma_f32_16x16x32_bf16 v[20:23], a[4:7], v[128:131], 0
    buffer_load_dwordx4 v[176:179], v0, s[8:11], s79 offen offset:0 sc1
    s_waitcnt vmcnt(11)
    v_mfma_f32_16x16x32_bf16 v[16:19], a[8:11], v[132:135], v[16:19]
    v_mfma_f32_16x16x32_bf16 v[20:23], a[12:15], v[132:135], v[20:23]
    buffer_load_dwordx4 v[180:183], v0, s[8:11], s79 offen offset:1024 sc1
    s_waitcnt vmcnt(11)
    v_mfma_f32_16x16x32_bf16 v[16:19], a[16:19], v[136:139], v[16:19]
    v_mfma_f32_16x16x32_bf16 v[20:23], a[20:23], v[136:139], v[20:23]
    buffer_load_dwordx4 v[184:187], v0, s[8:11], s79 offen offset:2048 sc1
    s_waitcnt vmcnt(11)
    v_mfma_f32_16x16x32_bf16 v[16:19], a[24:27], v[140:143], v[16:19]
    v_mfma_f32_16x16x32_bf16 v[20:23], a[28:31], v[140:143], v[20:23]
    buffer_load_dwordx4 v[188:191], v0, s[8:11], s79 offen offset:3072 sc1
    s_waitcnt vmcnt(11)
    v_mfma_f32_16x16x32_bf16 v[16:19], a[32:35], v[144:147], v[16:19]
    v_mfma_f32_16x16x32_bf16 v[20:23], a[36:39], v[144:147], v[20:23]
    buffer_load_dwordx4 v[192:195], v0, s[8:11], s80 offen offset:0 sc1
    s_waitcnt vmcnt(11)
    v_mfma_f32_16x16x32_bf16 v[16:19], a[40:43], v[148:151], v[16:19]
    v_mfma_f32_16x16x32_bf16 v[20:23], a[44:47], v[148:151], v[20:23]
    buffer_load_dwordx4 v[196:199], v0, s[8:11], s80 offen offset:1024 sc1
    s_waitcnt vmcnt(11)
    v_mfma_f32_16x16x32_bf16 v[16:19], a[48:51], v[152:155], v[16:19]
    v_mfma_f32_16x16x32_bf16 v[20:23], a[52:55], v[152:155], v[20:23]
    buffer_load_dwordx4 v[200:203], v0, s[8:11], s80 offen offset:2048 sc1
    s_waitcnt vmcnt(11)
    v_mfma_f32_16x16x32_bf16 v[16:19], a[56:59], v[156:159], v[16:19]
    v_mfma_f32_16x16x32_bf16 v[20:23], a[60:63], v[156:159], v[20:23]
    buffer_load_dwordx4 v[204:207], v0, s[8:11], s80 offen offset:3072 sc1
    s_waitcnt vmcnt(11)
    v_mfma_f32_16x16x32_bf16 v[16:19], a[64:67], v[160:163], v[16:19]
    v_mfma_f32_16x16x32_bf16 v[20:23], a[68:71], v[160:163], v[20:23]
    buffer_load_dwordx4 v[208:211], v0, s[8:11], s81 offen offset:0 sc1
    s_waitcnt vmcnt(11)
    v_mfma_f32_16x16x32_bf16 v[16:19], a[72:75], v[164:167], v[16:19]
    v_mfma_f32_16x16x32_bf16 v[20:23], a[76:79], v[164:167], v[20:23]
    buffer_load_dwordx4 v[212:215], v0, s[8:11], s81 offen offset:1024 sc1
    s_waitcnt vmcnt(11)
    v_mfma_f32_16x16x32_bf16 v[16:19], a[80:83], v[168:171], v[16:19]
    v_mfma_f32_16x16x32_bf16 v[20:23], a[84:87], v[168:171], v[20:23]
    buffer_load_dwordx4 v[216:219], v0, s[8:11], s81 offen offset:2048 sc1
    s_waitcnt vmcnt(11)
    v_mfma_f32_16x16x32_bf16 v[16:19], a[88:91], v[172:175], v[16:19]
    v_mfma_f32_16x16x32_bf16 v[20:23], a[92:95], v[172:175], v[20:23]
    buffer_load_dwordx4 v[220:223], v0, s[8:11], s81 offen offset:3072 sc1
    s_waitcnt vmcnt(11)
    v_mfma_f32_16x16x32_bf16 v[16:19], a[96:99], v[176:179], v[16:19]
    v_mfma_f32_16x16x32_bf16 v[20:23], a[100:103], v[176:179], v[20:23]
    buffer_load_dwordx4 v[224:227], v0, s[8:11], s82 offen offset:0 sc1
    s_waitcnt vmcnt(11)
    v_mfma_f32_16x16x32_bf16 v[16:19], a[104:107], v[180:183], v[16:19]
    v_mfma_f32_16x16x32_bf16 v[20:23], a[108:111], v[180:183], v[20:23]
    buffer_load_dwordx4 v[228:231], v0, s[8:11], s82 offen offset:1024 sc1
    s_waitcnt vmcnt(11)
    v_mfma_f32_16x16x32_bf16 v[16:19], a[112:115], v[184:187], v[16:19]
    v_mfma_f32_16x16x32_bf16 v[20:23], a[116:119], v[184:187], v[20:23]
    buffer_load_dwordx4 v[232:235], v0, s[8:11], s82 offen offset:2048 sc1
    s_waitcnt vmcnt(11)
    v_mfma_f32_16x16x32_bf16 v[16:19], a[120:123], v[188:191], v[16:19]
    v_mfma_f32_16x16x32_bf16 v[20:23], a[124:127], v[188:191], v[20:23]
    buffer_load_dwordx4 v[236:239], v0, s[8:11], s82 offen offset:3072 sc1
    s_waitcnt vmcnt(11)
    v_mfma_f32_16x16x32_bf16 v[16:19], a[128:131], v[192:195], v[16:19]
    v_mfma_f32_16x16x32_bf16 v[20:23], a[132:135], v[192:195], v[20:23]
    buffer_load_dwordx4 v[240:243], v0, s[8:11], s83 offen offset:0 sc1
    s_waitcnt vmcnt(11)
    v_mfma_f32_16x16x32_bf16 v[16:19], a[136:139], v[196:199], v[16:19]
    v_mfma_f32_16x16x32_bf16 v[20:23], a[140:143], v[196:199], v[20:23]
    buffer_load_dwordx4 v[244:247], v0, s[8:11], s83 offen offset:1024 sc1
    s_waitcnt vmcnt(11)
    v_mfma_f32_16x16x32_bf16 v[16:19], a[144:147], v[200:203], v[16:19]
    v_mfma_f32_16x16x32_bf16 v[20:23], a[148:151], v[200:203], v[20:23]
    buffer_load_dwordx4 v[248:251], v0, s[8:11], s83 offen offset:2048 sc1
    s_waitcnt vmcnt(11)
    v_mfma_f32_16x16x32_bf16 v[16:19], a[152:155], v[204:207], v[16:19]
    v_mfma_f32_16x16x32_bf16 v[20:23], a[156:159], v[204:207], v[20:23]
    buffer_load_dwordx4 v[252:255], v0, s[8:11], s83 offen offset:3072 sc1
    s_waitcnt vmcnt(11)
    v_mfma_f32_16x16x32_bf16 v[16:19], a[160:163], v[208:211], v[16:19]
    v_mfma_f32_16x16x32_bf16 v[20:23], a[164:167], v[208:211], v[20:23]
    s_waitcnt vmcnt(10)
    v_mfma_f32_16x16x32_bf16 v[16:19], a[168:171], v[212:215], v[16:19]
    v_mfma_f32_16x16x32_bf16 v[20:23], a[172:175], v[212:215], v[20:23]
    s_waitcnt vmcnt(9)
    v_mfma_f32_16x16x32_bf16 v[16:19], a[176:179], v[216:219], v[16:19]
    v_mfma_f32_16x16x32_bf16 v[20:23], a[180:183], v[216:219], v[20:23]
    s_waitcnt vmcnt(8)
    v_mfma_f32_16x16x32_bf16 v[16:19], a[184:187], v[220:223], v[16:19]
    v_mfma_f32_16x16x32_bf16 v[20:23], a[188:191], v[220:223], v[20:23]
    s_waitcnt vmcnt(7)
    v_mfma_f32_16x16x32_bf16 v[16:19], a[192:195], v[224:227], v[16:19]
    v_mfma_f32_16x16x32_bf16 v[20:23], a[196:199], v[224:227], v[20:23]
    s_waitcnt vmcnt(6)
    v_mfma_f32_16x16x32_bf16 v[16:19], a[200:203], v[228:231], v[16:19]
    v_mfma_f32_16x16x32_bf16 v[20:23], a[204:207], v[228:231], v[20:23]
    s_waitcnt vmcnt(5)
    v_mfma_f32_16x16x32_bf16 v[16:19], a[208:211], v[232:235], v[16:19]
    v_mfma_f32_16x16x32_bf16 v[20:23], a[212:215], v[232:235], v[20:23]
    s_waitcnt vmcnt(4)
    v_mfma_f32_16x16x32_bf16 v[16:19], a[216:219], v[236:239], v[16:19]
    v_mfma_f32_16x16x32_bf16 v[20:23], a[220:223], v[236:239], v[20:23]
    s_waitcnt vmcnt(3)
    v_mfma_f32_16x16x32_bf16 v[16:19], a[224:227], v[240:243], v[16:19]
    v_mfma_f32_16x16x32_bf16 v[20:23], a[228:231], v[240:243], v[20:23]
    s_waitcnt vmcnt(2)
    v_mfma_f32_16x16x32_bf16 v[16:19], a[232:235], v[244:247], v[16:19]
    v_mfma_f32_16x16x32_bf16 v[20:23], a[236:239], v[244:247], v[20:23]
    s_waitcnt vmcnt(1)
    v_mfma_f32_16x16x32_bf16 v[16:19], a[240:243], v[248:251], v[16:19]
    v_mfma_f32_16x16x32_bf16 v[20:23], a[244:247], v[248:251], v[20:23]
    s_waitcnt vmcnt(0)
    v_mfma_f32_16x16x32_bf16 v[16:19], a[248:251], v[252:255], v[16:19]
    v_mfma_f32_16x16x32_bf16 v[20:23], a[252:255], v[252:255], v[20:23]
    s_lshl_b32 s36, s32, 15
    s_lshl_b32 s19, s31, 6
    s_add_u32 s36, s36, s19
    s_lshl_b32 s19, s16, 5
    s_add_u32 s36, s36, s19
    s_add_u32 s36, s36, 1024
    s_nop 3
    ds_write_b128 v7, v[16:19]
    ds_write_b128 v7, v[20:23] offset:1024
    s_waitcnt lgkmcnt(0)
    s_barrier
    s_cmp_ge_u32 s16, 2
    s_cbranch_scc1 L_og_next
    ds_read_b128 v[24:27], v8 offset:0
    ds_read_b128 v[28:31], v8 offset:2048
    ds_read_b128 v[32:35], v8 offset:4096
    ds_read_b128 v[36:39], v8 offset:6144
    s_waitcnt lgkmcnt(0)
    v_add_f32 v24, v24, v28
    v_add_f32 v32, v32, v36
    v_add_f32 v25, v25, v29
    v_add_f32 v33, v33, v37
    v_add_f32 v26, v26, v30
    v_add_f32 v34, v34, v38
    v_add_f32 v27, v27, v31
    v_add_f32 v35, v35, v39
    v_add_f32 v24, v24, v32
    v_add_f32 v25, v25, v33
    v_add_f32 v26, v26, v34
    v_add_f32 v27, v27, v35
    v_cvt_pk_bf16_f32 v24, v24, v25
    v_cvt_pk_bf16_f32 v25, v26, v27
    buffer_store_dwordx2 v[24:25], v14, s[92:95], s36 offen
L_og_next:
    v_xor_b32 v7, 8192, v7
    v_xor_b32 v8, 8192, v8
    s_add_u32 s32, s32, 8
    s_cmp_lt_u32 s32, 128
    s_cbranch_scc1 L_og_top
    s_waitcnt vmcnt(0)
    s_endpgm
L_work_fail:
    v_mov_b32 v20, 56
    v_mov_b32 v21, s17
    v_add_u32 v21, 0x200, v21
    buffer_store_dword v21, v20, s[12:15], 0 offen sc1
    s_waitcnt vmcnt(0)
    s_endpgm
L_code_end:
.section .rodata,"a"
.p2align 6
.amdhsa_kernel concat_heads__linear_attn_block__memory_aug_recurrent_mem_tr__prompt_kernel
  .amdhsa_next_free_vgpr 512
  .amdhsa_next_free_sgpr 102
  .amdhsa_accum_offset 256
  .amdhsa_group_segment_fixed_size 0
  .amdhsa_kernarg_size 104
  .amdhsa_user_sgpr_count 2
  .amdhsa_user_sgpr_kernarg_segment_ptr 1
  .amdhsa_system_sgpr_workgroup_id_x 1
.end_amdhsa_kernel
```
